```python
import torch

def _softmax(x, axis=-1):
    return torch.softmax(x, dim=axis)
def _gelu(x):
    return torch.nn.functional.gelu(x, approximate="tanh")
def _silu(x):
    return torch.nn.functional.silu(x)
def _sigmoid(x):
    return torch.sigmoid(x)
def _layernorm(x, axis=-1, eps=1e-5):
    m = x.mean(dim=axis, keepdim=True)
    v = x.var(dim=axis, keepdim=True, unbiased=False)
    return (x - m) / torch.sqrt(v + eps)
def _scatter_add(tgt, idx, src, axis=0):
    return tgt.clone().index_add_(axis, idx, src)
def _segment_sum(src, seg, n):
    out = torch.zeros((n,) + src.shape[1:], dtype=src.dtype)
    return out.index_add_(0, seg, src)
def _pad(x, pw):
    flat = tuple(v for pair in reversed(pw) for v in pair)
    return torch.nn.functional.pad(x, flat)

kernel_name = 'standalone__modern_conv_block_slak__vision'

def setup_inputs():

    _w = (lambda a: (lambda t: t.to(torch.bfloat16) if t.is_floating_point() else t)(torch.as_tensor(a)))
    H = W = 224
    C = 96
    K = 7
    return {
        "x": _w((lambda *s: torch.randn(*s, dtype=torch.bfloat16) * 0.05)(1, H, W, C)),
        "dw": _w((lambda *s: torch.randn(*s, dtype=torch.bfloat16) * 0.05)(K, K, C)),
        "w1": _w((lambda *s: torch.randn(*s, dtype=torch.bfloat16) * 0.05)(C, 4 * C)),
        "w2": _w((lambda *s: torch.randn(*s, dtype=torch.bfloat16) * 0.05)(4 * C, C)),
        "grn_g": _w((lambda *s: torch.randn(*s, dtype=torch.bfloat16) * 0.05)(4 * C)),
        "grn_b": _w((lambda *s: torch.randn(*s, dtype=torch.bfloat16) * 0.05)(4 * C)),
    }

def reference(x, dw, w1, w2, grn_g, grn_b):
    B, H, W, C = x.shape
    K = dw.shape[0]
    pad = K // 2
    xp = _pad(x, ((0,0),(pad,pad),(pad,pad),(0,0)))
    out = torch.zeros_like(x)
    for i in range(K):
        for j in range(K):
            out = out + xp[:, i:i+H, j:j+W, :] * dw[i, j][None, None, None, :]
    h = _layernorm(out, axis=-1)
    h = _gelu(h @ w1)
    gx = torch.sqrt((h * h).sum(axis=(1, 2), keepdims=True) + 1e-6)
    nx = gx / (gx.mean(axis=-1, keepdims=True) + 1e-6)
    h = grn_g[None, None, None, :] * (h * nx) + grn_b[None, None, None, :] + h
    return x + h @ w2
```

```asm
; @launch grid=(256,1,1) block=(512,1,1) lds=163840
.amdgcn_target "amdgcn-amd-amdhsa--gfx950"
.text
.p2align 8
.type L_tab,@object
L_tab:
.long 150528,150528,0,30752,150320,150320,64,30816
.long 149072,160720,128,30880,148864,160512,192,30944
.long 150736,150736,272,31024,150528,150528,336,31088
.long 149280,160928,400,31152,149072,160720,400,31152
.long 151984,151984,30752,61440,151776,151776,30816,61504
.long 150528,150528,30880,61568,150320,150320,30944,61632
.long 152192,152192,31024,61712,151984,151984,31088,61776
.long 150736,150736,31152,61840,150528,150528,31152,61840
.long 150944,150944,64,30816,150736,150736,128,30880
.long 149488,161136,192,30944,149280,160928,272,31024
.long 151152,151152,336,31088,150944,150944,400,31152
.long 149696,161344,464,31216,149488,161136,464,31216
.long 152400,152400,30816,61504,152192,152192,30880,61568
.long 150944,150944,30944,61632,150736,150736,31024,61712
.long 152608,152608,31088,61776,152400,152400,31152,61840
.long 151152,151152,31216,61904,150944,150944,31216,61904
.long 151360,151360,128,30880,151152,151152,192,30944
.long 149904,161552,272,31024,149696,161344,336,31088
.long 151568,151568,400,31152,151360,151360,464,31216
.long 150112,161760,512,31264,149904,161552,512,31264
.long 152816,152816,30880,61568,152608,152608,30944,61632
.long 151360,151360,31024,61712,151152,151152,31088,61776
.long 153024,153024,31152,61840,152816,152816,31216,61904
.long 151568,151568,31264,61952,151360,151360,31264,61952
.long 151776,151776,192,30944,151568,151568,272,31024
.long 150320,161968,336,31088,150112,161760,400,31152
.long 151984,151984,464,31216,151776,151776,512,31264
.long 150528,162176,576,31328,150320,161968,576,31328
.long 153232,153232,30944,61632,153024,153024,31024,61712
.long 151776,151776,31088,61776,151568,151568,31152,61840
.long 153440,153440,31216,61904,153232,153232,31264,61952
.long 151984,151984,31328,62016,151776,151776,31328,62016
.long 0xc0c0100,0xc0c0c0c,0xc0c0302,0xc0c0c0c,0x1000c0c,0xc0c0c0c,0x3020c0c,0xc0c0c0c
.long 0xc0c0c0c,0xc0c0100,0xc0c0c0c,0xc0c0302,0xc0c0c0c,0x1000c0c,0xc0c0c0c,0x3020c0c
.long 0xc0c0c0c,0xc0c0c0c,0xc0c0302,0xc0c0c0c,0xc0c0c0c,0xc0c0c0c,0x3020c0c,0xc0c0c0c
.long 0xc0c0c0c,0xc0c0c0c,0xc0c0c0c,0xc0c0302,0xc0c0c0c,0xc0c0c0c,0xc0c0c0c,0x3020c0c
.long 0xc0c0100,0xc0c0c0c,0xc0c0302,0xc0c0c0c,0x1000c0c,0xc0c0c0c,0x3020c0c,0xc0c0c0c
.long 0xc0c0c0c,0xc0c0100,0xc0c0c0c,0xc0c0302,0xc0c0c0c,0x1000c0c,0xc0c0c0c,0x3020c0c
.long 0xc0c0c0c,0xc0c0c0c,0xc0c0302,0xc0c0c0c,0xc0c0c0c,0xc0c0c0c,0x3020c0c,0xc0c0c0c
.long 0xc0c0c0c,0xc0c0c0c,0xc0c0c0c,0xc0c0302,0xc0c0c0c,0xc0c0c0c,0xc0c0c0c,0x3020c0c
.long 0xc0c0100,0xc0c0c0c,0xc0c0302,0xc0c0c0c,0x1000c0c,0xc0c0c0c,0x3020c0c,0xc0c0c0c
.long 0xc0c0c0c,0xc0c0100,0xc0c0c0c,0xc0c0302,0xc0c0c0c,0x1000c0c,0xc0c0c0c,0x3020c0c
.long 0xc0c0100,0xc0c0c0c,0xc0c0302,0xc0c0c0c,0x1000c0c,0xc0c0c0c,0x3020c0c,0xc0c0c0c
.long 0xc0c0c0c,0xc0c0100,0xc0c0c0c,0xc0c0302,0xc0c0c0c,0x1000c0c,0xc0c0c0c,0x3020c0c
.long 0xc0c0100,0xc0c0c0c,0xc0c0302,0xc0c0c0c,0x1000c0c,0xc0c0c0c,0x3020c0c,0xc0c0c0c
.long 0xc0c0c0c,0xc0c0100,0xc0c0c0c,0xc0c0302,0xc0c0c0c,0x1000c0c,0xc0c0c0c,0x3020c0c
.long 0xc0c0100,0xc0c0c0c,0xc0c0302,0xc0c0c0c,0x1000c0c,0xc0c0c0c,0x3020c0c,0xc0c0c0c
.long 0xc0c0c0c,0xc0c0100,0xc0c0c0c,0xc0c0302,0xc0c0c0c,0x1000c0c,0xc0c0c0c,0x3020c0c
.long 0xc0c0100,0xc0c0c0c,0xc0c0302,0xc0c0c0c,0x1000c0c,0xc0c0c0c,0x3020c0c,0xc0c0c0c
.long 0xc0c0c0c,0xc0c0100,0xc0c0c0c,0xc0c0302,0xc0c0c0c,0x1000c0c,0xc0c0c0c,0x3020c0c
.long 0xc0c0100,0xc0c0c0c,0xc0c0302,0xc0c0c0c,0x1000c0c,0xc0c0c0c,0x3020c0c,0xc0c0c0c
.long 0xc0c0c0c,0xc0c0100,0xc0c0c0c,0xc0c0302,0xc0c0c0c,0x1000c0c,0xc0c0c0c,0x3020c0c
.long 0xc0c0100,0xc0c0c0c,0xc0c0302,0xc0c0c0c,0x1000c0c,0xc0c0c0c,0x3020c0c,0xc0c0c0c
.long 0xc0c0c0c,0xc0c0100,0xc0c0c0c,0xc0c0302,0xc0c0c0c,0x1000c0c,0xc0c0c0c,0x3020c0c
.long 0xc0c0100,0xc0c0c0c,0xc0c0302,0xc0c0c0c,0x1000c0c,0xc0c0c0c,0x3020c0c,0xc0c0c0c
.long 0xc0c0c0c,0xc0c0100,0xc0c0c0c,0xc0c0302,0xc0c0c0c,0x1000c0c,0xc0c0c0c,0x3020c0c
.long 0xc0c0100,0xc0c0c0c,0xc0c0c0c,0xc0c0c0c,0x1000c0c,0xc0c0c0c,0xc0c0c0c,0xc0c0c0c
.long 0xc0c0c0c,0xc0c0100,0xc0c0c0c,0xc0c0c0c,0xc0c0c0c,0x1000c0c,0xc0c0c0c,0xc0c0c0c
.long 0xc0c0100,0xc0c0c0c,0xc0c0302,0xc0c0c0c,0x1000c0c,0xc0c0c0c,0x3020c0c,0xc0c0c0c
.long 0xc0c0c0c,0xc0c0100,0xc0c0c0c,0xc0c0302,0xc0c0c0c,0x1000c0c,0xc0c0c0c,0x3020c0c
.long 0xc0c0100,0xc0c0c0c,0xc0c0c0c,0xc0c0c0c,0x1000c0c,0xc0c0c0c,0xc0c0c0c,0xc0c0c0c
.long 0xc0c0c0c,0xc0c0100,0xc0c0c0c,0xc0c0c0c,0xc0c0c0c,0x1000c0c,0xc0c0c0c,0xc0c0c0c
.long 0xc0c0100,0xc0c0c0c,0xc0c0302,0xc0c0c0c,0x1000c0c,0xc0c0c0c,0x3020c0c,0xc0c0c0c
.long 0xc0c0c0c,0xc0c0100,0xc0c0c0c,0xc0c0302,0xc0c0c0c,0x1000c0c,0xc0c0c0c,0x3020c0c
.long 0,11648,23296,34944,208,11856,23504,35152
.long 416,12064,23712,35360,624,12272,23920,35568
.long 832,12480,24128,35776,1040,12688,24336,35984
.long 1248,12896,24544,36192,160888,160888,160888,160888
.long 1456,13104,24752,160792,1664,13312,24960,160808
.long 1872,13520,25168,160824,2080,13728,25376,160840
.long 2288,13936,25584,160856,2496,14144,25792,160872
.long 2704,14352,26000,160888,160776,160776,160776,160776
.long 2912,14560,26208,36400,3120,14768,26416,36608
.long 3328,14976,26624,36816,3536,15184,26832,37024
.long 3744,15392,27040,37232,3952,15600,27248,37440
.long 4160,15808,27456,37648,160888,160888,160888,160888
.long 4368,16016,27664,160792,4576,16224,27872,160808
.long 4784,16432,28080,160824,4992,16640,28288,160840
.long 5200,16848,28496,160856,5408,17056,28704,160872
.long 5616,17264,28912,160888,160776,160776,160776,160776
.long 5824,17472,29120,37856,6032,17680,29328,38064
.long 6240,17888,29536,38272,6448,18096,29744,38480
.long 6656,18304,29952,38688,6864,18512,30160,38896
.long 7072,18720,30368,39104,160888,160888,160888,160888
.long 7280,18928,30576,160792,7488,19136,30784,160808
.long 7696,19344,30992,160824,7904,19552,31200,160840
.long 8112,19760,31408,160856,8320,19968,31616,160872
.long 8528,20176,31824,160888,160776,160776,160776,160776
.long 8736,20384,32032,39312,8944,20592,32240,39520
.long 9152,20800,32448,39728,9360,21008,32656,159744
.long 9568,21216,32864,159936,9776,21424,33072,160128
.long 9984,21632,33280,160320,160888,160888,160888,160888
.long 10192,21840,33488,160792,10400,22048,33696,160808
.long 10608,22256,33904,160824,10816,22464,34112,160840
.long 11024,22672,34320,160856,11232,22880,34528,160872
.long 11440,23088,34736,160888,160776,160776,160776,160776
.long 0,76800,159744,160512,208,76808,159936,160512
.long 416,76816,160128,160512,624,76824,160320,160512
.long 3328,76864,160512,160512,3536,76872,160512,160512
.long 3744,76880,160512,160512,3952,76888,160512,160512
.long 832,76928,160512,159744,1040,76936,160512,159936
.long 1248,76944,160512,160128,1456,76952,160512,160320
.long 4160,76992,160512,160512,4368,77000,160512,160512
.long 4576,77008,160512,160512,4784,77016,160512,160512
.long 1664,76832,160512,160512,1872,76840,160512,160512
.long 2080,76848,160512,160512,2288,76856,160512,160512
.long 4992,76896,159744,160512,5200,76904,159936,160512
.long 5408,76912,160128,160512,5616,76920,160320,160512
.long 2496,76960,160512,160512,2704,76968,160512,160512
.long 2912,76976,160512,160512,3120,76984,160512,160512
.long 5824,77024,160512,159744,6032,77032,160512,159936
.long 6240,77040,160512,160128,6448,77048,160512,160320
.long 16,77312,159760,160512,224,77320,159952,160512
.long 432,77328,160144,160512,640,77336,160336,160512
.long 3344,77376,160512,160512,3552,77384,160512,160512
.long 3760,77392,160512,160512,3968,77400,160512,160512
.long 848,77440,160512,159760,1056,77448,160512,159952
.long 1264,77456,160512,160144,1472,77464,160512,160336
.long 4176,77504,160512,160512,4384,77512,160512,160512
.long 4592,77520,160512,160512,4800,77528,160512,160512
.long 1680,77344,160512,160512,1888,77352,160512,160512
.long 2096,77360,160512,160512,2304,77368,160512,160512
.long 5008,77408,159760,160512,5216,77416,159952,160512
.long 5424,77424,160144,160512,5632,77432,160336,160512
.long 2512,77472,160512,160512,2720,77480,160512,160512
.long 2928,77488,160512,160512,3136,77496,160512,160512
.long 5840,77536,160512,159760,6048,77544,160512,159952
.long 6256,77552,160512,160144,6464,77560,160512,160336
.long 0,16,384,400,416,432,800,816
.long 832,848,1216,1232,1248,1264,1632,1648
.long 1680,1664,2064,2048,2096,2080,2480,2464
.long 2512,2496,2896,2880,2928,2912,3312,3296
.long 3328,3344,3712,3728,3744,3760,4128,4144
.long 4160,4176,4544,4560,4576,4592,4960,4976
.long 5008,4992,5392,5376,5424,5408,5808,5792
.long 5840,5824,6224,6208,6256,6240,6640,6624
.long 6656,6672,7040,7056,7072,7088,7456,7472
.long 7488,7504,7872,7888,7904,7920,8288,8304
.long 8336,8320,8720,8704,8752,8736,9136,9120
.long 9168,9152,9552,9536,9584,9568,9968,9952
.long 9984,10000,10368,10384,10400,10416,10784,10800
.long 10816,10832,11200,11216,11232,11248,11616,11632
.long 11664,11648,12048,12032,12080,12064,12464,12448
.long 12496,12480,12880,12864,12912,12896,13296,13280
.long 32,48,53632,404,448,464,54048,820
.long 864,880,54464,1236,1280,1296,54880,1652
.long 1712,1696,55312,2052,2128,2112,55728,2468
.long 2544,2528,56144,2884,2960,2944,56560,3300
.long 3360,3376,56960,3732,3776,3792,57376,4148
.long 4192,4208,57792,4564,4608,4624,58208,4980
.long 5040,5024,58640,5380,5456,5440,59056,5796
.long 5872,5856,59472,6212,6288,6272,59888,6628
.long 6688,6704,60288,7060,7104,7120,60704,7476
.long 7520,7536,61120,7892,7936,7952,61536,8308
.long 8368,8352,61968,8708,8784,8768,62384,9124
.long 9200,9184,62800,9540,9616,9600,63216,9956
.long 10016,10032,63616,10388,10432,10448,64032,10804
.long 10848,10864,64448,11220,11264,11280,64864,11636
.long 11696,11680,65296,12036,12112,12096,65712,12452
.long 12528,12512,66128,12868,12944,12928,66544,13284
.long 0,960,44544,302400,384,1344,44928,302784
.long 768,1728,45312,303168,1152,2112,387072,303552
.long 1536,2496,387456,0x7fffffff,1920,344256,387840,0x7fffffff
.long 2304,344640,388224,0x7fffffff,344064,345024,388608,0x7fffffff
.long 344448,345408,388992,0x7fffffff,344832,345792,389376,0x7fffffff
.long 345216,346176,43200,0x7fffffff,345600,346560,43584,0x7fffffff
.long 345984,43008,43968,0x7fffffff,346368,43392,44352,0x7fffffff
.long 192,43776,44736,0x7fffffff,576,44160,45120,0x7fffffff
.long 16,976,44560,302416,400,1360,44944,302800
.long 784,1744,45328,303184,1168,2128,387088,303568
.long 1552,2512,387472,0x7fffffff,1936,344272,387856,0x7fffffff
.long 2320,344656,388240,0x7fffffff,344080,345040,388624,0x7fffffff
.long 344464,345424,389008,0x7fffffff,344848,345808,389392,0x7fffffff
.long 345232,346192,43216,0x7fffffff,345616,346576,43600,0x7fffffff
.long 346000,43024,43984,0x7fffffff,346384,43408,44368,0x7fffffff
.long 208,43792,44752,0x7fffffff,592,44176,45136,0x7fffffff
.long 32,992,44576,302432,416,1376,44960,302816
.long 800,1760,45344,303200,1184,2144,387104,303584
.long 1568,2528,387488,0x7fffffff,1952,344288,387872,0x7fffffff
.long 2336,344672,388256,0x7fffffff,344096,345056,388640,0x7fffffff
.long 344480,345440,389024,0x7fffffff,344864,345824,389408,0x7fffffff
.long 345248,346208,43232,0x7fffffff,345632,346592,43616,0x7fffffff
.long 346016,43040,44000,0x7fffffff,346400,43424,44384,0x7fffffff
.long 224,43808,44768,0x7fffffff,608,44192,45152,0x7fffffff
.long 48,1008,44592,302448,432,1392,44976,302832
.long 816,1776,45360,303216,1200,2160,387120,303600
.long 1584,2544,387504,0x7fffffff,1968,344304,387888,0x7fffffff
.long 2352,344688,388272,0x7fffffff,344112,345072,388656,0x7fffffff
.long 344496,345456,389040,0x7fffffff,344880,345840,389424,0x7fffffff
.long 345264,346224,43248,0x7fffffff,345648,346608,43632,0x7fffffff
.long 346032,43056,44016,0x7fffffff,346416,43440,44400,0x7fffffff
.long 240,43824,44784,0x7fffffff,624,44208,45168,0x7fffffff
.long 0,20480,40960,0,16,20496,40976,6
.long 32,20512,40992,12,48,20528,41008,18
.long 64,20544,41024,24,80,20560,41040,30
.long 96,20576,41056,36,112,20592,41072,42
.long 128,20608,41088,48,144,20624,41104,54
.long 160,20640,41120,60,176,20656,41136,194
.long 192,20672,41152,200,208,20688,41168,206
.long 224,20704,41184,212,240,20720,41200,218
.long 256,20736,41216,4,272,20752,41232,10
.long 288,20768,41248,16,304,20784,41264,22
.long 320,20800,41280,28,336,20816,41296,34
.long 352,20832,41312,40,368,20848,41328,46
.long 384,20864,41344,52,400,20880,41360,58
.long 416,20896,41376,192,432,20912,41392,198
.long 448,20928,41408,204,464,20944,41424,210
.long 480,20960,41440,216,496,20976,41456,222
.long 512,20992,41472,2,528,21008,41488,8
.long 544,21024,41504,14,560,21040,41520,20
.long 576,21056,41536,26,592,21072,41552,32
.long 608,21088,41568,38,624,21104,41584,44
.long 640,21120,41600,50,656,21136,41616,56
.long 672,21152,41632,62,688,21168,41648,196
.long 704,21184,41664,202,720,21200,41680,208
.long 736,21216,41696,214,752,21232,41712,220
.long 768,21248,41728,4,784,21264,41744,10
.long 800,21280,41760,16,816,21296,41776,22
.long 832,21312,41792,28,848,21328,41808,34
.long 864,21344,41824,40,880,21360,41840,46
.long 896,21376,41856,52,912,21392,41872,58
.long 928,21408,41888,192,944,21424,41904,198
.long 960,21440,41920,204,976,21456,41936,210
.long 992,21472,41952,216,1008,21488,41968,222
.long 392,400,106896,163360,808,816,107312,163372
.long 1224,1232,107728,163384,1224,1232,108144,163396
.long 1640,1648,108544,163408,2072,2048,108960,163420
.long 2488,2464,109376,163432,2488,2464,109792,163444
.long 2904,2880,110224,163456,3320,3296,110640,163468
.long 3720,3728,111056,163480,3720,3728,111472,163492
.long 4136,4144,111872,163504,4552,4560,112288,163516
.long 4968,4976,112704,163528,4968,4976,113120,163540
.long 5400,5376,113552,163552,5816,5792,113968,163564
.long 6232,6208,114384,163576,6232,6208,114800,163588
.long 6648,6624,115200,163600,7048,7056,115616,163612
.long 7464,7472,116032,163624,7464,7472,116448,163636
.long 7880,7888,116880,163648,8296,8304,117296,163660
.long 8728,8704,117712,163672,8728,8704,118128,163684
.long 9144,9120,118528,163696,9560,9536,118944,163708
.long 9976,9952,119360,163720,9976,9952,119776,163732
.long 10376,10384,106900,163360,10792,10800,107316,163372
.long 11208,11216,107732,163384,11208,11216,108148,163396
.long 11624,11632,108548,163408,12056,12032,108964,163420
.long 12472,12448,109380,163432,12472,12448,109796,163444
.long 12888,12864,110228,163456,13304,13280,110644,163468
.long 13704,13712,111060,163480,13704,13712,111476,163492
.long 14120,14128,111876,163504,14536,14544,112292,163516
.long 14952,14960,112708,163528,14952,14960,113124,163540
.long 15384,15360,113556,163552,15800,15776,113972,163564
.long 16216,16192,114388,163576,16216,16192,114804,163588
.long 16632,16608,115204,163600,17032,17040,115620,163612
.long 17448,17456,116036,163624,17448,17456,116452,163636
.long 17864,17872,116884,163648,18280,18288,117300,163660
.long 18712,18688,117716,163672,18712,18688,118132,163684
.long 19128,19104,118532,163696,19544,19520,118948,163708
.long 19960,19936,119364,163720,19960,19936,119780,163732
.long 0,384,0,0,8,392,8,8
.long 16,400,16,16,24,408,24,24
.long 416,800,192,192,424,808,200,200
.long 432,816,208,208,440,824,216,216
.long 832,1216,384,384,840,1224,392,392
.long 848,1232,400,400,856,1240,408,408
.long 1248,1632,576,576,1256,1640,584,584
.long 1264,1648,592,592,1272,1656,600,600
.long 1680,2064,800,736,1688,2072,808,744
.long 1664,2048,816,752,1672,2056,824,760
.long 2096,2480,992,928,2104,2488,1000,936
.long 2080,2464,1008,944,2088,2472,1016,952
.long 2512,2896,1184,1120,2520,2904,1192,1128
.long 2496,2880,1200,1136,2504,2888,1208,1144
.long 2928,3312,1376,1312,2936,3320,1384,1320
.long 2912,3296,1392,1328,2920,3304,1400,1336
.long 3328,3712,1536,1536,3336,3720,1544,1544
.long 3344,3728,1552,1552,3352,3736,1560,1560
.long 3744,4128,1728,1728,3752,4136,1736,1736
.long 3760,4144,1744,1744,3768,4152,1752,1752
.long 4160,4544,1920,1920,4168,4552,1928,1928
.long 4176,4560,1936,1936,4184,4568,1944,1944
.long 4576,4960,2112,2112,4584,4968,2120,2120
.long 4592,4976,2128,2128,4600,4984,2136,2136
.long 5008,5392,2336,2272,5016,5400,2344,2280
.long 4992,5376,2352,2288,5000,5384,2360,2296
.long 5424,5808,2528,2464,5432,5816,2536,2472
.long 5408,5792,2544,2480,5416,5800,2552,2488
.long 5840,6224,2720,2656,5848,6232,2728,2664
.long 5824,6208,2736,2672,5832,6216,2744,2680
.long 6256,6640,2912,2848,6264,6648,2920,2856
.long 6240,6624,2928,2864,6248,6632,2936,2872
.long 161792,161960,162132,161792,161792,161960,162132,161804
.long 161792,161960,162132,161816,161792,161960,162132,161828
.long 161792,161964,162132,161840,161792,161964,162132,161852
.long 161792,161964,162132,161864,161792,161964,162132,161876
.long 161792,161964,162136,161888,161792,161964,162136,161900
.long 161792,161964,162136,161912,161792,161964,162136,161924
.long 161796,161964,162136,161936,161796,161964,162136,161948
.long 161796,161964,162136,161960,161796,161964,162136,161972
.long 161796,161968,162136,161800,161796,161968,162136,161812
.long 161796,161968,162136,161824,161796,161968,162136,161836
.long 161796,161968,162140,161848,161796,161968,162140,161860
.long 161796,161968,162140,161872,161796,161968,162140,161884
.long 161800,161968,162140,161896,161800,161968,162140,161908
.long 161800,161968,162140,161920,161800,161968,162140,161932
.long 161800,161972,162140,161944,161800,161972,162140,161956
.long 161800,161972,162140,161968,161800,161972,162140,161980
.long 161800,161972,162144,161796,161800,161972,162144,161808
.long 161800,161972,162144,161820,161800,161972,162144,161832
.long 161804,161972,162144,161844,161804,161972,162144,161856
.long 161804,161972,162144,161868,161804,161972,162144,161880
.long 161804,161976,162144,161892,161804,161976,162144,161904
.long 161804,161976,162144,161916,161804,161976,162144,161928
.long 161804,161976,162148,161940,161804,161976,162148,161952
.long 161804,161976,162148,161964,161804,161976,162148,161976
.long 161808,161976,162148,161800,161808,161976,162148,161812
.long 161808,161976,162148,161824,161808,161976,162148,161836
.long 161808,161980,162148,161848,161808,161980,162148,161860
.long 161808,161980,162148,161872,161808,161980,162148,161884
.long 161808,161980,162152,161896,161808,161980,162152,161908
.long 161808,161980,162152,161920,161808,161980,162152,161932
.long 161812,161980,162152,161944,161812,161980,162152,161956
.long 161812,161980,162152,161968,161812,161980,162152,161980
.long 0,8192,16416,0,16,8208,16432,16
.long 32,8224,16384,32,48,8240,16400,48
.long 64,8256,16480,64,80,8272,16496,80
.long 96,8288,16448,96,112,8304,16464,112
.long 128,8320,16544,128,144,8336,16560,144
.long 160,8352,16512,160,176,8368,16528,176
.long 192,8384,16608,192,208,8400,16624,208
.long 224,8416,16576,224,240,8432,16592,240
.long 256,8480,16672,2048,272,8496,16688,2064
.long 288,8448,16640,2080,304,8464,16656,2096
.long 320,8544,16736,2112,336,8560,16752,2128
.long 352,8512,16704,2144,368,8528,16720,2160
.long 384,8608,16800,2176,400,8624,16816,2192
.long 416,8576,16768,2208,432,8592,16784,2224
.long 448,8672,16864,2240,464,8688,16880,2256
.long 480,8640,16832,2272,496,8656,16848,2288
.long 512,8736,16896,4096,528,8752,16912,4112
.long 544,8704,16928,4128,560,8720,16944,4144
.long 576,8800,16960,4160,592,8816,16976,4176
.long 608,8768,16992,4192,624,8784,17008,4208
.long 640,8864,17024,4224,656,8880,17040,4240
.long 672,8832,17056,4256,688,8848,17072,4272
.long 704,8928,17088,4288,720,8944,17104,4304
.long 736,8896,17120,4320,752,8912,17136,4336
.long 800,8992,17152,6144,816,9008,17168,6160
.long 768,8960,17184,6176,784,8976,17200,6192
.long 864,9056,17216,6208,880,9072,17232,6224
.long 832,9024,17248,6240,848,9040,17264,6256
.long 928,9120,17280,6272,944,9136,17296,6288
.long 896,9088,17312,6304,912,9104,17328,6320
.long 992,9184,17344,6336,1008,9200,17360,6352
.long 960,9152,17376,6368,976,9168,17392,6384
.long 16256,0,0,0,0x3f800000,0,0,0
.long 0,16256,0,0,0,0x3f800000,0,0
.long 0,0,16256,0,0,0,0x3f800000,0
.long 0,0,0,16256,0,0,0,0x3f800000
.long 0,0,0,0,0,0,0,0
.long 0,0,0,0,0,0,0,0
.long 0,0,0,0,0,0,0,0
.long 0,0,0,0,0,0,0,0
.long 0,0,0,0,0,0,0,0
.long 0,0,0,0,0,0,0,0
.long 0,0,0,0,0,0,0,0
.long 0,0,0,0,0,0,0,0
.long 16256,0,0,0,0x3f800000,0,0,0
.long 0,16256,0,0,0,0x3f800000,0,0
.long 0,0,16256,0,0,0,0x3f800000,0
.long 0,0,0,16256,0,0,0,0x3f800000
.long 0,0,0,0,0,0,0,0
.long 0,0,0,0,0,0,0,0
.long 0,0,0,0,0,0,0,0
.long 0,0,0,0,0,0,0,0
.long 0,0,0,0,0,0,0,0
.long 0,0,0,0,0,0,0,0
.long 0,0,0,0,0,0,0,0
.long 0,0,0,0,0,0,0,0
.long 0,0,0,0,0,0,0,0
.long 0,0,0,0,0,0,0,0
.long 0,0,0,0,0,0,0,0
.long 0,0,0,0,0,0,0,0
.long 0,0,0,0,0,0,0,0
.long 0,0,0,0,0,0,0,0
.long 0,0,0,0,0,0,0,0
.long 0,0,0,0,0,0,0,0
.long 0,0,0,0,0,0,0,0
.long 0,0,0,0,0,0,0,0
.long 0,0,0,0,0,0,0,0
.long 0,0,0,0,0,0,0,0
.long 0,0,0,0,0,0,0,0
.long 0,0,0,0,0,0,0,0
.long 0,0,0,0,0,0,0,0
.long 0,0,0,0,0,0,0,0
.long 0,0,0,0,0,0,0,0
.long 0,0,0,0,0,0,0,0
.long 0,0,0,0,0,0,0,0
.long 0,0,0,0,0,0,0,0
.long 0,0,0,0,0,0,0,0
.long 0,0,0,0,0,0,0,0
.long 0,0,0,0,0,0,0,0
.long 0,0,0,0,0,0,0,0
.long 16256,0,0,0,0x3f800000,0,0,0
.long 0,16256,0,0,0,0x3f800000,0,0
.long 0,0,16256,0,0,0,0x3f800000,0
.long 0,0,0,16256,0,0,0,0x3f800000
.long 0,0,0,0,0,0,0,0
.long 0,0,0,0,0,0,0,0
.long 0,0,0,0,0,0,0,0
.long 0,0,0,0,0,0,0,0
.long 0,0,0,0,0,0,0,0
.long 0,0,0,0,0,0,0,0
.long 0,0,0,0,0,0,0,0
.long 0,0,0,0,0,0,0,0
.long 16256,0,0,0,0x3f800000,0,0,0
.long 0,16256,0,0,0,0x3f800000,0,0
.long 0,0,16256,0,0,0,0x3f800000,0
.long 0,0,0,16256,0,0,0,0x3f800000
.long 79872,79872,0,163360,80080,79888,400,163360
.long 80288,79904,800,163360,80496,79920,1200,163360
.long 80704,79936,64,163360,80912,79952,464,163360
.long 81120,79968,864,163360,81328,79984,1264,163360
.long 81536,80000,128,163360,81744,80016,528,163360
.long 81952,80032,928,163360,82160,80048,1328,163360
.long 82368,80080,8384,163360,82576,80096,8400,163360
.long 82784,80112,8416,163360,82992,80128,8432,163360
.long 79880,80144,16,163376,80088,80160,416,163376
.long 80296,80176,816,163376,80504,80192,1216,163376
.long 80712,80208,80,163376,80920,80224,480,163376
.long 81128,80240,880,163376,81336,80256,1280,163376
.long 81544,80288,144,163376,81752,80304,544,163376
.long 81960,80320,944,163376,82168,80336,1344,163376
.long 82376,80352,8640,163376,82584,80368,8656,163376
.long 82792,80384,8672,163376,83000,80400,8688,163376
.long 79888,80416,32,163392,80096,80432,432,163392
.long 80304,80448,832,163392,80512,80464,1232,163392
.long 80720,80496,96,163392,80928,80512,496,163392
.long 81136,80528,896,163392,81344,80544,1296,163392
.long 81552,80560,160,163392,81760,80576,560,163392
.long 81968,80592,960,163392,82176,80608,1360,163392
.long 82384,80624,8896,163392,82592,80640,8912,163392
.long 82800,80656,8928,163392,83008,80672,8944,163392
.long 79896,80496,48,163408,80104,80512,448,163408
.long 80312,80528,848,163408,80520,80544,1248,163408
.long 80728,80560,112,163408,80936,80576,512,163408
.long 81144,80592,912,163408,81352,80608,1312,163408
.long 81560,80624,176,163408,81768,80640,576,163408
.long 81976,80656,976,163408,82184,80672,1376,163408
.long 82392,80496,9152,163408,82600,80512,9168,163408
.long 82808,80528,9184,163408,83016,80544,9200,163408
.long 0,1536,960,2496,16,1552,976,2512
.long 32,1568,992,2528,48,1584,1008,2544
.long 64,1600,1024,2560,80,1616,1040,2576
.long 96,1632,1056,2592,112,1648,1072,2608
.long 128,1664,1088,2624,144,1680,1104,2640
.long 160,1696,1120,2656,176,1712,1136,2672
.long 384,1920,1344,344256,400,1936,1360,344272
.long 416,1952,1376,344288,432,1968,1392,344304
.long 448,1984,1408,344320,464,2000,1424,344336
.long 480,2016,1440,344352,496,2032,1456,344368
.long 512,2048,1472,344384,528,2064,1488,344400
.long 544,2080,1504,344416,560,2096,1520,344432
.long 768,2304,1728,344640,784,2320,1744,344656
.long 800,2336,1760,344672,816,2352,1776,344688
.long 832,2368,1792,344704,848,2384,1808,344720
.long 864,2400,1824,344736,880,2416,1840,344752
.long 896,2432,1856,344768,912,2448,1872,344784
.long 928,2464,1888,344800,944,2480,1904,344816
.long 1152,344064,2112,345024,1168,344080,2128,345040
.long 1184,344096,2144,345056,1200,344112,2160,345072
.long 1216,344128,2176,345088,1232,344144,2192,345104
.long 1248,344160,2208,345120,1264,344176,2224,345136
.long 1280,344192,2240,345152,1296,344208,2256,345168
.long 1312,344224,2272,345184,1328,344240,2288,345200
.long 0x7fffffff,0x7fffffff,0x7fffffff,0x7fffffff,0x7fffffff,0x7fffffff,0x7fffffff,0x7fffffff
.long 0x7fffffff,0x7fffffff,0x7fffffff,0x7fffffff,0x7fffffff,0x7fffffff,0x7fffffff,0x7fffffff
.long 0x7fffffff,0x7fffffff,0x7fffffff,0x7fffffff,0x7fffffff,0x7fffffff,0x7fffffff,0x7fffffff
.long 0x7fffffff,0x7fffffff,0x7fffffff,0x7fffffff,0x7fffffff,0x7fffffff,0x7fffffff,0x7fffffff
.long 0x7fffffff,0x7fffffff,0x7fffffff,0x7fffffff,0x7fffffff,0x7fffffff,0x7fffffff,0x7fffffff
.long 0x7fffffff,0x7fffffff,0x7fffffff,0x7fffffff,0x7fffffff,0x7fffffff,0x7fffffff,0x7fffffff
.long 0x7fffffff,0x7fffffff,0x7fffffff,0x7fffffff,0x7fffffff,0x7fffffff,0x7fffffff,0x7fffffff
.long 0x7fffffff,0x7fffffff,0x7fffffff,0x7fffffff,0x7fffffff,0x7fffffff,0x7fffffff,0x7fffffff
.long 44544,387456,302400,0,44560,387472,302416,32
.long 44576,387488,302432,64,44592,387504,302448,96
.long 44608,387520,302464,128,44624,387536,302480,160
.long 44640,387552,302496,192,44656,387568,302512,224
.long 44672,387584,302528,256,44688,387600,302544,288
.long 44704,387616,302560,320,44720,387632,302576,352
.long 44928,387840,302784,400,44944,387856,302800,432
.long 44960,387872,302816,464,44976,387888,302832,496
.long 44992,387904,302848,528,45008,387920,302864,560
.long 45024,387936,302880,592,45040,387952,302896,624
.long 45056,387968,302912,656,45072,387984,302928,688
.long 45088,388000,302944,720,45104,388016,302960,752
.long 45312,388224,303168,800,45328,388240,303184,832
.long 45344,388256,303200,864,45360,388272,303216,896
.long 45376,388288,303232,928,45392,388304,303248,960
.long 45408,388320,303264,992,45424,388336,303280,1024
.long 45440,388352,303296,1056,45456,388368,303312,1088
.long 45472,388384,303328,1120,45488,388400,303344,1152
.long 387072,388608,303552,1200,387088,388624,303568,1232
.long 387104,388640,303584,1264,387120,388656,303600,1296
.long 387136,388672,303616,1328,387152,388688,303632,1360
.long 387168,388704,303648,1392,387184,388720,303664,1424
.long 387200,388736,303680,1456,387216,388752,303696,1488
.long 387232,388768,303712,1520,387248,388784,303728,1552
.long 0x7fffffff,0x7fffffff,0x7fffffff,1200,0x7fffffff,0x7fffffff,0x7fffffff,1232
.long 0x7fffffff,0x7fffffff,0x7fffffff,1264,0x7fffffff,0x7fffffff,0x7fffffff,1296
.long 0x7fffffff,0x7fffffff,0x7fffffff,1328,0x7fffffff,0x7fffffff,0x7fffffff,1360
.long 0x7fffffff,0x7fffffff,0x7fffffff,1392,0x7fffffff,0x7fffffff,0x7fffffff,1424
.long 0x7fffffff,0x7fffffff,0x7fffffff,1456,0x7fffffff,0x7fffffff,0x7fffffff,1488
.long 0x7fffffff,0x7fffffff,0x7fffffff,1520,0x7fffffff,0x7fffffff,0x7fffffff,1552
.long 0x7fffffff,0x7fffffff,0x7fffffff,1200,0x7fffffff,0x7fffffff,0x7fffffff,1232
.long 0x7fffffff,0x7fffffff,0x7fffffff,1264,0x7fffffff,0x7fffffff,0x7fffffff,1296
.long 150536,150536,8,30760,150328,150328,72,30824
.long 149080,160728,136,30888,148872,160520,200,30952
.long 150744,150744,280,31032,150536,150536,344,31096
.long 149288,160936,408,31160,149080,160728,408,31160
.long 151992,151992,30760,61448,151784,151784,30824,61512
.long 150536,150536,30888,61576,150328,150328,30952,61640
.long 152200,152200,31032,61720,151992,151992,31096,61784
.long 150744,150744,31160,61848,150536,150536,31160,61848
.long 150952,150952,72,30824,150744,150744,136,30888
.long 149496,161144,200,30952,149288,160936,280,31032
.long 151160,151160,344,31096,150952,150952,408,31160
.long 149704,161352,472,31224,149496,161144,472,31224
.long 152408,152408,30824,61512,152200,152200,30888,61576
.long 150952,150952,30952,61640,150744,150744,31032,61720
.long 152616,152616,31096,61784,152408,152408,31160,61848
.long 151160,151160,31224,61912,150952,150952,31224,61912
.long 151368,151368,136,30888,151160,151160,200,30952
.long 149912,161560,280,31032,149704,161352,344,31096
.long 151576,151576,408,31160,151368,151368,472,31224
.long 150120,161768,520,31272,149912,161560,520,31272
.long 152824,152824,30888,61576,152616,152616,30952,61640
.long 151368,151368,31032,61720,151160,151160,31096,61784
.long 153032,153032,31160,61848,152824,152824,31224,61912
.long 151576,151576,31272,61960,151368,151368,31272,61960
.long 151784,151784,200,30952,151576,151576,280,31032
.long 150328,161976,344,31096,150120,161768,408,31160
.long 151992,151992,472,31224,151784,151784,520,31272
.long 150536,162184,584,31336,150328,161976,584,31336
.long 153240,153240,30952,61640,153032,153032,31032,61720
.long 151784,151784,31096,61784,151576,151576,31160,61848
.long 153448,153448,31224,61912,153240,153240,31272,61960
.long 151992,151992,31336,62024,151784,151784,31336,62024
.long 0xc0c0100,0xc0c0c0c,0xc0c0302,0xc0c0c0c,0x1000c0c,0xc0c0c0c,0x3020c0c,0xc0c0c0c
.long 0xc0c0c0c,0xc0c0100,0xc0c0c0c,0xc0c0302,0xc0c0c0c,0x1000c0c,0xc0c0c0c,0x3020c0c
.long 0xc0c0c0c,0xc0c0c0c,0xc0c0302,0xc0c0c0c,0xc0c0c0c,0xc0c0c0c,0x3020c0c,0xc0c0c0c
.long 0xc0c0c0c,0xc0c0c0c,0xc0c0c0c,0xc0c0302,0xc0c0c0c,0xc0c0c0c,0xc0c0c0c,0x3020c0c
.long 0xc0c0100,0xc0c0c0c,0xc0c0302,0xc0c0c0c,0x1000c0c,0xc0c0c0c,0x3020c0c,0xc0c0c0c
.long 0xc0c0c0c,0xc0c0100,0xc0c0c0c,0xc0c0302,0xc0c0c0c,0x1000c0c,0xc0c0c0c,0x3020c0c
.long 0xc0c0c0c,0xc0c0c0c,0xc0c0302,0xc0c0c0c,0xc0c0c0c,0xc0c0c0c,0x3020c0c,0xc0c0c0c
.long 0xc0c0c0c,0xc0c0c0c,0xc0c0c0c,0xc0c0302,0xc0c0c0c,0xc0c0c0c,0xc0c0c0c,0x3020c0c
.long 0xc0c0100,0xc0c0c0c,0xc0c0302,0xc0c0c0c,0x1000c0c,0xc0c0c0c,0x3020c0c,0xc0c0c0c
.long 0xc0c0c0c,0xc0c0100,0xc0c0c0c,0xc0c0302,0xc0c0c0c,0x1000c0c,0xc0c0c0c,0x3020c0c
.long 0xc0c0100,0xc0c0c0c,0xc0c0302,0xc0c0c0c,0x1000c0c,0xc0c0c0c,0x3020c0c,0xc0c0c0c
.long 0xc0c0c0c,0xc0c0100,0xc0c0c0c,0xc0c0302,0xc0c0c0c,0x1000c0c,0xc0c0c0c,0x3020c0c
.long 0xc0c0100,0xc0c0c0c,0xc0c0302,0xc0c0c0c,0x1000c0c,0xc0c0c0c,0x3020c0c,0xc0c0c0c
.long 0xc0c0c0c,0xc0c0100,0xc0c0c0c,0xc0c0302,0xc0c0c0c,0x1000c0c,0xc0c0c0c,0x3020c0c
.long 0xc0c0100,0xc0c0c0c,0xc0c0302,0xc0c0c0c,0x1000c0c,0xc0c0c0c,0x3020c0c,0xc0c0c0c
.long 0xc0c0c0c,0xc0c0100,0xc0c0c0c,0xc0c0302,0xc0c0c0c,0x1000c0c,0xc0c0c0c,0x3020c0c
.long 0xc0c0100,0xc0c0c0c,0xc0c0302,0xc0c0c0c,0x1000c0c,0xc0c0c0c,0x3020c0c,0xc0c0c0c
.long 0xc0c0c0c,0xc0c0100,0xc0c0c0c,0xc0c0302,0xc0c0c0c,0x1000c0c,0xc0c0c0c,0x3020c0c
.long 0xc0c0100,0xc0c0c0c,0xc0c0302,0xc0c0c0c,0x1000c0c,0xc0c0c0c,0x3020c0c,0xc0c0c0c
.long 0xc0c0c0c,0xc0c0100,0xc0c0c0c,0xc0c0302,0xc0c0c0c,0x1000c0c,0xc0c0c0c,0x3020c0c
.long 0xc0c0100,0xc0c0c0c,0xc0c0302,0xc0c0c0c,0x1000c0c,0xc0c0c0c,0x3020c0c,0xc0c0c0c
.long 0xc0c0c0c,0xc0c0100,0xc0c0c0c,0xc0c0302,0xc0c0c0c,0x1000c0c,0xc0c0c0c,0x3020c0c
.long 0xc0c0100,0xc0c0c0c,0xc0c0302,0xc0c0c0c,0x1000c0c,0xc0c0c0c,0x3020c0c,0xc0c0c0c
.long 0xc0c0c0c,0xc0c0100,0xc0c0c0c,0xc0c0302,0xc0c0c0c,0x1000c0c,0xc0c0c0c,0x3020c0c
.long 0xc0c0100,0xc0c0c0c,0xc0c0c0c,0xc0c0c0c,0x1000c0c,0xc0c0c0c,0xc0c0c0c,0xc0c0c0c
.long 0xc0c0c0c,0xc0c0100,0xc0c0c0c,0xc0c0c0c,0xc0c0c0c,0x1000c0c,0xc0c0c0c,0xc0c0c0c
.long 0xc0c0100,0xc0c0c0c,0xc0c0302,0xc0c0c0c,0x1000c0c,0xc0c0c0c,0x3020c0c,0xc0c0c0c
.long 0xc0c0c0c,0xc0c0100,0xc0c0c0c,0xc0c0302,0xc0c0c0c,0x1000c0c,0xc0c0c0c,0x3020c0c
.long 0xc0c0100,0xc0c0c0c,0xc0c0c0c,0xc0c0c0c,0x1000c0c,0xc0c0c0c,0xc0c0c0c,0xc0c0c0c
.long 0xc0c0c0c,0xc0c0100,0xc0c0c0c,0xc0c0c0c,0xc0c0c0c,0x1000c0c,0xc0c0c0c,0xc0c0c0c
.long 0xc0c0100,0xc0c0c0c,0xc0c0302,0xc0c0c0c,0x1000c0c,0xc0c0c0c,0x3020c0c,0xc0c0c0c
.long 0xc0c0c0c,0xc0c0100,0xc0c0c0c,0xc0c0302,0xc0c0c0c,0x1000c0c,0xc0c0c0c,0x3020c0c
.long 8,11656,23304,34952,216,11864,23512,35160
.long 424,12072,23720,35368,632,12280,23928,35576
.long 840,12488,24136,35784,1048,12696,24344,35992
.long 1256,12904,24552,36200,160880,160880,160880,160880
.long 1464,13112,24760,160784,1672,13320,24968,160800
.long 1880,13528,25176,160816,2088,13736,25384,160832
.long 2296,13944,25592,160848,2504,14152,25800,160864
.long 2712,14360,26008,160880,160768,160768,160768,160768
.long 2920,14568,26216,36408,3128,14776,26424,36616
.long 3336,14984,26632,36824,3544,15192,26840,37032
.long 3752,15400,27048,37240,3960,15608,27256,37448
.long 4168,15816,27464,37656,160880,160880,160880,160880
.long 4376,16024,27672,160784,4584,16232,27880,160800
.long 4792,16440,28088,160816,5000,16648,28296,160832
.long 5208,16856,28504,160848,5416,17064,28712,160864
.long 5624,17272,28920,160880,160768,160768,160768,160768
.long 5832,17480,29128,37864,6040,17688,29336,38072
.long 6248,17896,29544,38280,6456,18104,29752,38488
.long 6664,18312,29960,38696,6872,18520,30168,38904
.long 7080,18728,30376,39112,160880,160880,160880,160880
.long 7288,18936,30584,160784,7496,19144,30792,160800
.long 7704,19352,31000,160816,7912,19560,31208,160832
.long 8120,19768,31416,160848,8328,19976,31624,160864
.long 8536,20184,31832,160880,160768,160768,160768,160768
.long 8744,20392,32040,39320,8952,20600,32248,39528
.long 9160,20808,32456,39736,9368,21016,32664,159752
.long 9576,21224,32872,159944,9784,21432,33080,160136
.long 9992,21640,33288,160328,160880,160880,160880,160880
.long 10200,21848,33496,160784,10408,22056,33704,160800
.long 10616,22264,33912,160816,10824,22472,34120,160832
.long 11032,22680,34328,160848,11240,22888,34536,160864
.long 11448,23096,34744,160880,160768,160768,160768,160768
.long 0,82944,159744,160512,208,82952,159936,160512
.long 416,82960,160128,160512,624,82968,160320,160512
.long 3328,83008,160512,160512,3536,83016,160512,160512
.long 3744,83024,160512,160512,3952,83032,160512,160512
.long 832,83072,160512,159744,1040,83080,160512,159936
.long 1248,83088,160512,160128,1456,83096,160512,160320
.long 4160,83136,160512,160512,4368,83144,160512,160512
.long 4576,83152,160512,160512,4784,83160,160512,160512
.long 1664,82976,160512,160512,1872,82984,160512,160512
.long 2080,82992,160512,160512,2288,83000,160512,160512
.long 4992,83040,159744,160512,5200,83048,159936,160512
.long 5408,83056,160128,160512,5616,83064,160320,160512
.long 2496,83104,160512,160512,2704,83112,160512,160512
.long 2912,83120,160512,160512,3120,83128,160512,160512
.long 5824,83168,160512,159744,6032,83176,160512,159936
.long 6240,83184,160512,160128,6448,83192,160512,160320
.long 16,83456,159760,160512,224,83464,159952,160512
.long 432,83472,160144,160512,640,83480,160336,160512
.long 3344,83520,160512,160512,3552,83528,160512,160512
.long 3760,83536,160512,160512,3968,83544,160512,160512
.long 848,83584,160512,159760,1056,83592,160512,159952
.long 1264,83600,160512,160144,1472,83608,160512,160336
.long 4176,83648,160512,160512,4384,83656,160512,160512
.long 4592,83664,160512,160512,4800,83672,160512,160512
.long 1680,83488,160512,160512,1888,83496,160512,160512
.long 2096,83504,160512,160512,2304,83512,160512,160512
.long 5008,83552,159760,160512,5216,83560,159952,160512
.long 5424,83568,160144,160512,5632,83576,160336,160512
.long 2512,83616,160512,160512,2720,83624,160512,160512
.long 2928,83632,160512,160512,3136,83640,160512,160512
.long 5840,83680,160512,159760,6048,83688,160512,159952
.long 6256,83696,160512,160144,6464,83704,160512,160336
.long 13312,13328,13696,13712,13728,13744,14112,14128
.long 14144,14160,14528,14544,14560,14576,14944,14960
.long 14992,14976,15376,15360,15408,15392,15792,15776
.long 15824,15808,16208,16192,16240,16224,16624,16608
.long 16640,16656,17024,17040,17056,17072,17440,17456
.long 17472,17488,17856,17872,17888,17904,18272,18288
.long 18320,18304,18704,18688,18736,18720,19120,19104
.long 19152,19136,19536,19520,19568,19552,19952,19936
.long 19968,19984,20352,20368,20384,20400,20768,20784
.long 20800,20816,21184,21200,21216,21232,21600,21616
.long 21648,21632,22032,22016,22064,22048,22448,22432
.long 22480,22464,22864,22848,22896,22880,23280,23264
.long 23296,23312,23680,23696,23712,23728,24096,24112
.long 24128,24144,24512,24528,24544,24560,24928,24944
.long 24976,24960,25360,25344,25392,25376,25776,25760
.long 25808,25792,26192,26176,26224,26208,26608,26592
.long 13344,13360,66944,13716,13760,13776,67360,14132
.long 14176,14192,67776,14548,14592,14608,68192,14964
.long 15024,15008,68624,15364,15440,15424,69040,15780
.long 15856,15840,69456,16196,16272,16256,69872,16612
.long 16672,16688,70272,17044,17088,17104,70688,17460
.long 17504,17520,71104,17876,17920,17936,71520,18292
.long 18352,18336,71952,18692,18768,18752,72368,19108
.long 19184,19168,72784,19524,19600,19584,73200,19940
.long 20000,20016,73600,20372,20416,20432,74016,20788
.long 20832,20848,74432,21204,21248,21264,74848,21620
.long 21680,21664,75280,22020,22096,22080,75696,22436
.long 22512,22496,76112,22852,22928,22912,76528,23268
.long 23328,23344,76928,23700,23744,23760,77344,24116
.long 24160,24176,77760,24532,24576,24592,78176,24948
.long 25008,24992,78608,25348,25424,25408,79024,25764
.long 25840,25824,79440,26180,26256,26240,79856,26596
.long 96,1056,44640,302496,480,1440,45024,302880
.long 864,1824,45408,303264,1248,2208,387168,303648
.long 1632,2592,387552,0x7fffffff,2016,344352,387936,0x7fffffff
.long 2400,344736,388320,0x7fffffff,344160,345120,388704,0x7fffffff
.long 344544,345504,389088,0x7fffffff,344928,345888,389472,0x7fffffff
.long 345312,346272,43296,0x7fffffff,345696,346656,43680,0x7fffffff
.long 346080,43104,44064,0x7fffffff,346464,43488,44448,0x7fffffff
.long 288,43872,44832,0x7fffffff,672,44256,45216,0x7fffffff
.long 112,1072,44656,302512,496,1456,45040,302896
.long 880,1840,45424,303280,1264,2224,387184,303664
.long 1648,2608,387568,0x7fffffff,2032,344368,387952,0x7fffffff
.long 2416,344752,388336,0x7fffffff,344176,345136,388720,0x7fffffff
.long 344560,345520,389104,0x7fffffff,344944,345904,389488,0x7fffffff
.long 345328,346288,43312,0x7fffffff,345712,346672,43696,0x7fffffff
.long 346096,43120,44080,0x7fffffff,346480,43504,44464,0x7fffffff
.long 304,43888,44848,0x7fffffff,688,44272,45232,0x7fffffff
.long 128,1088,44672,302528,512,1472,45056,302912
.long 896,1856,45440,303296,1280,2240,387200,303680
.long 1664,2624,387584,0x7fffffff,2048,344384,387968,0x7fffffff
.long 2432,344768,388352,0x7fffffff,344192,345152,388736,0x7fffffff
.long 344576,345536,389120,0x7fffffff,344960,345920,389504,0x7fffffff
.long 345344,346304,43328,0x7fffffff,345728,346688,43712,0x7fffffff
.long 346112,43136,44096,0x7fffffff,346496,43520,44480,0x7fffffff
.long 320,43904,44864,0x7fffffff,704,44288,45248,0x7fffffff
.long 144,1104,44688,302544,528,1488,45072,302928
.long 912,1872,45456,303312,1296,2256,387216,303696
.long 1680,2640,387600,0x7fffffff,2064,344400,387984,0x7fffffff
.long 2448,344784,388368,0x7fffffff,344208,345168,388752,0x7fffffff
.long 344592,345552,389136,0x7fffffff,344976,345936,389520,0x7fffffff
.long 345360,346320,43344,0x7fffffff,345744,346704,43728,0x7fffffff
.long 346128,43152,44112,0x7fffffff,346512,43536,44496,0x7fffffff
.long 336,43920,44880,0x7fffffff,720,44304,45264,0x7fffffff
.long 1024,21504,41984,224,1040,21520,42000,230
.long 1056,21536,42016,236,1072,21552,42032,242
.long 1088,21568,42048,248,1104,21584,42064,254
.long 1120,21600,42080,388,1136,21616,42096,394
.long 1152,21632,42112,400,1168,21648,42128,406
.long 1184,21664,42144,412,1200,21680,42160,418
.long 1216,21696,42176,424,1232,21712,42192,430
.long 1248,21728,42208,436,1264,21744,42224,442
.long 1280,21760,42240,228,1296,21776,42256,234
.long 1312,21792,42272,240,1328,21808,42288,246
.long 1344,21824,42304,252,1360,21840,42320,386
.long 1376,21856,42336,392,1392,21872,42352,398
.long 1408,21888,42368,404,1424,21904,42384,410
.long 1440,21920,42400,416,1456,21936,42416,422
.long 1472,21952,42432,428,1488,21968,42448,434
.long 1504,21984,42464,440,1520,22000,42480,446
.long 1536,22016,42496,226,1552,22032,42512,232
.long 1568,22048,42528,238,1584,22064,42544,244
.long 1600,22080,42560,250,1616,22096,42576,384
.long 1632,22112,42592,390,1648,22128,42608,396
.long 1664,22144,42624,402,1680,22160,42640,408
.long 1696,22176,42656,414,1712,22192,42672,420
.long 1728,22208,42688,426,1744,22224,42704,432
.long 1760,22240,42720,438,1776,22256,42736,444
.long 1792,22272,42752,228,1808,22288,42768,234
.long 1824,22304,42784,240,1840,22320,42800,246
.long 1856,22336,42816,252,1872,22352,42832,386
.long 1888,22368,42848,392,1904,22384,42864,398
.long 1920,22400,42880,404,1936,22416,42896,410
.long 1952,22432,42912,416,1968,22448,42928,422
.long 1984,22464,42944,428,2000,22480,42960,434
.long 2016,22496,42976,440,2032,22512,42992,446
.long 20360,20368,120208,163360,20776,20784,120624,163372
.long 21192,21200,121040,163384,21192,21200,121456,163396
.long 21608,21616,121856,163408,22040,22016,122272,163420
.long 22456,22432,122688,163432,22456,22432,123104,163444
.long 22872,22848,123536,163456,23288,23264,123952,163468
.long 23688,23696,124368,163480,23688,23696,124784,163492
.long 24104,24112,125184,163504,24520,24528,125600,163516
.long 24936,24944,126016,163528,24936,24944,126432,163540
.long 25368,25344,126864,163552,25784,25760,127280,163564
.long 26200,26176,127696,163576,26200,26176,128112,163588
.long 26616,26592,128512,163600,27016,27024,128928,163612
.long 27432,27440,129344,163624,27432,27440,129760,163636
.long 27848,27856,130192,163648,28264,28272,130608,163660
.long 28696,28672,131024,163672,28696,28672,131440,163684
.long 29112,29088,131840,163696,29528,29504,132256,163708
.long 29944,29920,132672,163720,29944,29920,133088,163732
.long 30344,30352,120212,163360,30760,30768,120628,163372
.long 31176,31184,121044,163384,31176,31184,121460,163396
.long 31592,31600,121860,163408,32024,32000,122276,163420
.long 32440,32416,122692,163432,32440,32416,123108,163444
.long 32856,32832,123540,163456,33272,33248,123956,163468
.long 33672,33680,124372,163480,33672,33680,124788,163492
.long 34088,34096,125188,163504,34504,34512,125604,163516
.long 34920,34928,126020,163528,34920,34928,126436,163540
.long 35352,35328,126868,163552,35768,35744,127284,163564
.long 36184,36160,127700,163576,36184,36160,128116,163588
.long 36600,36576,128516,163600,37000,37008,128932,163612
.long 37416,37424,129348,163624,37416,37424,129764,163636
.long 37832,37840,130196,163648,38248,38256,130612,163660
.long 38680,38656,131028,163672,38680,38656,131444,163684
.long 39096,39072,131844,163696,39512,39488,132260,163708
.long 39928,39904,132676,163720,39928,39904,133092,163732
.long 0,384,96,96,8,392,104,104
.long 16,400,112,112,24,408,120,120
.long 416,800,288,288,424,808,296,296
.long 432,816,304,304,440,824,312,312
.long 832,1216,480,480,840,1224,488,488
.long 848,1232,496,496,856,1240,504,504
.long 1248,1632,672,672,1256,1640,680,680
.long 1264,1648,688,688,1272,1656,696,696
.long 1680,2064,832,896,1688,2072,840,904
.long 1664,2048,848,912,1672,2056,856,920
.long 2096,2480,1024,1088,2104,2488,1032,1096
.long 2080,2464,1040,1104,2088,2472,1048,1112
.long 2512,2896,1216,1280,2520,2904,1224,1288
.long 2496,2880,1232,1296,2504,2888,1240,1304
.long 2928,3312,1408,1472,2936,3320,1416,1480
.long 2912,3296,1424,1488,2920,3304,1432,1496
.long 3328,3712,1632,1632,3336,3720,1640,1640
.long 3344,3728,1648,1648,3352,3736,1656,1656
.long 3744,4128,1824,1824,3752,4136,1832,1832
.long 3760,4144,1840,1840,3768,4152,1848,1848
.long 4160,4544,2016,2016,4168,4552,2024,2024
.long 4176,4560,2032,2032,4184,4568,2040,2040
.long 4576,4960,2208,2208,4584,4968,2216,2216
.long 4592,4976,2224,2224,4600,4984,2232,2232
.long 5008,5392,2368,2432,5016,5400,2376,2440
.long 4992,5376,2384,2448,5000,5384,2392,2456
.long 5424,5808,2560,2624,5432,5816,2568,2632
.long 5408,5792,2576,2640,5416,5800,2584,2648
.long 5840,6224,2752,2816,5848,6232,2760,2824
.long 5824,6208,2768,2832,5832,6216,2776,2840
.long 6256,6640,2944,3008,6264,6648,2952,3016
.long 6240,6624,2960,3024,6248,6632,2968,3032
.long 161812,161984,162152,161984,161812,161984,162152,161996
.long 161812,161984,162152,162008,161812,161984,162152,162020
.long 161812,161984,162156,162032,161812,161984,162156,162044
.long 161812,161984,162156,162056,161812,161984,162156,162068
.long 161816,161984,162156,162080,161816,161984,162156,162092
.long 161816,161984,162156,162104,161816,161984,162156,162116
.long 161816,161988,162156,162128,161816,161988,162156,162140
.long 161816,161988,162156,162152,161816,161988,162156,162164
.long 161816,161988,162160,161992,161816,161988,162160,162004
.long 161816,161988,162160,162016,161816,161988,162160,162028
.long 161820,161988,162160,162040,161820,161988,162160,162052
.long 161820,161988,162160,162064,161820,161988,162160,162076
.long 161820,161992,162160,162088,161820,161992,162160,162100
.long 161820,161992,162160,162112,161820,161992,162160,162124
.long 161820,161992,162164,162136,161820,161992,162164,162148
.long 161820,161992,162164,162160,161820,161992,162164,162172
.long 161824,161992,162164,161988,161824,161992,162164,162000
.long 161824,161992,162164,162012,161824,161992,162164,162024
.long 161824,161996,162164,162036,161824,161996,162164,162048
.long 161824,161996,162164,162060,161824,161996,162164,162072
.long 161824,161996,162168,162084,161824,161996,162168,162096
.long 161824,161996,162168,162108,161824,161996,162168,162120
.long 161828,161996,162168,162132,161828,161996,162168,162144
.long 161828,161996,162168,162156,161828,161996,162168,162168
.long 161828,162000,162168,161992,161828,162000,162168,162004
.long 161828,162000,162168,162016,161828,162000,162168,162028
.long 161828,162000,162172,162040,161828,162000,162172,162052
.long 161828,162000,162172,162064,161828,162000,162172,162076
.long 161832,162000,162172,162088,161832,162000,162172,162100
.long 161832,162000,162172,162112,161832,162000,162172,162124
.long 161832,162004,162172,162136,161832,162004,162172,162148
.long 161832,162004,162172,162160,161832,162004,162172,162172
.long 1056,9216,17408,256,1072,9232,17424,272
.long 1024,9248,17440,288,1040,9264,17456,304
.long 1120,9280,17472,320,1136,9296,17488,336
.long 1088,9312,17504,352,1104,9328,17520,368
.long 1184,9344,17536,384,1200,9360,17552,400
.long 1152,9376,17568,416,1168,9392,17584,432
.long 1248,9408,17600,448,1264,9424,17616,464
.long 1216,9440,17632,480,1232,9456,17648,496
.long 1312,9472,17696,2304,1328,9488,17712,2320
.long 1280,9504,17664,2336,1296,9520,17680,2352
.long 1376,9536,17760,2368,1392,9552,17776,2384
.long 1344,9568,17728,2400,1360,9584,17744,2416
.long 1440,9600,17824,2432,1456,9616,17840,2448
.long 1408,9632,17792,2464,1424,9648,17808,2480
.long 1504,9664,17888,2496,1520,9680,17904,2512
.long 1472,9696,17856,2528,1488,9712,17872,2544
.long 1536,9728,17952,4352,1552,9744,17968,4368
.long 1568,9760,17920,4384,1584,9776,17936,4400
.long 1600,9792,18016,4416,1616,9808,18032,4432
.long 1632,9824,17984,4448,1648,9840,18000,4464
.long 1664,9856,18080,4480,1680,9872,18096,4496
.long 1696,9888,18048,4512,1712,9904,18064,4528
.long 1728,9920,18144,4544,1744,9936,18160,4560
.long 1760,9952,18112,4576,1776,9968,18128,4592
.long 1792,10016,18208,6400,1808,10032,18224,6416
.long 1824,9984,18176,6432,1840,10000,18192,6448
.long 1856,10080,18272,6464,1872,10096,18288,6480
.long 1888,10048,18240,6496,1904,10064,18256,6512
.long 1920,10144,18336,6528,1936,10160,18352,6544
.long 1952,10112,18304,6560,1968,10128,18320,6576
.long 1984,10208,18400,6592,2000,10224,18416,6608
.long 2016,10176,18368,6624,2032,10192,18384,6640
.long 16256,0,0,0,0x3f800000,0,0,0
.long 0,16256,0,0,0,0x3f800000,0,0
.long 0,0,16256,0,0,0,0x3f800000,0
.long 0,0,0,16256,0,0,0,0x3f800000
.long 0,0,0,0,0,0,0,0
.long 0,0,0,0,0,0,0,0
.long 0,0,0,0,0,0,0,0
.long 0,0,0,0,0,0,0,0
.long 0,0,0,0,0,0,0,0
.long 0,0,0,0,0,0,0,0
.long 0,0,0,0,0,0,0,0
.long 0,0,0,0,0,0,0,0
.long 16256,0,0,0,0x3f800000,0,0,0
.long 0,16256,0,0,0,0x3f800000,0,0
.long 0,0,16256,0,0,0,0x3f800000,0
.long 0,0,0,16256,0,0,0,0x3f800000
.long 0,0,0,0,0,0,0,0
.long 0,0,0,0,0,0,0,0
.long 0,0,0,0,0,0,0,0
.long 0,0,0,0,0,0,0,0
.long 0,0,0,0,0,0,0,0
.long 0,0,0,0,0,0,0,0
.long 0,0,0,0,0,0,0,0
.long 0,0,0,0,0,0,0,0
.long 0,0,0,0,0,0,0,0
.long 0,0,0,0,0,0,0,0
.long 0,0,0,0,0,0,0,0
.long 0,0,0,0,0,0,0,0
.long 0,0,0,0,0,0,0,0
.long 0,0,0,0,0,0,0,0
.long 0,0,0,0,0,0,0,0
.long 0,0,0,0,0,0,0,0
.long 0,0,0,0,0,0,0,0
.long 0,0,0,0,0,0,0,0
.long 0,0,0,0,0,0,0,0
.long 0,0,0,0,0,0,0,0
.long 0,0,0,0,0,0,0,0
.long 0,0,0,0,0,0,0,0
.long 0,0,0,0,0,0,0,0
.long 0,0,0,0,0,0,0,0
.long 0,0,0,0,0,0,0,0
.long 0,0,0,0,0,0,0,0
.long 0,0,0,0,0,0,0,0
.long 0,0,0,0,0,0,0,0
.long 0,0,0,0,0,0,0,0
.long 0,0,0,0,0,0,0,0
.long 0,0,0,0,0,0,0,0
.long 0,0,0,0,0,0,0,0
.long 16256,0,0,0,0x3f800000,0,0,0
.long 0,16256,0,0,0,0x3f800000,0,0
.long 0,0,16256,0,0,0,0x3f800000,0
.long 0,0,0,16256,0,0,0,0x3f800000
.long 0,0,0,0,0,0,0,0
.long 0,0,0,0,0,0,0,0
.long 0,0,0,0,0,0,0,0
.long 0,0,0,0,0,0,0,0
.long 0,0,0,0,0,0,0,0
.long 0,0,0,0,0,0,0,0
.long 0,0,0,0,0,0,0,0
.long 0,0,0,0,0,0,0,0
.long 16256,0,0,0,0x3f800000,0,0,0
.long 0,16256,0,0,0,0x3f800000,0,0
.long 0,0,16256,0,0,0,0x3f800000,0
.long 0,0,0,16256,0,0,0,0x3f800000
.long 79968,81536,192,163552,80176,81552,592,163552
.long 80384,81568,992,163552,80592,81584,1392,163552
.long 80800,81600,256,163552,81008,81616,656,163552
.long 81216,81632,1056,163552,81424,81648,1456,163552
.long 81632,81664,320,163552,81840,81680,720,163552
.long 82048,81696,1120,163552,82256,81712,1520,163552
.long 82464,81744,9408,163552,82672,81760,9424,163552
.long 82880,81776,9440,163552,83088,81792,9456,163552
.long 79976,81808,208,163568,80184,81824,608,163568
.long 80392,81840,1008,163568,80600,81856,1408,163568
.long 80808,81872,272,163568,81016,81888,672,163568
.long 81224,81904,1072,163568,81432,81920,1472,163568
.long 81640,81952,336,163568,81848,81968,736,163568
.long 82056,81984,1136,163568,82264,82000,1536,163568
.long 82472,82016,9664,163568,82680,82032,9680,163568
.long 82888,82048,9696,163568,83096,82064,9712,163568
.long 79984,82080,224,163584,80192,82096,624,163584
.long 80400,82112,1024,163584,80608,82128,1424,163584
.long 80816,82160,288,163584,81024,82176,688,163584
.long 81232,82192,1088,163584,81440,82208,1488,163584
.long 81648,82224,352,163584,81856,82240,752,163584
.long 82064,82256,1152,163584,82272,82272,1552,163584
.long 82480,82288,9920,163584,82688,82304,9936,163584
.long 82896,82320,9952,163584,83104,82336,9968,163584
.long 79992,82160,240,163600,80200,82176,640,163600
.long 80408,82192,1040,163600,80616,82208,1440,163600
.long 80824,82224,304,163600,81032,82240,704,163600
.long 81240,82256,1104,163600,81448,82272,1504,163600
.long 81656,82288,368,163600,81864,82304,768,163600
.long 82072,82320,1168,163600,82280,82336,1568,163600
.long 82488,82160,10176,163600,82696,82176,10192,163600
.long 82904,82192,10208,163600,83112,82208,10224,163600
.long 344448,345984,345408,43008,344464,346000,345424,43024
.long 344480,346016,345440,43040,344496,346032,345456,43056
.long 344512,346048,345472,43072,344528,346064,345488,43088
.long 344544,346080,345504,43104,344560,346096,345520,43120
.long 344576,346112,345536,43136,344592,346128,345552,43152
.long 344608,346144,345568,43168,344624,346160,345584,43184
.long 344832,346368,345792,43392,344848,346384,345808,43408
.long 344864,346400,345824,43424,344880,346416,345840,43440
.long 344896,346432,345856,43456,344912,346448,345872,43472
.long 344928,346464,345888,43488,344944,346480,345904,43504
.long 344960,346496,345920,43520,344976,346512,345936,43536
.long 344992,346528,345952,43552,345008,346544,345968,43568
.long 345216,192,346176,43776,345232,208,346192,43792
.long 345248,224,346208,43808,345264,240,346224,43824
.long 345280,256,346240,43840,345296,272,346256,43856
.long 345312,288,346272,43872,345328,304,346288,43888
.long 345344,320,346304,43904,345360,336,346320,43920
.long 345376,352,346336,43936,345392,368,346352,43952
.long 345600,576,346560,44160,345616,592,346576,44176
.long 345632,608,346592,44192,345648,624,346608,44208
.long 345664,640,346624,44224,345680,656,346640,44240
.long 345696,672,346656,44256,345712,688,346672,44272
.long 345728,704,346688,44288,345744,720,346704,44304
.long 345760,736,346720,44320,345776,752,346736,44336
.long 0x7fffffff,0x7fffffff,0x7fffffff,0x7fffffff,0x7fffffff,0x7fffffff,0x7fffffff,0x7fffffff
.long 0x7fffffff,0x7fffffff,0x7fffffff,0x7fffffff,0x7fffffff,0x7fffffff,0x7fffffff,0x7fffffff
.long 0x7fffffff,0x7fffffff,0x7fffffff,0x7fffffff,0x7fffffff,0x7fffffff,0x7fffffff,0x7fffffff
.long 0x7fffffff,0x7fffffff,0x7fffffff,0x7fffffff,0x7fffffff,0x7fffffff,0x7fffffff,0x7fffffff
.long 0x7fffffff,0x7fffffff,0x7fffffff,0x7fffffff,0x7fffffff,0x7fffffff,0x7fffffff,0x7fffffff
.long 0x7fffffff,0x7fffffff,0x7fffffff,0x7fffffff,0x7fffffff,0x7fffffff,0x7fffffff,0x7fffffff
.long 0x7fffffff,0x7fffffff,0x7fffffff,0x7fffffff,0x7fffffff,0x7fffffff,0x7fffffff,0x7fffffff
.long 0x7fffffff,0x7fffffff,0x7fffffff,0x7fffffff,0x7fffffff,0x7fffffff,0x7fffffff,0x7fffffff
.long 388992,43968,302400,0,389008,43984,302416,32
.long 389024,44000,302432,64,389040,44016,302448,96
.long 389056,44032,302464,128,389072,44048,302480,160
.long 389088,44064,302496,192,389104,44080,302512,224
.long 389120,44096,302528,256,389136,44112,302544,288
.long 389152,44128,302560,320,389168,44144,302576,352
.long 389376,44352,302784,400,389392,44368,302800,432
.long 389408,44384,302816,464,389424,44400,302832,496
.long 389440,44416,302848,528,389456,44432,302864,560
.long 389472,44448,302880,592,389488,44464,302896,624
.long 389504,44480,302912,656,389520,44496,302928,688
.long 389536,44512,302944,720,389552,44528,302960,752
.long 43200,44736,303168,800,43216,44752,303184,832
.long 43232,44768,303200,864,43248,44784,303216,896
.long 43264,44800,303232,928,43280,44816,303248,960
.long 43296,44832,303264,992,43312,44848,303280,1024
.long 43328,44864,303296,1056,43344,44880,303312,1088
.long 43360,44896,303328,1120,43376,44912,303344,1152
.long 43584,45120,303552,1200,43600,45136,303568,1232
.long 43616,45152,303584,1264,43632,45168,303600,1296
.long 43648,45184,303616,1328,43664,45200,303632,1360
.long 43680,45216,303648,1392,43696,45232,303664,1424
.long 43712,45248,303680,1456,43728,45264,303696,1488
.long 43744,45280,303712,1520,43760,45296,303728,1552
.long 0x7fffffff,0x7fffffff,0x7fffffff,1200,0x7fffffff,0x7fffffff,0x7fffffff,1232
.long 0x7fffffff,0x7fffffff,0x7fffffff,1264,0x7fffffff,0x7fffffff,0x7fffffff,1296
.long 0x7fffffff,0x7fffffff,0x7fffffff,1328,0x7fffffff,0x7fffffff,0x7fffffff,1360
.long 0x7fffffff,0x7fffffff,0x7fffffff,1392,0x7fffffff,0x7fffffff,0x7fffffff,1424
.long 0x7fffffff,0x7fffffff,0x7fffffff,1456,0x7fffffff,0x7fffffff,0x7fffffff,1488
.long 0x7fffffff,0x7fffffff,0x7fffffff,1520,0x7fffffff,0x7fffffff,0x7fffffff,1552
.long 0x7fffffff,0x7fffffff,0x7fffffff,1200,0x7fffffff,0x7fffffff,0x7fffffff,1232
.long 0x7fffffff,0x7fffffff,0x7fffffff,1264,0x7fffffff,0x7fffffff,0x7fffffff,1296
.long 150544,150544,16,30768,150336,150336,80,30832
.long 149088,160736,144,30896,148880,160528,208,30960
.long 150752,150752,256,31008,150544,150544,320,31072
.long 149296,160944,384,31136,149088,160736,384,31136
.long 152000,152000,30768,61456,151792,151792,30832,61520
.long 150544,150544,30896,61584,150336,150336,30960,61648
.long 152208,152208,31008,61696,152000,152000,31072,61760
.long 150752,150752,31136,61824,150544,150544,31136,61824
.long 150960,150960,80,30832,150752,150752,144,30896
.long 149504,161152,208,30960,149296,160944,256,31008
.long 151168,151168,320,31072,150960,150960,384,31136
.long 149712,161360,448,31200,149504,161152,448,31200
.long 152416,152416,30832,61520,152208,152208,30896,61584
.long 150960,150960,30960,61648,150752,150752,31008,61696
.long 152624,152624,31072,61760,152416,152416,31136,61824
.long 151168,151168,31200,61888,150960,150960,31200,61888
.long 151376,151376,144,30896,151168,151168,208,30960
.long 149920,161568,256,31008,149712,161360,320,31072
.long 151584,151584,384,31136,151376,151376,448,31200
.long 150128,161776,528,31280,149920,161568,528,31280
.long 152832,152832,30896,61584,152624,152624,30960,61648
.long 151376,151376,31008,61696,151168,151168,31072,61760
.long 153040,153040,31136,61824,152832,152832,31200,61888
.long 151584,151584,31280,61968,151376,151376,31280,61968
.long 151792,151792,208,30960,151584,151584,256,31008
.long 150336,161984,320,31072,150128,161776,384,31136
.long 152000,152000,448,31200,151792,151792,528,31280
.long 150544,162192,592,31344,150336,161984,592,31344
.long 153248,153248,30960,61648,153040,153040,31008,61696
.long 151792,151792,31072,61760,151584,151584,31136,61824
.long 153456,153456,31200,61888,153248,153248,31280,61968
.long 152000,152000,31344,62032,151792,151792,31344,62032
.long 0xc0c0100,0xc0c0c0c,0xc0c0302,0xc0c0c0c,0x1000c0c,0xc0c0c0c,0x3020c0c,0xc0c0c0c
.long 0xc0c0c0c,0xc0c0100,0xc0c0c0c,0xc0c0302,0xc0c0c0c,0x1000c0c,0xc0c0c0c,0x3020c0c
.long 0xc0c0c0c,0xc0c0c0c,0xc0c0302,0xc0c0c0c,0xc0c0c0c,0xc0c0c0c,0x3020c0c,0xc0c0c0c
.long 0xc0c0c0c,0xc0c0c0c,0xc0c0c0c,0xc0c0302,0xc0c0c0c,0xc0c0c0c,0xc0c0c0c,0x3020c0c
.long 0xc0c0100,0xc0c0c0c,0xc0c0302,0xc0c0c0c,0x1000c0c,0xc0c0c0c,0x3020c0c,0xc0c0c0c
.long 0xc0c0c0c,0xc0c0100,0xc0c0c0c,0xc0c0302,0xc0c0c0c,0x1000c0c,0xc0c0c0c,0x3020c0c
.long 0xc0c0c0c,0xc0c0c0c,0xc0c0302,0xc0c0c0c,0xc0c0c0c,0xc0c0c0c,0x3020c0c,0xc0c0c0c
.long 0xc0c0c0c,0xc0c0c0c,0xc0c0c0c,0xc0c0302,0xc0c0c0c,0xc0c0c0c,0xc0c0c0c,0x3020c0c
.long 0xc0c0100,0xc0c0c0c,0xc0c0302,0xc0c0c0c,0x1000c0c,0xc0c0c0c,0x3020c0c,0xc0c0c0c
.long 0xc0c0c0c,0xc0c0100,0xc0c0c0c,0xc0c0302,0xc0c0c0c,0x1000c0c,0xc0c0c0c,0x3020c0c
.long 0xc0c0100,0xc0c0c0c,0xc0c0302,0xc0c0c0c,0x1000c0c,0xc0c0c0c,0x3020c0c,0xc0c0c0c
.long 0xc0c0c0c,0xc0c0100,0xc0c0c0c,0xc0c0302,0xc0c0c0c,0x1000c0c,0xc0c0c0c,0x3020c0c
.long 0xc0c0100,0xc0c0c0c,0xc0c0302,0xc0c0c0c,0x1000c0c,0xc0c0c0c,0x3020c0c,0xc0c0c0c
.long 0xc0c0c0c,0xc0c0100,0xc0c0c0c,0xc0c0302,0xc0c0c0c,0x1000c0c,0xc0c0c0c,0x3020c0c
.long 0xc0c0100,0xc0c0c0c,0xc0c0302,0xc0c0c0c,0x1000c0c,0xc0c0c0c,0x3020c0c,0xc0c0c0c
.long 0xc0c0c0c,0xc0c0100,0xc0c0c0c,0xc0c0302,0xc0c0c0c,0x1000c0c,0xc0c0c0c,0x3020c0c
.long 0xc0c0100,0xc0c0c0c,0xc0c0302,0xc0c0c0c,0x1000c0c,0xc0c0c0c,0x3020c0c,0xc0c0c0c
.long 0xc0c0c0c,0xc0c0100,0xc0c0c0c,0xc0c0302,0xc0c0c0c,0x1000c0c,0xc0c0c0c,0x3020c0c
.long 0xc0c0100,0xc0c0c0c,0xc0c0302,0xc0c0c0c,0x1000c0c,0xc0c0c0c,0x3020c0c,0xc0c0c0c
.long 0xc0c0c0c,0xc0c0100,0xc0c0c0c,0xc0c0302,0xc0c0c0c,0x1000c0c,0xc0c0c0c,0x3020c0c
.long 0xc0c0100,0xc0c0c0c,0xc0c0302,0xc0c0c0c,0x1000c0c,0xc0c0c0c,0x3020c0c,0xc0c0c0c
.long 0xc0c0c0c,0xc0c0100,0xc0c0c0c,0xc0c0302,0xc0c0c0c,0x1000c0c,0xc0c0c0c,0x3020c0c
.long 0xc0c0100,0xc0c0c0c,0xc0c0302,0xc0c0c0c,0x1000c0c,0xc0c0c0c,0x3020c0c,0xc0c0c0c
.long 0xc0c0c0c,0xc0c0100,0xc0c0c0c,0xc0c0302,0xc0c0c0c,0x1000c0c,0xc0c0c0c,0x3020c0c
.long 0xc0c0100,0xc0c0c0c,0xc0c0c0c,0xc0c0c0c,0x1000c0c,0xc0c0c0c,0xc0c0c0c,0xc0c0c0c
.long 0xc0c0c0c,0xc0c0100,0xc0c0c0c,0xc0c0c0c,0xc0c0c0c,0x1000c0c,0xc0c0c0c,0xc0c0c0c
.long 0xc0c0100,0xc0c0c0c,0xc0c0302,0xc0c0c0c,0x1000c0c,0xc0c0c0c,0x3020c0c,0xc0c0c0c
.long 0xc0c0c0c,0xc0c0100,0xc0c0c0c,0xc0c0302,0xc0c0c0c,0x1000c0c,0xc0c0c0c,0x3020c0c
.long 0xc0c0100,0xc0c0c0c,0xc0c0c0c,0xc0c0c0c,0x1000c0c,0xc0c0c0c,0xc0c0c0c,0xc0c0c0c
.long 0xc0c0c0c,0xc0c0100,0xc0c0c0c,0xc0c0c0c,0xc0c0c0c,0x1000c0c,0xc0c0c0c,0xc0c0c0c
.long 0xc0c0100,0xc0c0c0c,0xc0c0302,0xc0c0c0c,0x1000c0c,0xc0c0c0c,0x3020c0c,0xc0c0c0c
.long 0xc0c0c0c,0xc0c0100,0xc0c0c0c,0xc0c0302,0xc0c0c0c,0x1000c0c,0xc0c0c0c,0x3020c0c
.long 16,11664,23312,34960,224,11872,23520,35168
.long 432,12080,23728,35376,640,12288,23936,35584
.long 848,12496,24144,35792,1056,12704,24352,36000
.long 1264,12912,24560,36208,160888,160888,160888,160888
.long 1472,13120,24768,160792,1680,13328,24976,160808
.long 1888,13536,25184,160824,2096,13744,25392,160840
.long 2304,13952,25600,160856,2512,14160,25808,160872
.long 2720,14368,26016,160888,160776,160776,160776,160776
.long 2928,14576,26224,36416,3136,14784,26432,36624
.long 3344,14992,26640,36832,3552,15200,26848,37040
.long 3760,15408,27056,37248,3968,15616,27264,37456
.long 4176,15824,27472,37664,160888,160888,160888,160888
.long 4384,16032,27680,160792,4592,16240,27888,160808
.long 4800,16448,28096,160824,5008,16656,28304,160840
.long 5216,16864,28512,160856,5424,17072,28720,160872
.long 5632,17280,28928,160888,160776,160776,160776,160776
.long 5840,17488,29136,37872,6048,17696,29344,38080
.long 6256,17904,29552,38288,6464,18112,29760,38496
.long 6672,18320,29968,38704,6880,18528,30176,38912
.long 7088,18736,30384,39120,160888,160888,160888,160888
.long 7296,18944,30592,160792,7504,19152,30800,160808
.long 7712,19360,31008,160824,7920,19568,31216,160840
.long 8128,19776,31424,160856,8336,19984,31632,160872
.long 8544,20192,31840,160888,160776,160776,160776,160776
.long 8752,20400,32048,39328,8960,20608,32256,39536
.long 9168,20816,32464,39744,9376,21024,32672,159760
.long 9584,21232,32880,159952,9792,21440,33088,160144
.long 10000,21648,33296,160336,160888,160888,160888,160888
.long 10208,21856,33504,160792,10416,22064,33712,160808
.long 10624,22272,33920,160824,10832,22480,34128,160840
.long 11040,22688,34336,160856,11248,22896,34544,160872
.long 11456,23104,34752,160888,160776,160776,160776,160776
.long 0,89088,159744,160512,208,89096,159936,160512
.long 416,89104,160128,160512,624,89112,160320,160512
.long 3328,89152,160512,160512,3536,89160,160512,160512
.long 3744,89168,160512,160512,3952,89176,160512,160512
.long 832,89216,160512,159744,1040,89224,160512,159936
.long 1248,89232,160512,160128,1456,89240,160512,160320
.long 4160,89280,160512,160512,4368,89288,160512,160512
.long 4576,89296,160512,160512,4784,89304,160512,160512
.long 1664,89120,160512,160512,1872,89128,160512,160512
.long 2080,89136,160512,160512,2288,89144,160512,160512
.long 4992,89184,159744,160512,5200,89192,159936,160512
.long 5408,89200,160128,160512,5616,89208,160320,160512
.long 2496,89248,160512,160512,2704,89256,160512,160512
.long 2912,89264,160512,160512,3120,89272,160512,160512
.long 5824,89312,160512,159744,6032,89320,160512,159936
.long 6240,89328,160512,160128,6448,89336,160512,160320
.long 16,89600,159760,160512,224,89608,159952,160512
.long 432,89616,160144,160512,640,89624,160336,160512
.long 3344,89664,160512,160512,3552,89672,160512,160512
.long 3760,89680,160512,160512,3968,89688,160512,160512
.long 848,89728,160512,159760,1056,89736,160512,159952
.long 1264,89744,160512,160144,1472,89752,160512,160336
.long 4176,89792,160512,160512,4384,89800,160512,160512
.long 4592,89808,160512,160512,4800,89816,160512,160512
.long 1680,89632,160512,160512,1888,89640,160512,160512
.long 2096,89648,160512,160512,2304,89656,160512,160512
.long 5008,89696,159760,160512,5216,89704,159952,160512
.long 5424,89712,160144,160512,5632,89720,160336,160512
.long 2512,89760,160512,160512,2720,89768,160512,160512
.long 2928,89776,160512,160512,3136,89784,160512,160512
.long 5840,89824,160512,159760,6048,89832,160512,159952
.long 6256,89840,160512,160144,6464,89848,160512,160336
.long 26624,26640,27008,27024,27040,27056,27424,27440
.long 27456,27472,27840,27856,27872,27888,28256,28272
.long 28304,28288,28688,28672,28720,28704,29104,29088
.long 29136,29120,29520,29504,29552,29536,29936,29920
.long 29952,29968,30336,30352,30368,30384,30752,30768
.long 30784,30800,31168,31184,31200,31216,31584,31600
.long 31632,31616,32016,32000,32048,32032,32432,32416
.long 32464,32448,32848,32832,32880,32864,33264,33248
.long 33280,33296,33664,33680,33696,33712,34080,34096
.long 34112,34128,34496,34512,34528,34544,34912,34928
.long 34960,34944,35344,35328,35376,35360,35760,35744
.long 35792,35776,36176,36160,36208,36192,36592,36576
.long 36608,36624,36992,37008,37024,37040,37408,37424
.long 37440,37456,37824,37840,37856,37872,38240,38256
.long 38288,38272,38672,38656,38704,38688,39088,39072
.long 39120,39104,39504,39488,39536,39520,39920,39904
.long 26656,26672,80256,27028,27072,27088,80672,27444
.long 27488,27504,81088,27860,27904,27920,81504,28276
.long 28336,28320,81936,28676,28752,28736,82352,29092
.long 29168,29152,82768,29508,29584,29568,83184,29924
.long 29984,30000,83584,30356,30400,30416,84000,30772
.long 30816,30832,84416,31188,31232,31248,84832,31604
.long 31664,31648,85264,32004,32080,32064,85680,32420
.long 32496,32480,86096,32836,32912,32896,86512,33252
.long 33312,33328,86912,33684,33728,33744,87328,34100
.long 34144,34160,87744,34516,34560,34576,88160,34932
.long 34992,34976,88592,35332,35408,35392,89008,35748
.long 35824,35808,89424,36164,36240,36224,89840,36580
.long 36640,36656,90240,37012,37056,37072,90656,37428
.long 37472,37488,91072,37844,37888,37904,91488,38260
.long 38320,38304,91920,38660,38736,38720,92336,39076
.long 39152,39136,92752,39492,39568,39552,93168,39908
.long 45504,430464,431424,302400,387264,430848,431808,302784
.long 387648,431232,432192,303168,388032,431616,432576,303552
.long 388416,432000,129024,0x7fffffff,388800,432384,129408,0x7fffffff
.long 389184,86208,129792,0x7fffffff,389568,86592,130176,0x7fffffff
.long 86016,86976,130560,0x7fffffff,86400,87360,130944,0x7fffffff
.long 86784,87744,131328,0x7fffffff,87168,88128,473088,0x7fffffff
.long 87552,88512,473472,0x7fffffff,87936,430272,473856,0x7fffffff
.long 88320,430656,474240,0x7fffffff,430080,431040,474624,0x7fffffff
.long 45520,430480,431440,302416,387280,430864,431824,302800
.long 387664,431248,432208,303184,388048,431632,432592,303568
.long 388432,432016,129040,0x7fffffff,388816,432400,129424,0x7fffffff
.long 389200,86224,129808,0x7fffffff,389584,86608,130192,0x7fffffff
.long 86032,86992,130576,0x7fffffff,86416,87376,130960,0x7fffffff
.long 86800,87760,131344,0x7fffffff,87184,88144,473104,0x7fffffff
.long 87568,88528,473488,0x7fffffff,87952,430288,473872,0x7fffffff
.long 88336,430672,474256,0x7fffffff,430096,431056,474640,0x7fffffff
.long 45536,430496,431456,302432,387296,430880,431840,302816
.long 387680,431264,432224,303200,388064,431648,432608,303584
.long 388448,432032,129056,0x7fffffff,388832,432416,129440,0x7fffffff
.long 389216,86240,129824,0x7fffffff,389600,86624,130208,0x7fffffff
.long 86048,87008,130592,0x7fffffff,86432,87392,130976,0x7fffffff
.long 86816,87776,131360,0x7fffffff,87200,88160,473120,0x7fffffff
.long 87584,88544,473504,0x7fffffff,87968,430304,473888,0x7fffffff
.long 88352,430688,474272,0x7fffffff,430112,431072,474656,0x7fffffff
.long 45552,430512,431472,302448,387312,430896,431856,302832
.long 387696,431280,432240,303216,388080,431664,432624,303600
.long 388464,432048,129072,0x7fffffff,388848,432432,129456,0x7fffffff
.long 389232,86256,129840,0x7fffffff,389616,86640,130224,0x7fffffff
.long 86064,87024,130608,0x7fffffff,86448,87408,130992,0x7fffffff
.long 86832,87792,131376,0x7fffffff,87216,88176,473136,0x7fffffff
.long 87600,88560,473520,0x7fffffff,87984,430320,473904,0x7fffffff
.long 88368,430704,474288,0x7fffffff,430128,431088,474672,0x7fffffff
.long 2048,22528,55296,576,2064,22544,55312,582
.long 2080,22560,55328,588,2096,22576,55344,594
.long 2112,22592,55360,600,2128,22608,55376,606
.long 2144,22624,55392,612,2160,22640,55408,618
.long 2176,22656,55424,624,2192,22672,55440,630
.long 2208,22688,55456,636,2224,22704,55472,66
.long 2240,22720,55488,72,2256,22736,55504,78
.long 2272,22752,55520,84,2288,22768,55536,90
.long 2304,22784,55552,580,2320,22800,55568,586
.long 2336,22816,55584,592,2352,22832,55600,598
.long 2368,22848,55616,604,2384,22864,55632,610
.long 2400,22880,55648,616,2416,22896,55664,622
.long 2432,22912,55680,628,2448,22928,55696,634
.long 2464,22944,55712,64,2480,22960,55728,70
.long 2496,22976,55744,76,2512,22992,55760,82
.long 2528,23008,55776,88,2544,23024,55792,94
.long 2560,23040,55808,578,2576,23056,55824,584
.long 2592,23072,55840,590,2608,23088,55856,596
.long 2624,23104,55872,602,2640,23120,55888,608
.long 2656,23136,55904,614,2672,23152,55920,620
.long 2688,23168,55936,626,2704,23184,55952,632
.long 2720,23200,55968,638,2736,23216,55984,68
.long 2752,23232,56000,74,2768,23248,56016,80
.long 2784,23264,56032,86,2800,23280,56048,92
.long 2816,23296,56064,580,2832,23312,56080,586
.long 2848,23328,56096,592,2864,23344,56112,598
.long 2880,23360,56128,604,2896,23376,56144,610
.long 2912,23392,56160,616,2928,23408,56176,622
.long 2944,23424,56192,628,2960,23440,56208,634
.long 2976,23456,56224,64,2992,23472,56240,70
.long 3008,23488,56256,76,3024,23504,56272,82
.long 3040,23520,56288,88,3056,23536,56304,94
.long 40328,40336,133520,163360,40744,40752,133936,163372
.long 41160,41168,134352,163384,41160,41168,134768,163396
.long 41576,41584,135168,163408,42008,41984,135584,163420
.long 42424,42400,136000,163432,42424,42400,136416,163444
.long 42840,42816,136848,163456,43256,43232,137264,163468
.long 43656,43664,137680,163480,43656,43664,138096,163492
.long 44072,44080,138496,163504,44488,44496,138912,163516
.long 44904,44912,139328,163528,44904,44912,139744,163540
.long 45336,45312,140176,163552,45752,45728,140592,163564
.long 46168,46144,141008,163576,46168,46144,141424,163588
.long 46584,46560,141824,163600,46984,46992,142240,163612
.long 47400,47408,142656,163624,47400,47408,143072,163636
.long 47816,47824,143504,163648,48232,48240,143920,163660
.long 48664,48640,144336,163672,48664,48640,144752,163684
.long 49080,49056,145152,163696,49496,49472,145568,163708
.long 49912,49888,145984,163720,49912,49888,146400,163732
.long 50312,50320,133524,163360,50728,50736,133940,163372
.long 51144,51152,134356,163384,51144,51152,134772,163396
.long 51560,51568,135172,163408,51992,51968,135588,163420
.long 52408,52384,136004,163432,52408,52384,136420,163444
.long 52824,52800,136852,163456,53240,53216,137268,163468
.long 53640,53648,137684,163480,53640,53648,138100,163492
.long 54056,54064,138500,163504,54472,54480,138916,163516
.long 54888,54896,139332,163528,54888,54896,139748,163540
.long 55320,55296,140180,163552,55736,55712,140596,163564
.long 56152,56128,141012,163576,56152,56128,141428,163588
.long 56568,56544,141828,163600,56968,56976,142244,163612
.long 57384,57392,142660,163624,57384,57392,143076,163636
.long 57800,57808,143508,163648,58216,58224,143924,163660
.long 58648,58624,144340,163672,58648,58624,144756,163684
.long 59064,59040,145156,163696,59480,59456,145572,163708
.long 59896,59872,145988,163720,59896,59872,146404,163732
.long 96,13696,0,0,104,13704,8,8
.long 112,13712,16,16,120,13720,24,24
.long 512,14112,192,192,520,14120,200,200
.long 528,14128,208,208,536,14136,216,216
.long 928,14528,384,384,936,14536,392,392
.long 944,14544,400,400,952,14552,408,408
.long 1344,14944,576,576,1352,14952,584,584
.long 1360,14960,592,592,1368,14968,600,600
.long 1776,15376,800,736,1784,15384,808,744
.long 1760,15360,816,752,1768,15368,824,760
.long 2192,15792,992,928,2200,15800,1000,936
.long 2176,15776,1008,944,2184,15784,1016,952
.long 2608,16208,1184,1120,2616,16216,1192,1128
.long 2592,16192,1200,1136,2600,16200,1208,1144
.long 3024,16624,1376,1312,3032,16632,1384,1320
.long 3008,16608,1392,1328,3016,16616,1400,1336
.long 3424,17024,1536,1536,3432,17032,1544,1544
.long 3440,17040,1552,1552,3448,17048,1560,1560
.long 3840,17440,1728,1728,3848,17448,1736,1736
.long 3856,17456,1744,1744,3864,17464,1752,1752
.long 4256,17856,1920,1920,4264,17864,1928,1928
.long 4272,17872,1936,1936,4280,17880,1944,1944
.long 4672,18272,2112,2112,4680,18280,2120,2120
.long 4688,18288,2128,2128,4696,18296,2136,2136
.long 5104,18704,2336,2272,5112,18712,2344,2280
.long 5088,18688,2352,2288,5096,18696,2360,2296
.long 5520,19120,2528,2464,5528,19128,2536,2472
.long 5504,19104,2544,2480,5512,19112,2552,2488
.long 5936,19536,2720,2656,5944,19544,2728,2664
.long 5920,19520,2736,2672,5928,19528,2744,2680
.long 6352,19952,2912,2848,6360,19960,2920,2856
.long 6336,19936,2928,2864,6344,19944,2936,2872
.long 161832,162004,162176,162176,161832,162004,162176,162188
.long 161832,162004,162176,162200,161832,162004,162176,162212
.long 161836,162004,162176,162224,161836,162004,162176,162236
.long 161836,162004,162176,162248,161836,162004,162176,162260
.long 161836,162008,162176,162272,161836,162008,162176,162284
.long 161836,162008,162176,162296,161836,162008,162176,162308
.long 161836,162008,162180,162320,161836,162008,162180,162332
.long 161836,162008,162180,162344,161836,162008,162180,162356
.long 161840,162008,162180,162184,161840,162008,162180,162196
.long 161840,162008,162180,162208,161840,162008,162180,162220
.long 161840,162012,162180,162232,161840,162012,162180,162244
.long 161840,162012,162180,162256,161840,162012,162180,162268
.long 161840,162012,162184,162280,161840,162012,162184,162292
.long 161840,162012,162184,162304,161840,162012,162184,162316
.long 161844,162012,162184,162328,161844,162012,162184,162340
.long 161844,162012,162184,162352,161844,162012,162184,162364
.long 161844,162016,162184,162180,161844,162016,162184,162192
.long 161844,162016,162184,162204,161844,162016,162184,162216
.long 161844,162016,162188,162228,161844,162016,162188,162240
.long 161844,162016,162188,162252,161844,162016,162188,162264
.long 161848,162016,162188,162276,161848,162016,162188,162288
.long 161848,162016,162188,162300,161848,162016,162188,162312
.long 161848,162020,162188,162324,161848,162020,162188,162336
.long 161848,162020,162188,162348,161848,162020,162188,162360
.long 161848,162020,162192,162184,161848,162020,162192,162196
.long 161848,162020,162192,162208,161848,162020,162192,162220
.long 161852,162020,162192,162232,161852,162020,162192,162244
.long 161852,162020,162192,162256,161852,162020,162192,162268
.long 161852,162024,162192,162280,161852,162024,162192,162292
.long 161852,162024,162192,162304,161852,162024,162192,162316
.long 161852,162024,162196,162328,161852,162024,162196,162340
.long 161852,162024,162196,162352,161852,162024,162196,162364
.long 2048,10272,18432,512,2064,10288,18448,528
.long 2080,10240,18464,544,2096,10256,18480,560
.long 2112,10336,18496,576,2128,10352,18512,592
.long 2144,10304,18528,608,2160,10320,18544,624
.long 2176,10400,18560,640,2192,10416,18576,656
.long 2208,10368,18592,672,2224,10384,18608,688
.long 2240,10464,18624,704,2256,10480,18640,720
.long 2272,10432,18656,736,2288,10448,18672,752
.long 2336,10528,18688,2560,2352,10544,18704,2576
.long 2304,10496,18720,2592,2320,10512,18736,2608
.long 2400,10592,18752,2624,2416,10608,18768,2640
.long 2368,10560,18784,2656,2384,10576,18800,2672
.long 2464,10656,18816,2688,2480,10672,18832,2704
.long 2432,10624,18848,2720,2448,10640,18864,2736
.long 2528,10720,18880,2752,2544,10736,18896,2768
.long 2496,10688,18912,2784,2512,10704,18928,2800
.long 2592,10752,18944,4608,2608,10768,18960,4624
.long 2560,10784,18976,4640,2576,10800,18992,4656
.long 2656,10816,19008,4672,2672,10832,19024,4688
.long 2624,10848,19040,4704,2640,10864,19056,4720
.long 2720,10880,19072,4736,2736,10896,19088,4752
.long 2688,10912,19104,4768,2704,10928,19120,4784
.long 2784,10944,19136,4800,2800,10960,19152,4816
.long 2752,10976,19168,4832,2768,10992,19184,4848
.long 2848,11008,19232,6656,2864,11024,19248,6672
.long 2816,11040,19200,6688,2832,11056,19216,6704
.long 2912,11072,19296,6720,2928,11088,19312,6736
.long 2880,11104,19264,6752,2896,11120,19280,6768
.long 2976,11136,19360,6784,2992,11152,19376,6800
.long 2944,11168,19328,6816,2960,11184,19344,6832
.long 3040,11200,19424,6848,3056,11216,19440,6864
.long 3008,11232,19392,6880,3024,11248,19408,6896
.long 16256,0,0,0,0x3f800000,0,0,0
.long 0,16256,0,0,0,0x3f800000,0,0
.long 0,0,16256,0,0,0,0x3f800000,0
.long 0,0,0,16256,0,0,0,0x3f800000
.long 0,0,0,0,0,0,0,0
.long 0,0,0,0,0,0,0,0
.long 0,0,0,0,0,0,0,0
.long 0,0,0,0,0,0,0,0
.long 0,0,0,0,0,0,0,0
.long 0,0,0,0,0,0,0,0
.long 0,0,0,0,0,0,0,0
.long 0,0,0,0,0,0,0,0
.long 16256,0,0,0,0x3f800000,0,0,0
.long 0,16256,0,0,0,0x3f800000,0,0
.long 0,0,16256,0,0,0,0x3f800000,0
.long 0,0,0,16256,0,0,0,0x3f800000
.long 0,0,0,0,0,0,0,0
.long 0,0,0,0,0,0,0,0
.long 0,0,0,0,0,0,0,0
.long 0,0,0,0,0,0,0,0
.long 0,0,0,0,0,0,0,0
.long 0,0,0,0,0,0,0,0
.long 0,0,0,0,0,0,0,0
.long 0,0,0,0,0,0,0,0
.long 0,0,0,0,0,0,0,0
.long 0,0,0,0,0,0,0,0
.long 0,0,0,0,0,0,0,0
.long 0,0,0,0,0,0,0,0
.long 0,0,0,0,0,0,0,0
.long 0,0,0,0,0,0,0,0
.long 0,0,0,0,0,0,0,0
.long 0,0,0,0,0,0,0,0
.long 0,0,0,0,0,0,0,0
.long 0,0,0,0,0,0,0,0
.long 0,0,0,0,0,0,0,0
.long 0,0,0,0,0,0,0,0
.long 0,0,0,0,0,0,0,0
.long 0,0,0,0,0,0,0,0
.long 0,0,0,0,0,0,0,0
.long 0,0,0,0,0,0,0,0
.long 0,0,0,0,0,0,0,0
.long 0,0,0,0,0,0,0,0
.long 0,0,0,0,0,0,0,0
.long 0,0,0,0,0,0,0,0
.long 0,0,0,0,0,0,0,0
.long 0,0,0,0,0,0,0,0
.long 0,0,0,0,0,0,0,0
.long 0,0,0,0,0,0,0,0
.long 16256,0,0,0,0x3f800000,0,0,0
.long 0,16256,0,0,0,0x3f800000,0,0
.long 0,0,16256,0,0,0,0x3f800000,0
.long 0,0,0,16256,0,0,0,0x3f800000
.long 0,0,0,0,0,0,0,0
.long 0,0,0,0,0,0,0,0
.long 0,0,0,0,0,0,0,0
.long 0,0,0,0,0,0,0,0
.long 0,0,0,0,0,0,0,0
.long 0,0,0,0,0,0,0,0
.long 0,0,0,0,0,0,0,0
.long 0,0,0,0,0,0,0,0
.long 16256,0,0,0,0x3f800000,0,0,0
.long 0,16256,0,0,0,0x3f800000,0,0
.long 0,0,16256,0,0,0,0x3f800000,0
.long 0,0,0,16256,0,0,0,0x3f800000
.long 89856,89856,1600,163360,90064,89872,2000,163360
.long 90272,89888,2400,163360,90480,89904,2800,163360
.long 90688,89920,1664,163360,90896,89936,2064,163360
.long 91104,89952,2464,163360,91312,89968,2864,163360
.long 91520,89984,1728,163360,91728,90000,2128,163360
.long 91936,90016,2528,163360,92144,90032,2928,163360
.long 92352,90064,10432,163360,92560,90080,10448,163360
.long 92768,90096,10464,163360,92976,90112,10480,163360
.long 89864,90128,1616,163376,90072,90144,2016,163376
.long 90280,90160,2416,163376,90488,90176,2816,163376
.long 90696,90192,1680,163376,90904,90208,2080,163376
.long 91112,90224,2480,163376,91320,90240,2880,163376
.long 91528,90272,1744,163376,91736,90288,2144,163376
.long 91944,90304,2544,163376,92152,90320,2944,163376
.long 92360,90336,10688,163376,92568,90352,10704,163376
.long 92776,90368,10720,163376,92984,90384,10736,163376
.long 89872,90400,1632,163392,90080,90416,2032,163392
.long 90288,90432,2432,163392,90496,90448,2832,163392
.long 90704,90480,1696,163392,90912,90496,2096,163392
.long 91120,90512,2496,163392,91328,90528,2896,163392
.long 91536,90544,1760,163392,91744,90560,2160,163392
.long 91952,90576,2560,163392,92160,90592,2960,163392
.long 92368,90608,10944,163392,92576,90624,10960,163392
.long 92784,90640,10976,163392,92992,90656,10992,163392
.long 89880,90480,1648,163408,90088,90496,2048,163408
.long 90296,90512,2448,163408,90504,90528,2848,163408
.long 90712,90544,1712,163408,90920,90560,2112,163408
.long 91128,90576,2512,163408,91336,90592,2912,163408
.long 91544,90608,1776,163408,91752,90624,2176,163408
.long 91960,90640,2576,163408,92168,90656,2976,163408
.long 92376,90480,11200,163408,92584,90496,11216,163408
.long 92792,90512,11232,163408,93000,90528,11248,163408
.long 45504,388416,430464,432000,45520,388432,430480,432016
.long 45536,388448,430496,432032,45552,388464,430512,432048
.long 45568,388480,430528,432064,45584,388496,430544,432080
.long 45600,388512,430560,432096,45616,388528,430576,432112
.long 45632,388544,430592,432128,45648,388560,430608,432144
.long 45664,388576,430624,432160,45680,388592,430640,432176
.long 387264,388800,430848,432384,387280,388816,430864,432400
.long 387296,388832,430880,432416,387312,388848,430896,432432
.long 387328,388864,430912,432448,387344,388880,430928,432464
.long 387360,388896,430944,432480,387376,388912,430960,432496
.long 387392,388928,430976,432512,387408,388944,430992,432528
.long 387424,388960,431008,432544,387440,388976,431024,432560
.long 387648,389184,431232,86208,387664,389200,431248,86224
.long 387680,389216,431264,86240,387696,389232,431280,86256
.long 387712,389248,431296,86272,387728,389264,431312,86288
.long 387744,389280,431328,86304,387760,389296,431344,86320
.long 387776,389312,431360,86336,387792,389328,431376,86352
.long 387808,389344,431392,86368,387824,389360,431408,86384
.long 388032,389568,431616,86592,388048,389584,431632,86608
.long 388064,389600,431648,86624,388080,389616,431664,86640
.long 388096,389632,431680,86656,388112,389648,431696,86672
.long 388128,389664,431712,86688,388144,389680,431728,86704
.long 388160,389696,431744,86720,388176,389712,431760,86736
.long 388192,389728,431776,86752,388208,389744,431792,86768
.long 0x7fffffff,0x7fffffff,0x7fffffff,0x7fffffff,0x7fffffff,0x7fffffff,0x7fffffff,0x7fffffff
.long 0x7fffffff,0x7fffffff,0x7fffffff,0x7fffffff,0x7fffffff,0x7fffffff,0x7fffffff,0x7fffffff
.long 0x7fffffff,0x7fffffff,0x7fffffff,0x7fffffff,0x7fffffff,0x7fffffff,0x7fffffff,0x7fffffff
.long 0x7fffffff,0x7fffffff,0x7fffffff,0x7fffffff,0x7fffffff,0x7fffffff,0x7fffffff,0x7fffffff
.long 0x7fffffff,0x7fffffff,0x7fffffff,0x7fffffff,0x7fffffff,0x7fffffff,0x7fffffff,0x7fffffff
.long 0x7fffffff,0x7fffffff,0x7fffffff,0x7fffffff,0x7fffffff,0x7fffffff,0x7fffffff,0x7fffffff
.long 0x7fffffff,0x7fffffff,0x7fffffff,0x7fffffff,0x7fffffff,0x7fffffff,0x7fffffff,0x7fffffff
.long 0x7fffffff,0x7fffffff,0x7fffffff,0x7fffffff,0x7fffffff,0x7fffffff,0x7fffffff,0x7fffffff
.long 431424,129024,302400,0,431440,129040,302416,32
.long 431456,129056,302432,64,431472,129072,302448,96
.long 431488,129088,302464,128,431504,129104,302480,160
.long 431520,129120,302496,192,431536,129136,302512,224
.long 431552,129152,302528,256,431568,129168,302544,288
.long 431584,129184,302560,320,431600,129200,302576,352
.long 431808,129408,302784,400,431824,129424,302800,432
.long 431840,129440,302816,464,431856,129456,302832,496
.long 431872,129472,302848,528,431888,129488,302864,560
.long 431904,129504,302880,592,431920,129520,302896,624
.long 431936,129536,302912,656,431952,129552,302928,688
.long 431968,129568,302944,720,431984,129584,302960,752
.long 432192,129792,303168,800,432208,129808,303184,832
.long 432224,129824,303200,864,432240,129840,303216,896
.long 432256,129856,303232,928,432272,129872,303248,960
.long 432288,129888,303264,992,432304,129904,303280,1024
.long 432320,129920,303296,1056,432336,129936,303312,1088
.long 432352,129952,303328,1120,432368,129968,303344,1152
.long 432576,130176,303552,1200,432592,130192,303568,1232
.long 432608,130208,303584,1264,432624,130224,303600,1296
.long 432640,130240,303616,1328,432656,130256,303632,1360
.long 432672,130272,303648,1392,432688,130288,303664,1424
.long 432704,130304,303680,1456,432720,130320,303696,1488
.long 432736,130336,303712,1520,432752,130352,303728,1552
.long 0x7fffffff,0x7fffffff,0x7fffffff,1200,0x7fffffff,0x7fffffff,0x7fffffff,1232
.long 0x7fffffff,0x7fffffff,0x7fffffff,1264,0x7fffffff,0x7fffffff,0x7fffffff,1296
.long 0x7fffffff,0x7fffffff,0x7fffffff,1328,0x7fffffff,0x7fffffff,0x7fffffff,1360
.long 0x7fffffff,0x7fffffff,0x7fffffff,1392,0x7fffffff,0x7fffffff,0x7fffffff,1424
.long 0x7fffffff,0x7fffffff,0x7fffffff,1456,0x7fffffff,0x7fffffff,0x7fffffff,1488
.long 0x7fffffff,0x7fffffff,0x7fffffff,1520,0x7fffffff,0x7fffffff,0x7fffffff,1552
.long 0x7fffffff,0x7fffffff,0x7fffffff,1200,0x7fffffff,0x7fffffff,0x7fffffff,1232
.long 0x7fffffff,0x7fffffff,0x7fffffff,1264,0x7fffffff,0x7fffffff,0x7fffffff,1296
.long 150552,150552,24,30776,150344,150344,88,30840
.long 149096,160744,152,30904,148888,160536,216,30968
.long 150760,150760,264,31016,150552,150552,328,31080
.long 149304,160952,392,31144,149096,160744,392,31144
.long 152008,152008,30776,61464,151800,151800,30840,61528
.long 150552,150552,30904,61592,150344,150344,30968,61656
.long 152216,152216,31016,61704,152008,152008,31080,61768
.long 150760,150760,31144,61832,150552,150552,31144,61832
.long 150968,150968,88,30840,150760,150760,152,30904
.long 149512,161160,216,30968,149304,160952,264,31016
.long 151176,151176,328,31080,150968,150968,392,31144
.long 149720,161368,456,31208,149512,161160,456,31208
.long 152424,152424,30840,61528,152216,152216,30904,61592
.long 150968,150968,30968,61656,150760,150760,31016,61704
.long 152632,152632,31080,61768,152424,152424,31144,61832
.long 151176,151176,31208,61896,150968,150968,31208,61896
.long 151384,151384,152,30904,151176,151176,216,30968
.long 149928,161576,264,31016,149720,161368,328,31080
.long 151592,151592,392,31144,151384,151384,456,31208
.long 150136,161784,536,31288,149928,161576,536,31288
.long 152840,152840,30904,61592,152632,152632,30968,61656
.long 151384,151384,31016,61704,151176,151176,31080,61768
.long 153048,153048,31144,61832,152840,152840,31208,61896
.long 151592,151592,31288,61976,151384,151384,31288,61976
.long 151800,151800,216,30968,151592,151592,264,31016
.long 150344,161992,328,31080,150136,161784,392,31144
.long 152008,152008,456,31208,151800,151800,536,31288
.long 150552,162200,600,31352,150344,161992,600,31352
.long 153256,153256,30968,61656,153048,153048,31016,61704
.long 151800,151800,31080,61768,151592,151592,31144,61832
.long 153464,153464,31208,61896,153256,153256,31288,61976
.long 152008,152008,31352,62040,151800,151800,31352,62040
.long 0xc0c0100,0xc0c0c0c,0xc0c0302,0xc0c0c0c,0x1000c0c,0xc0c0c0c,0x3020c0c,0xc0c0c0c
.long 0xc0c0c0c,0xc0c0100,0xc0c0c0c,0xc0c0302,0xc0c0c0c,0x1000c0c,0xc0c0c0c,0x3020c0c
.long 0xc0c0c0c,0xc0c0c0c,0xc0c0302,0xc0c0c0c,0xc0c0c0c,0xc0c0c0c,0x3020c0c,0xc0c0c0c
.long 0xc0c0c0c,0xc0c0c0c,0xc0c0c0c,0xc0c0302,0xc0c0c0c,0xc0c0c0c,0xc0c0c0c,0x3020c0c
.long 0xc0c0100,0xc0c0c0c,0xc0c0302,0xc0c0c0c,0x1000c0c,0xc0c0c0c,0x3020c0c,0xc0c0c0c
.long 0xc0c0c0c,0xc0c0100,0xc0c0c0c,0xc0c0302,0xc0c0c0c,0x1000c0c,0xc0c0c0c,0x3020c0c
.long 0xc0c0c0c,0xc0c0c0c,0xc0c0302,0xc0c0c0c,0xc0c0c0c,0xc0c0c0c,0x3020c0c,0xc0c0c0c
.long 0xc0c0c0c,0xc0c0c0c,0xc0c0c0c,0xc0c0302,0xc0c0c0c,0xc0c0c0c,0xc0c0c0c,0x3020c0c
.long 0xc0c0100,0xc0c0c0c,0xc0c0302,0xc0c0c0c,0x1000c0c,0xc0c0c0c,0x3020c0c,0xc0c0c0c
.long 0xc0c0c0c,0xc0c0100,0xc0c0c0c,0xc0c0302,0xc0c0c0c,0x1000c0c,0xc0c0c0c,0x3020c0c
.long 0xc0c0100,0xc0c0c0c,0xc0c0302,0xc0c0c0c,0x1000c0c,0xc0c0c0c,0x3020c0c,0xc0c0c0c
.long 0xc0c0c0c,0xc0c0100,0xc0c0c0c,0xc0c0302,0xc0c0c0c,0x1000c0c,0xc0c0c0c,0x3020c0c
.long 0xc0c0100,0xc0c0c0c,0xc0c0302,0xc0c0c0c,0x1000c0c,0xc0c0c0c,0x3020c0c,0xc0c0c0c
.long 0xc0c0c0c,0xc0c0100,0xc0c0c0c,0xc0c0302,0xc0c0c0c,0x1000c0c,0xc0c0c0c,0x3020c0c
.long 0xc0c0100,0xc0c0c0c,0xc0c0302,0xc0c0c0c,0x1000c0c,0xc0c0c0c,0x3020c0c,0xc0c0c0c
.long 0xc0c0c0c,0xc0c0100,0xc0c0c0c,0xc0c0302,0xc0c0c0c,0x1000c0c,0xc0c0c0c,0x3020c0c
.long 0xc0c0100,0xc0c0c0c,0xc0c0302,0xc0c0c0c,0x1000c0c,0xc0c0c0c,0x3020c0c,0xc0c0c0c
.long 0xc0c0c0c,0xc0c0100,0xc0c0c0c,0xc0c0302,0xc0c0c0c,0x1000c0c,0xc0c0c0c,0x3020c0c
.long 0xc0c0100,0xc0c0c0c,0xc0c0302,0xc0c0c0c,0x1000c0c,0xc0c0c0c,0x3020c0c,0xc0c0c0c
.long 0xc0c0c0c,0xc0c0100,0xc0c0c0c,0xc0c0302,0xc0c0c0c,0x1000c0c,0xc0c0c0c,0x3020c0c
.long 0xc0c0100,0xc0c0c0c,0xc0c0302,0xc0c0c0c,0x1000c0c,0xc0c0c0c,0x3020c0c,0xc0c0c0c
.long 0xc0c0c0c,0xc0c0100,0xc0c0c0c,0xc0c0302,0xc0c0c0c,0x1000c0c,0xc0c0c0c,0x3020c0c
.long 0xc0c0100,0xc0c0c0c,0xc0c0302,0xc0c0c0c,0x1000c0c,0xc0c0c0c,0x3020c0c,0xc0c0c0c
.long 0xc0c0c0c,0xc0c0100,0xc0c0c0c,0xc0c0302,0xc0c0c0c,0x1000c0c,0xc0c0c0c,0x3020c0c
.long 0xc0c0100,0xc0c0c0c,0xc0c0c0c,0xc0c0c0c,0x1000c0c,0xc0c0c0c,0xc0c0c0c,0xc0c0c0c
.long 0xc0c0c0c,0xc0c0100,0xc0c0c0c,0xc0c0c0c,0xc0c0c0c,0x1000c0c,0xc0c0c0c,0xc0c0c0c
.long 0xc0c0100,0xc0c0c0c,0xc0c0302,0xc0c0c0c,0x1000c0c,0xc0c0c0c,0x3020c0c,0xc0c0c0c
.long 0xc0c0c0c,0xc0c0100,0xc0c0c0c,0xc0c0302,0xc0c0c0c,0x1000c0c,0xc0c0c0c,0x3020c0c
.long 0xc0c0100,0xc0c0c0c,0xc0c0c0c,0xc0c0c0c,0x1000c0c,0xc0c0c0c,0xc0c0c0c,0xc0c0c0c
.long 0xc0c0c0c,0xc0c0100,0xc0c0c0c,0xc0c0c0c,0xc0c0c0c,0x1000c0c,0xc0c0c0c,0xc0c0c0c
.long 0xc0c0100,0xc0c0c0c,0xc0c0302,0xc0c0c0c,0x1000c0c,0xc0c0c0c,0x3020c0c,0xc0c0c0c
.long 0xc0c0c0c,0xc0c0100,0xc0c0c0c,0xc0c0302,0xc0c0c0c,0x1000c0c,0xc0c0c0c,0x3020c0c
.long 24,11672,23320,34968,232,11880,23528,35176
.long 440,12088,23736,35384,648,12296,23944,35592
.long 856,12504,24152,35800,1064,12712,24360,36008
.long 1272,12920,24568,36216,160880,160880,160880,160880
.long 1480,13128,24776,160784,1688,13336,24984,160800
.long 1896,13544,25192,160816,2104,13752,25400,160832
.long 2312,13960,25608,160848,2520,14168,25816,160864
.long 2728,14376,26024,160880,160768,160768,160768,160768
.long 2936,14584,26232,36424,3144,14792,26440,36632
.long 3352,15000,26648,36840,3560,15208,26856,37048
.long 3768,15416,27064,37256,3976,15624,27272,37464
.long 4184,15832,27480,37672,160880,160880,160880,160880
.long 4392,16040,27688,160784,4600,16248,27896,160800
.long 4808,16456,28104,160816,5016,16664,28312,160832
.long 5224,16872,28520,160848,5432,17080,28728,160864
.long 5640,17288,28936,160880,160768,160768,160768,160768
.long 5848,17496,29144,37880,6056,17704,29352,38088
.long 6264,17912,29560,38296,6472,18120,29768,38504
.long 6680,18328,29976,38712,6888,18536,30184,38920
.long 7096,18744,30392,39128,160880,160880,160880,160880
.long 7304,18952,30600,160784,7512,19160,30808,160800
.long 7720,19368,31016,160816,7928,19576,31224,160832
.long 8136,19784,31432,160848,8344,19992,31640,160864
.long 8552,20200,31848,160880,160768,160768,160768,160768
.long 8760,20408,32056,39336,8968,20616,32264,39544
.long 9176,20824,32472,39752,9384,21032,32680,159768
.long 9592,21240,32888,159960,9800,21448,33096,160152
.long 10008,21656,33304,160344,160880,160880,160880,160880
.long 10216,21864,33512,160784,10424,22072,33720,160800
.long 10632,22280,33928,160816,10840,22488,34136,160832
.long 11048,22696,34344,160848,11256,22904,34552,160864
.long 11464,23112,34760,160880,160768,160768,160768,160768
.long 0,95232,159744,160512,208,95240,159936,160512
.long 416,95248,160128,160512,624,95256,160320,160512
.long 3328,95296,160512,160512,3536,95304,160512,160512
.long 3744,95312,160512,160512,3952,95320,160512,160512
.long 832,95360,160512,159744,1040,95368,160512,159936
.long 1248,95376,160512,160128,1456,95384,160512,160320
.long 4160,95424,160512,160512,4368,95432,160512,160512
.long 4576,95440,160512,160512,4784,95448,160512,160512
.long 1664,95264,160512,160512,1872,95272,160512,160512
.long 2080,95280,160512,160512,2288,95288,160512,160512
.long 4992,95328,159744,160512,5200,95336,159936,160512
.long 5408,95344,160128,160512,5616,95352,160320,160512
.long 2496,95392,160512,160512,2704,95400,160512,160512
.long 2912,95408,160512,160512,3120,95416,160512,160512
.long 5824,95456,160512,159744,6032,95464,160512,159936
.long 6240,95472,160512,160128,6448,95480,160512,160320
.long 16,95744,159760,160512,224,95752,159952,160512
.long 432,95760,160144,160512,640,95768,160336,160512
.long 3344,95808,160512,160512,3552,95816,160512,160512
.long 3760,95824,160512,160512,3968,95832,160512,160512
.long 848,95872,160512,159760,1056,95880,160512,159952
.long 1264,95888,160512,160144,1472,95896,160512,160336
.long 4176,95936,160512,160512,4384,95944,160512,160512
.long 4592,95952,160512,160512,4800,95960,160512,160512
.long 1680,95776,160512,160512,1888,95784,160512,160512
.long 2096,95792,160512,160512,2304,95800,160512,160512
.long 5008,95840,159760,160512,5216,95848,159952,160512
.long 5424,95856,160144,160512,5632,95864,160336,160512
.long 2512,95904,160512,160512,2720,95912,160512,160512
.long 2928,95920,160512,160512,3136,95928,160512,160512
.long 5840,95968,160512,159760,6048,95976,160512,159952
.long 6256,95984,160512,160144,6464,95992,160512,160336
.long 39936,39952,40320,40336,40352,40368,40736,40752
.long 40768,40784,41152,41168,41184,41200,41568,41584
.long 41616,41600,42000,41984,42032,42016,42416,42400
.long 42448,42432,42832,42816,42864,42848,43248,43232
.long 43264,43280,43648,43664,43680,43696,44064,44080
.long 44096,44112,44480,44496,44512,44528,44896,44912
.long 44944,44928,45328,45312,45360,45344,45744,45728
.long 45776,45760,46160,46144,46192,46176,46576,46560
.long 46592,46608,46976,46992,47008,47024,47392,47408
.long 47424,47440,47808,47824,47840,47856,48224,48240
.long 48272,48256,48656,48640,48688,48672,49072,49056
.long 49104,49088,49488,49472,49520,49504,49904,49888
.long 49920,49936,50304,50320,50336,50352,50720,50736
.long 50752,50768,51136,51152,51168,51184,51552,51568
.long 51600,51584,51984,51968,52016,52000,52400,52384
.long 52432,52416,52816,52800,52848,52832,53232,53216
.long 39968,39984,93568,40340,40384,40400,93984,40756
.long 40800,40816,94400,41172,41216,41232,94816,41588
.long 41648,41632,95248,41988,42064,42048,95664,42404
.long 42480,42464,96080,42820,42896,42880,96496,43236
.long 43296,43312,96896,43668,43712,43728,97312,44084
.long 44128,44144,97728,44500,44544,44560,98144,44916
.long 44976,44960,98576,45316,45392,45376,98992,45732
.long 45808,45792,99408,46148,46224,46208,99824,46564
.long 46624,46640,100224,46996,47040,47056,100640,47412
.long 47456,47472,101056,47828,47872,47888,101472,48244
.long 48304,48288,101904,48644,48720,48704,102320,49060
.long 49136,49120,102736,49476,49552,49536,103152,49892
.long 49952,49968,103552,50324,50368,50384,103968,50740
.long 50784,50800,104384,51156,51200,51216,104800,51572
.long 51632,51616,105232,51972,52048,52032,105648,52388
.long 52464,52448,106064,52804,52880,52864,106480,53220
.long 45600,430560,431520,302496,387360,430944,431904,302880
.long 387744,431328,432288,303264,388128,431712,432672,303648
.long 388512,432096,129120,0x7fffffff,388896,432480,129504,0x7fffffff
.long 389280,86304,129888,0x7fffffff,389664,86688,130272,0x7fffffff
.long 86112,87072,130656,0x7fffffff,86496,87456,131040,0x7fffffff
.long 86880,87840,131424,0x7fffffff,87264,88224,473184,0x7fffffff
.long 87648,88608,473568,0x7fffffff,88032,430368,473952,0x7fffffff
.long 88416,430752,474336,0x7fffffff,430176,431136,474720,0x7fffffff
.long 45616,430576,431536,302512,387376,430960,431920,302896
.long 387760,431344,432304,303280,388144,431728,432688,303664
.long 388528,432112,129136,0x7fffffff,388912,432496,129520,0x7fffffff
.long 389296,86320,129904,0x7fffffff,389680,86704,130288,0x7fffffff
.long 86128,87088,130672,0x7fffffff,86512,87472,131056,0x7fffffff
.long 86896,87856,131440,0x7fffffff,87280,88240,473200,0x7fffffff
.long 87664,88624,473584,0x7fffffff,88048,430384,473968,0x7fffffff
.long 88432,430768,474352,0x7fffffff,430192,431152,474736,0x7fffffff
.long 45632,430592,431552,302528,387392,430976,431936,302912
.long 387776,431360,432320,303296,388160,431744,432704,303680
.long 388544,432128,129152,0x7fffffff,388928,432512,129536,0x7fffffff
.long 389312,86336,129920,0x7fffffff,389696,86720,130304,0x7fffffff
.long 86144,87104,130688,0x7fffffff,86528,87488,131072,0x7fffffff
.long 86912,87872,131456,0x7fffffff,87296,88256,473216,0x7fffffff
.long 87680,88640,473600,0x7fffffff,88064,430400,473984,0x7fffffff
.long 88448,430784,474368,0x7fffffff,430208,431168,474752,0x7fffffff
.long 45648,430608,431568,302544,387408,430992,431952,302928
.long 387792,431376,432336,303312,388176,431760,432720,303696
.long 388560,432144,129168,0x7fffffff,388944,432528,129552,0x7fffffff
.long 389328,86352,129936,0x7fffffff,389712,86736,130320,0x7fffffff
.long 86160,87120,130704,0x7fffffff,86544,87504,131088,0x7fffffff
.long 86928,87888,131472,0x7fffffff,87312,88272,473232,0x7fffffff
.long 87696,88656,473616,0x7fffffff,88080,430416,474000,0x7fffffff
.long 88464,430800,474384,0x7fffffff,430224,431184,474768,0x7fffffff
.long 3072,23552,56320,96,3088,23568,56336,102
.long 3104,23584,56352,108,3120,23600,56368,114
.long 3136,23616,56384,120,3152,23632,56400,126
.long 3168,23648,56416,260,3184,23664,56432,266
.long 3200,23680,56448,272,3216,23696,56464,278
.long 3232,23712,56480,284,3248,23728,56496,290
.long 3264,23744,56512,296,3280,23760,56528,302
.long 3296,23776,56544,308,3312,23792,56560,314
.long 3328,23808,56576,100,3344,23824,56592,106
.long 3360,23840,56608,112,3376,23856,56624,118
.long 3392,23872,56640,124,3408,23888,56656,258
.long 3424,23904,56672,264,3440,23920,56688,270
.long 3456,23936,56704,276,3472,23952,56720,282
.long 3488,23968,56736,288,3504,23984,56752,294
.long 3520,24000,56768,300,3536,24016,56784,306
.long 3552,24032,56800,312,3568,24048,56816,318
.long 3584,24064,56832,98,3600,24080,56848,104
.long 3616,24096,56864,110,3632,24112,56880,116
.long 3648,24128,56896,122,3664,24144,56912,256
.long 3680,24160,56928,262,3696,24176,56944,268
.long 3712,24192,56960,274,3728,24208,56976,280
.long 3744,24224,56992,286,3760,24240,57008,292
.long 3776,24256,57024,298,3792,24272,57040,304
.long 3808,24288,57056,310,3824,24304,57072,316
.long 3840,24320,57088,100,3856,24336,57104,106
.long 3872,24352,57120,112,3888,24368,57136,118
.long 3904,24384,57152,124,3920,24400,57168,258
.long 3936,24416,57184,264,3952,24432,57200,270
.long 3968,24448,57216,276,3984,24464,57232,282
.long 4000,24480,57248,288,4016,24496,57264,294
.long 4032,24512,57280,300,4048,24528,57296,306
.long 4064,24544,57312,312,4080,24560,57328,318
.long 60296,60304,146832,163360,60712,60720,147248,163372
.long 61128,61136,147664,163384,61128,61136,148080,163396
.long 61544,61552,148480,163408,61976,61952,148896,163420
.long 62392,62368,149312,163432,62392,62368,149728,163444
.long 62808,62784,150160,163456,63224,63200,150576,163468
.long 63624,63632,150992,163480,63624,63632,151408,163492
.long 64040,64048,151808,163504,64456,64464,152224,163516
.long 64872,64880,152640,163528,64872,64880,153056,163540
.long 65304,65280,153488,163552,65720,65696,153904,163564
.long 66136,66112,154320,163576,66136,66112,154736,163588
.long 66552,66528,155136,163600,66952,66960,155552,163612
.long 67368,67376,155968,163624,67368,67376,156384,163636
.long 67784,67792,156816,163648,68200,68208,157232,163660
.long 68632,68608,157648,163672,68632,68608,158064,163684
.long 69048,69024,158464,163696,69464,69440,158880,163708
.long 69880,69856,159296,163720,69880,69856,159712,163732
.long 70280,70288,146836,163360,70696,70704,147252,163372
.long 71112,71120,147668,163384,71112,71120,148084,163396
.long 71528,71536,148484,163408,71960,71936,148900,163420
.long 72376,72352,149316,163432,72376,72352,149732,163444
.long 72792,72768,150164,163456,73208,73184,150580,163468
.long 73608,73616,150996,163480,73608,73616,151412,163492
.long 74024,74032,151812,163504,74440,74448,152228,163516
.long 74856,74864,152644,163528,74856,74864,153060,163540
.long 75288,75264,153492,163552,75704,75680,153908,163564
.long 76120,76096,154324,163576,76120,76096,154740,163588
.long 76536,76512,155140,163600,76936,76944,155556,163612
.long 77352,77360,155972,163624,77352,77360,156388,163636
.long 77768,77776,156820,163648,78184,78192,157236,163660
.long 78616,78592,157652,163672,78616,78592,158068,163684
.long 79032,79008,158468,163696,79448,79424,158884,163708
.long 79864,79840,159300,163720,79864,79840,159716,163732
.long 96,13696,96,96,104,13704,104,104
.long 112,13712,112,112,120,13720,120,120
.long 512,14112,288,288,520,14120,296,296
.long 528,14128,304,304,536,14136,312,312
.long 928,14528,480,480,936,14536,488,488
.long 944,14544,496,496,952,14552,504,504
.long 1344,14944,672,672,1352,14952,680,680
.long 1360,14960,688,688,1368,14968,696,696
.long 1776,15376,832,896,1784,15384,840,904
.long 1760,15360,848,912,1768,15368,856,920
.long 2192,15792,1024,1088,2200,15800,1032,1096
.long 2176,15776,1040,1104,2184,15784,1048,1112
.long 2608,16208,1216,1280,2616,16216,1224,1288
.long 2592,16192,1232,1296,2600,16200,1240,1304
.long 3024,16624,1408,1472,3032,16632,1416,1480
.long 3008,16608,1424,1488,3016,16616,1432,1496
.long 3424,17024,1632,1632,3432,17032,1640,1640
.long 3440,17040,1648,1648,3448,17048,1656,1656
.long 3840,17440,1824,1824,3848,17448,1832,1832
.long 3856,17456,1840,1840,3864,17464,1848,1848
.long 4256,17856,2016,2016,4264,17864,2024,2024
.long 4272,17872,2032,2032,4280,17880,2040,2040
.long 4672,18272,2208,2208,4680,18280,2216,2216
.long 4688,18288,2224,2224,4696,18296,2232,2232
.long 5104,18704,2368,2432,5112,18712,2376,2440
.long 5088,18688,2384,2448,5096,18696,2392,2456
.long 5520,19120,2560,2624,5528,19128,2568,2632
.long 5504,19104,2576,2640,5512,19112,2584,2648
.long 5936,19536,2752,2816,5944,19544,2760,2824
.long 5920,19520,2768,2832,5928,19528,2776,2840
.long 6352,19952,2944,3008,6360,19960,2952,3016
.long 6336,19936,2960,3024,6344,19944,2968,3032
.long 161856,162024,162196,162368,161856,162024,162196,162380
.long 161856,162024,162196,162392,161856,162024,162196,162404
.long 161856,162028,162196,162416,161856,162028,162196,162428
.long 161856,162028,162196,162440,161856,162028,162196,162452
.long 161856,162028,162200,162464,161856,162028,162200,162476
.long 161856,162028,162200,162488,161856,162028,162200,162500
.long 161860,162028,162200,162512,161860,162028,162200,162524
.long 161860,162028,162200,162536,161860,162028,162200,162548
.long 161860,162032,162200,162376,161860,162032,162200,162388
.long 161860,162032,162200,162400,161860,162032,162200,162412
.long 161860,162032,162204,162424,161860,162032,162204,162436
.long 161860,162032,162204,162448,161860,162032,162204,162460
.long 161864,162032,162204,162472,161864,162032,162204,162484
.long 161864,162032,162204,162496,161864,162032,162204,162508
.long 161864,162036,162204,162520,161864,162036,162204,162532
.long 161864,162036,162204,162544,161864,162036,162204,162556
.long 161864,162036,162208,162372,161864,162036,162208,162384
.long 161864,162036,162208,162396,161864,162036,162208,162408
.long 161868,162036,162208,162420,161868,162036,162208,162432
.long 161868,162036,162208,162444,161868,162036,162208,162456
.long 161868,162040,162208,162468,161868,162040,162208,162480
.long 161868,162040,162208,162492,161868,162040,162208,162504
.long 161868,162040,162212,162516,161868,162040,162212,162528
.long 161868,162040,162212,162540,161868,162040,162212,162552
.long 161872,162040,162212,162376,161872,162040,162212,162388
.long 161872,162040,162212,162400,161872,162040,162212,162412
.long 161872,162044,162212,162424,161872,162044,162212,162436
.long 161872,162044,162212,162448,161872,162044,162212,162460
.long 161872,162044,162216,162472,161872,162044,162216,162484
.long 161872,162044,162216,162496,161872,162044,162216,162508
.long 161876,162044,162216,162520,161876,162044,162216,162532
.long 161876,162044,162216,162544,161876,162044,162216,162556
.long 3072,11264,19488,768,3088,11280,19504,784
.long 3104,11296,19456,800,3120,11312,19472,816
.long 3136,11328,19552,832,3152,11344,19568,848
.long 3168,11360,19520,864,3184,11376,19536,880
.long 3200,11392,19616,896,3216,11408,19632,912
.long 3232,11424,19584,928,3248,11440,19600,944
.long 3264,11456,19680,960,3280,11472,19696,976
.long 3296,11488,19648,992,3312,11504,19664,1008
.long 3328,11552,19744,2816,3344,11568,19760,2832
.long 3360,11520,19712,2848,3376,11536,19728,2864
.long 3392,11616,19808,2880,3408,11632,19824,2896
.long 3424,11584,19776,2912,3440,11600,19792,2928
.long 3456,11680,19872,2944,3472,11696,19888,2960
.long 3488,11648,19840,2976,3504,11664,19856,2992
.long 3520,11744,19936,3008,3536,11760,19952,3024
.long 3552,11712,19904,3040,3568,11728,19920,3056
.long 3584,11808,19968,4864,3600,11824,19984,4880
.long 3616,11776,20000,4896,3632,11792,20016,4912
.long 3648,11872,20032,4928,3664,11888,20048,4944
.long 3680,11840,20064,4960,3696,11856,20080,4976
.long 3712,11936,20096,4992,3728,11952,20112,5008
.long 3744,11904,20128,5024,3760,11920,20144,5040
.long 3776,12000,20160,5056,3792,12016,20176,5072
.long 3808,11968,20192,5088,3824,11984,20208,5104
.long 3872,12064,20224,6912,3888,12080,20240,6928
.long 3840,12032,20256,6944,3856,12048,20272,6960
.long 3936,12128,20288,6976,3952,12144,20304,6992
.long 3904,12096,20320,7008,3920,12112,20336,7024
.long 4000,12192,20352,7040,4016,12208,20368,7056
.long 3968,12160,20384,7072,3984,12176,20400,7088
.long 4064,12256,20416,7104,4080,12272,20432,7120
.long 4032,12224,20448,7136,4048,12240,20464,7152
.long 16256,0,0,0,0x3f800000,0,0,0
.long 0,16256,0,0,0,0x3f800000,0,0
.long 0,0,16256,0,0,0,0x3f800000,0
.long 0,0,0,16256,0,0,0,0x3f800000
.long 0,0,0,0,0,0,0,0
.long 0,0,0,0,0,0,0,0
.long 0,0,0,0,0,0,0,0
.long 0,0,0,0,0,0,0,0
.long 0,0,0,0,0,0,0,0
.long 0,0,0,0,0,0,0,0
.long 0,0,0,0,0,0,0,0
.long 0,0,0,0,0,0,0,0
.long 16256,0,0,0,0x3f800000,0,0,0
.long 0,16256,0,0,0,0x3f800000,0,0
.long 0,0,16256,0,0,0,0x3f800000,0
.long 0,0,0,16256,0,0,0,0x3f800000
.long 0,0,0,0,0,0,0,0
.long 0,0,0,0,0,0,0,0
.long 0,0,0,0,0,0,0,0
.long 0,0,0,0,0,0,0,0
.long 0,0,0,0,0,0,0,0
.long 0,0,0,0,0,0,0,0
.long 0,0,0,0,0,0,0,0
.long 0,0,0,0,0,0,0,0
.long 0,0,0,0,0,0,0,0
.long 0,0,0,0,0,0,0,0
.long 0,0,0,0,0,0,0,0
.long 0,0,0,0,0,0,0,0
.long 0,0,0,0,0,0,0,0
.long 0,0,0,0,0,0,0,0
.long 0,0,0,0,0,0,0,0
.long 0,0,0,0,0,0,0,0
.long 0,0,0,0,0,0,0,0
.long 0,0,0,0,0,0,0,0
.long 0,0,0,0,0,0,0,0
.long 0,0,0,0,0,0,0,0
.long 0,0,0,0,0,0,0,0
.long 0,0,0,0,0,0,0,0
.long 0,0,0,0,0,0,0,0
.long 0,0,0,0,0,0,0,0
.long 0,0,0,0,0,0,0,0
.long 0,0,0,0,0,0,0,0
.long 0,0,0,0,0,0,0,0
.long 0,0,0,0,0,0,0,0
.long 0,0,0,0,0,0,0,0
.long 0,0,0,0,0,0,0,0
.long 0,0,0,0,0,0,0,0
.long 0,0,0,0,0,0,0,0
.long 16256,0,0,0,0x3f800000,0,0,0
.long 0,16256,0,0,0,0x3f800000,0,0
.long 0,0,16256,0,0,0,0x3f800000,0
.long 0,0,0,16256,0,0,0,0x3f800000
.long 0,0,0,0,0,0,0,0
.long 0,0,0,0,0,0,0,0
.long 0,0,0,0,0,0,0,0
.long 0,0,0,0,0,0,0,0
.long 0,0,0,0,0,0,0,0
.long 0,0,0,0,0,0,0,0
.long 0,0,0,0,0,0,0,0
.long 0,0,0,0,0,0,0,0
.long 16256,0,0,0,0x3f800000,0,0,0
.long 0,16256,0,0,0,0x3f800000,0,0
.long 0,0,16256,0,0,0,0x3f800000,0
.long 0,0,0,16256,0,0,0,0x3f800000
.long 89952,91520,1792,163552,90160,91536,2192,163552
.long 90368,91552,2592,163552,90576,91568,2992,163552
.long 90784,91584,1856,163552,90992,91600,2256,163552
.long 91200,91616,2656,163552,91408,91632,3056,163552
.long 91616,91648,1920,163552,91824,91664,2320,163552
.long 92032,91680,2720,163552,92240,91696,3120,163552
.long 92448,91728,11456,163552,92656,91744,11472,163552
.long 92864,91760,11488,163552,93072,91776,11504,163552
.long 89960,91792,1808,163568,90168,91808,2208,163568
.long 90376,91824,2608,163568,90584,91840,3008,163568
.long 90792,91856,1872,163568,91000,91872,2272,163568
.long 91208,91888,2672,163568,91416,91904,3072,163568
.long 91624,91936,1936,163568,91832,91952,2336,163568
.long 92040,91968,2736,163568,92248,91984,3136,163568
.long 92456,92000,11712,163568,92664,92016,11728,163568
.long 92872,92032,11744,163568,93080,92048,11760,163568
.long 89968,92064,1824,163584,90176,92080,2224,163584
.long 90384,92096,2624,163584,90592,92112,3024,163584
.long 90800,92144,1888,163584,91008,92160,2288,163584
.long 91216,92176,2688,163584,91424,92192,3088,163584
.long 91632,92208,1952,163584,91840,92224,2352,163584
.long 92048,92240,2752,163584,92256,92256,3152,163584
.long 92464,92272,11968,163584,92672,92288,11984,163584
.long 92880,92304,12000,163584,93088,92320,12016,163584
.long 89976,92144,1840,163600,90184,92160,2240,163600
.long 90392,92176,2640,163600,90600,92192,3040,163600
.long 90808,92208,1904,163600,91016,92224,2304,163600
.long 91224,92240,2704,163600,91432,92256,3104,163600
.long 91640,92272,1968,163600,91848,92288,2368,163600
.long 92056,92304,2768,163600,92264,92320,3168,163600
.long 92472,92144,12224,163600,92680,92160,12240,163600
.long 92888,92176,12256,163600,93096,92192,12272,163600
.long 86016,87552,86976,88512,86032,87568,86992,88528
.long 86048,87584,87008,88544,86064,87600,87024,88560
.long 86080,87616,87040,88576,86096,87632,87056,88592
.long 86112,87648,87072,88608,86128,87664,87088,88624
.long 86144,87680,87104,88640,86160,87696,87120,88656
.long 86176,87712,87136,88672,86192,87728,87152,88688
.long 86400,87936,87360,430272,86416,87952,87376,430288
.long 86432,87968,87392,430304,86448,87984,87408,430320
.long 86464,88000,87424,430336,86480,88016,87440,430352
.long 86496,88032,87456,430368,86512,88048,87472,430384
.long 86528,88064,87488,430400,86544,88080,87504,430416
.long 86560,88096,87520,430432,86576,88112,87536,430448
.long 86784,88320,87744,430656,86800,88336,87760,430672
.long 86816,88352,87776,430688,86832,88368,87792,430704
.long 86848,88384,87808,430720,86864,88400,87824,430736
.long 86880,88416,87840,430752,86896,88432,87856,430768
.long 86912,88448,87872,430784,86928,88464,87888,430800
.long 86944,88480,87904,430816,86960,88496,87920,430832
.long 87168,430080,88128,431040,87184,430096,88144,431056
.long 87200,430112,88160,431072,87216,430128,88176,431088
.long 87232,430144,88192,431104,87248,430160,88208,431120
.long 87264,430176,88224,431136,87280,430192,88240,431152
.long 87296,430208,88256,431168,87312,430224,88272,431184
.long 87328,430240,88288,431200,87344,430256,88304,431216
.long 0x7fffffff,0x7fffffff,0x7fffffff,0x7fffffff,0x7fffffff,0x7fffffff,0x7fffffff,0x7fffffff
.long 0x7fffffff,0x7fffffff,0x7fffffff,0x7fffffff,0x7fffffff,0x7fffffff,0x7fffffff,0x7fffffff
.long 0x7fffffff,0x7fffffff,0x7fffffff,0x7fffffff,0x7fffffff,0x7fffffff,0x7fffffff,0x7fffffff
.long 0x7fffffff,0x7fffffff,0x7fffffff,0x7fffffff,0x7fffffff,0x7fffffff,0x7fffffff,0x7fffffff
.long 0x7fffffff,0x7fffffff,0x7fffffff,0x7fffffff,0x7fffffff,0x7fffffff,0x7fffffff,0x7fffffff
.long 0x7fffffff,0x7fffffff,0x7fffffff,0x7fffffff,0x7fffffff,0x7fffffff,0x7fffffff,0x7fffffff
.long 0x7fffffff,0x7fffffff,0x7fffffff,0x7fffffff,0x7fffffff,0x7fffffff,0x7fffffff,0x7fffffff
.long 0x7fffffff,0x7fffffff,0x7fffffff,0x7fffffff,0x7fffffff,0x7fffffff,0x7fffffff,0x7fffffff
.long 130560,473472,302400,0,130576,473488,302416,32
.long 130592,473504,302432,64,130608,473520,302448,96
.long 130624,473536,302464,128,130640,473552,302480,160
.long 130656,473568,302496,192,130672,473584,302512,224
.long 130688,473600,302528,256,130704,473616,302544,288
.long 130720,473632,302560,320,130736,473648,302576,352
.long 130944,473856,302784,400,130960,473872,302800,432
.long 130976,473888,302816,464,130992,473904,302832,496
.long 131008,473920,302848,528,131024,473936,302864,560
.long 131040,473952,302880,592,131056,473968,302896,624
.long 131072,473984,302912,656,131088,474000,302928,688
.long 131104,474016,302944,720,131120,474032,302960,752
.long 131328,474240,303168,800,131344,474256,303184,832
.long 131360,474272,303200,864,131376,474288,303216,896
.long 131392,474304,303232,928,131408,474320,303248,960
.long 131424,474336,303264,992,131440,474352,303280,1024
.long 131456,474368,303296,1056,131472,474384,303312,1088
.long 131488,474400,303328,1120,131504,474416,303344,1152
.long 473088,474624,303552,1200,473104,474640,303568,1232
.long 473120,474656,303584,1264,473136,474672,303600,1296
.long 473152,474688,303616,1328,473168,474704,303632,1360
.long 473184,474720,303648,1392,473200,474736,303664,1424
.long 473216,474752,303680,1456,473232,474768,303696,1488
.long 473248,474784,303712,1520,473264,474800,303728,1552
.long 0x7fffffff,0x7fffffff,0x7fffffff,1200,0x7fffffff,0x7fffffff,0x7fffffff,1232
.long 0x7fffffff,0x7fffffff,0x7fffffff,1264,0x7fffffff,0x7fffffff,0x7fffffff,1296
.long 0x7fffffff,0x7fffffff,0x7fffffff,1328,0x7fffffff,0x7fffffff,0x7fffffff,1360
.long 0x7fffffff,0x7fffffff,0x7fffffff,1392,0x7fffffff,0x7fffffff,0x7fffffff,1424
.long 0x7fffffff,0x7fffffff,0x7fffffff,1456,0x7fffffff,0x7fffffff,0x7fffffff,1488
.long 0x7fffffff,0x7fffffff,0x7fffffff,1520,0x7fffffff,0x7fffffff,0x7fffffff,1552
.long 0x7fffffff,0x7fffffff,0x7fffffff,1200,0x7fffffff,0x7fffffff,0x7fffffff,1232
.long 0x7fffffff,0x7fffffff,0x7fffffff,1264,0x7fffffff,0x7fffffff,0x7fffffff,1296
.long 150560,150560,32,30720,150352,150352,96,30784
.long 149104,160752,160,30848,148896,160544,224,30912
.long 150768,150768,304,30992,150560,150560,368,31056
.long 149312,160960,432,31120,149104,160752,432,31120
.long 152016,152016,30720,61472,151808,151808,30784,61536
.long 150560,150560,30848,61600,150352,150352,30912,61664
.long 152224,152224,30992,61744,152016,152016,31056,61808
.long 150768,150768,31120,61872,150560,150560,31120,61872
.long 150976,150976,96,30784,150768,150768,160,30848
.long 149520,161168,224,30912,149312,160960,304,30992
.long 151184,151184,368,31056,150976,150976,432,31120
.long 149728,161376,496,31184,149520,161168,496,31184
.long 152432,152432,30784,61536,152224,152224,30848,61600
.long 150976,150976,30912,61664,150768,150768,30992,61744
.long 152640,152640,31056,61808,152432,152432,31120,61872
.long 151184,151184,31184,61936,150976,150976,31184,61936
.long 151392,151392,160,30848,151184,151184,224,30912
.long 149936,161584,304,30992,149728,161376,368,31056
.long 151600,151600,432,31120,151392,151392,496,31184
.long 150144,161792,544,31232,149936,161584,544,31232
.long 152848,152848,30848,61600,152640,152640,30912,61664
.long 151392,151392,30992,61744,151184,151184,31056,61808
.long 153056,153056,31120,61872,152848,152848,31184,61936
.long 151600,151600,31232,61984,151392,151392,31232,61984
.long 151808,151808,224,30912,151600,151600,304,30992
.long 150352,162000,368,31056,150144,161792,432,31120
.long 152016,152016,496,31184,151808,151808,544,31232
.long 150560,162208,608,31296,150352,162000,608,31296
.long 153264,153264,30912,61664,153056,153056,30992,61744
.long 151808,151808,31056,61808,151600,151600,31120,61872
.long 153472,153472,31184,61936,153264,153264,31232,61984
.long 152016,152016,31296,62048,151808,151808,31296,62048
.long 0xc0c0100,0xc0c0c0c,0xc0c0302,0xc0c0c0c,0x1000c0c,0xc0c0c0c,0x3020c0c,0xc0c0c0c
.long 0xc0c0c0c,0xc0c0100,0xc0c0c0c,0xc0c0302,0xc0c0c0c,0x1000c0c,0xc0c0c0c,0x3020c0c
.long 0xc0c0c0c,0xc0c0c0c,0xc0c0302,0xc0c0c0c,0xc0c0c0c,0xc0c0c0c,0x3020c0c,0xc0c0c0c
.long 0xc0c0c0c,0xc0c0c0c,0xc0c0c0c,0xc0c0302,0xc0c0c0c,0xc0c0c0c,0xc0c0c0c,0x3020c0c
.long 0xc0c0100,0xc0c0c0c,0xc0c0302,0xc0c0c0c,0x1000c0c,0xc0c0c0c,0x3020c0c,0xc0c0c0c
.long 0xc0c0c0c,0xc0c0100,0xc0c0c0c,0xc0c0302,0xc0c0c0c,0x1000c0c,0xc0c0c0c,0x3020c0c
.long 0xc0c0c0c,0xc0c0c0c,0xc0c0302,0xc0c0c0c,0xc0c0c0c,0xc0c0c0c,0x3020c0c,0xc0c0c0c
.long 0xc0c0c0c,0xc0c0c0c,0xc0c0c0c,0xc0c0302,0xc0c0c0c,0xc0c0c0c,0xc0c0c0c,0x3020c0c
.long 0xc0c0100,0xc0c0c0c,0xc0c0302,0xc0c0c0c,0x1000c0c,0xc0c0c0c,0x3020c0c,0xc0c0c0c
.long 0xc0c0c0c,0xc0c0100,0xc0c0c0c,0xc0c0302,0xc0c0c0c,0x1000c0c,0xc0c0c0c,0x3020c0c
.long 0xc0c0100,0xc0c0c0c,0xc0c0302,0xc0c0c0c,0x1000c0c,0xc0c0c0c,0x3020c0c,0xc0c0c0c
.long 0xc0c0c0c,0xc0c0100,0xc0c0c0c,0xc0c0302,0xc0c0c0c,0x1000c0c,0xc0c0c0c,0x3020c0c
.long 0xc0c0100,0xc0c0c0c,0xc0c0302,0xc0c0c0c,0x1000c0c,0xc0c0c0c,0x3020c0c,0xc0c0c0c
.long 0xc0c0c0c,0xc0c0100,0xc0c0c0c,0xc0c0302,0xc0c0c0c,0x1000c0c,0xc0c0c0c,0x3020c0c
.long 0xc0c0100,0xc0c0c0c,0xc0c0302,0xc0c0c0c,0x1000c0c,0xc0c0c0c,0x3020c0c,0xc0c0c0c
.long 0xc0c0c0c,0xc0c0100,0xc0c0c0c,0xc0c0302,0xc0c0c0c,0x1000c0c,0xc0c0c0c,0x3020c0c
.long 0xc0c0100,0xc0c0c0c,0xc0c0302,0xc0c0c0c,0x1000c0c,0xc0c0c0c,0x3020c0c,0xc0c0c0c
.long 0xc0c0c0c,0xc0c0100,0xc0c0c0c,0xc0c0302,0xc0c0c0c,0x1000c0c,0xc0c0c0c,0x3020c0c
.long 0xc0c0100,0xc0c0c0c,0xc0c0302,0xc0c0c0c,0x1000c0c,0xc0c0c0c,0x3020c0c,0xc0c0c0c
.long 0xc0c0c0c,0xc0c0100,0xc0c0c0c,0xc0c0302,0xc0c0c0c,0x1000c0c,0xc0c0c0c,0x3020c0c
.long 0xc0c0100,0xc0c0c0c,0xc0c0302,0xc0c0c0c,0x1000c0c,0xc0c0c0c,0x3020c0c,0xc0c0c0c
.long 0xc0c0c0c,0xc0c0100,0xc0c0c0c,0xc0c0302,0xc0c0c0c,0x1000c0c,0xc0c0c0c,0x3020c0c
.long 0xc0c0100,0xc0c0c0c,0xc0c0302,0xc0c0c0c,0x1000c0c,0xc0c0c0c,0x3020c0c,0xc0c0c0c
.long 0xc0c0c0c,0xc0c0100,0xc0c0c0c,0xc0c0302,0xc0c0c0c,0x1000c0c,0xc0c0c0c,0x3020c0c
.long 0xc0c0100,0xc0c0c0c,0xc0c0c0c,0xc0c0c0c,0x1000c0c,0xc0c0c0c,0xc0c0c0c,0xc0c0c0c
.long 0xc0c0c0c,0xc0c0100,0xc0c0c0c,0xc0c0c0c,0xc0c0c0c,0x1000c0c,0xc0c0c0c,0xc0c0c0c
.long 0xc0c0100,0xc0c0c0c,0xc0c0302,0xc0c0c0c,0x1000c0c,0xc0c0c0c,0x3020c0c,0xc0c0c0c
.long 0xc0c0c0c,0xc0c0100,0xc0c0c0c,0xc0c0302,0xc0c0c0c,0x1000c0c,0xc0c0c0c,0x3020c0c
.long 0xc0c0100,0xc0c0c0c,0xc0c0c0c,0xc0c0c0c,0x1000c0c,0xc0c0c0c,0xc0c0c0c,0xc0c0c0c
.long 0xc0c0c0c,0xc0c0100,0xc0c0c0c,0xc0c0c0c,0xc0c0c0c,0x1000c0c,0xc0c0c0c,0xc0c0c0c
.long 0xc0c0100,0xc0c0c0c,0xc0c0302,0xc0c0c0c,0x1000c0c,0xc0c0c0c,0x3020c0c,0xc0c0c0c
.long 0xc0c0c0c,0xc0c0100,0xc0c0c0c,0xc0c0302,0xc0c0c0c,0x1000c0c,0xc0c0c0c,0x3020c0c
.long 32,11680,23328,34976,240,11888,23536,35184
.long 448,12096,23744,35392,656,12304,23952,35600
.long 864,12512,24160,35808,1072,12720,24368,36016
.long 1280,12928,24576,36224,160888,160888,160888,160888
.long 1488,13136,24784,160792,1696,13344,24992,160808
.long 1904,13552,25200,160824,2112,13760,25408,160840
.long 2320,13968,25616,160856,2528,14176,25824,160872
.long 2736,14384,26032,160888,160776,160776,160776,160776
.long 2944,14592,26240,36432,3152,14800,26448,36640
.long 3360,15008,26656,36848,3568,15216,26864,37056
.long 3776,15424,27072,37264,3984,15632,27280,37472
.long 4192,15840,27488,37680,160888,160888,160888,160888
.long 4400,16048,27696,160792,4608,16256,27904,160808
.long 4816,16464,28112,160824,5024,16672,28320,160840
.long 5232,16880,28528,160856,5440,17088,28736,160872
.long 5648,17296,28944,160888,160776,160776,160776,160776
.long 5856,17504,29152,37888,6064,17712,29360,38096
.long 6272,17920,29568,38304,6480,18128,29776,38512
.long 6688,18336,29984,38720,6896,18544,30192,38928
.long 7104,18752,30400,39136,160888,160888,160888,160888
.long 7312,18960,30608,160792,7520,19168,30816,160808
.long 7728,19376,31024,160824,7936,19584,31232,160840
.long 8144,19792,31440,160856,8352,20000,31648,160872
.long 8560,20208,31856,160888,160776,160776,160776,160776
.long 8768,20416,32064,39344,8976,20624,32272,39552
.long 9184,20832,32480,39760,9392,21040,32688,159776
.long 9600,21248,32896,159968,9808,21456,33104,160160
.long 10016,21664,33312,160352,160888,160888,160888,160888
.long 10224,21872,33520,160792,10432,22080,33728,160808
.long 10640,22288,33936,160824,10848,22496,34144,160840
.long 11056,22704,34352,160856,11264,22912,34560,160872
.long 11472,23120,34768,160888,160776,160776,160776,160776
.long 6656,76800,159744,160512,6864,76808,159936,160512
.long 7072,76816,160128,160512,7280,76824,160320,160512
.long 9984,76864,160512,160512,10192,76872,160512,160512
.long 10400,76880,160512,160512,10608,76888,160512,160512
.long 7488,76928,160512,159744,7696,76936,160512,159936
.long 7904,76944,160512,160128,8112,76952,160512,160320
.long 10816,76992,160512,160512,11024,77000,160512,160512
.long 11232,77008,160512,160512,11440,77016,160512,160512
.long 8320,76832,160512,160512,8528,76840,160512,160512
.long 8736,76848,160512,160512,8944,76856,160512,160512
.long 11648,76896,159744,160512,11856,76904,159936,160512
.long 12064,76912,160128,160512,12272,76920,160320,160512
.long 9152,76960,160512,160512,9360,76968,160512,160512
.long 9568,76976,160512,160512,9776,76984,160512,160512
.long 12480,77024,160512,159744,12688,77032,160512,159936
.long 12896,77040,160512,160128,13104,77048,160512,160320
.long 6672,77312,159760,160512,6880,77320,159952,160512
.long 7088,77328,160144,160512,7296,77336,160336,160512
.long 10000,77376,160512,160512,10208,77384,160512,160512
.long 10416,77392,160512,160512,10624,77400,160512,160512
.long 7504,77440,160512,159760,7712,77448,160512,159952
.long 7920,77456,160512,160144,8128,77464,160512,160336
.long 10832,77504,160512,160512,11040,77512,160512,160512
.long 11248,77520,160512,160512,11456,77528,160512,160512
.long 8336,77344,160512,160512,8544,77352,160512,160512
.long 8752,77360,160512,160512,8960,77368,160512,160512
.long 11664,77408,159760,160512,11872,77416,159952,160512
.long 12080,77424,160144,160512,12288,77432,160336,160512
.long 9168,77472,160512,160512,9376,77480,160512,160512
.long 9584,77488,160512,160512,9792,77496,160512,160512
.long 12496,77536,160512,159760,12704,77544,160512,159952
.long 12912,77552,160512,160144,13120,77560,160512,160336
.long 64,80,106880,408,480,496,107296,824
.long 896,912,107712,1240,1312,1328,108128,1656
.long 1744,1728,108560,2056,2160,2144,108976,2472
.long 2576,2560,109392,2888,2992,2976,109808,3304
.long 3392,3408,110208,3736,3808,3824,110624,4152
.long 4224,4240,111040,4568,4640,4656,111456,4984
.long 5072,5056,111888,5384,5488,5472,112304,5800
.long 5904,5888,112720,6216,6320,6304,113136,6632
.long 6720,6736,113536,7064,7136,7152,113952,7480
.long 7552,7568,114368,7896,7968,7984,114784,8312
.long 8400,8384,115216,8712,8816,8800,115632,9128
.long 9232,9216,116048,9544,9648,9632,116464,9960
.long 10048,10064,116864,10392,10464,10480,117280,10808
.long 10880,10896,117696,11224,11296,11312,118112,11640
.long 11728,11712,118544,12040,12144,12128,118960,12456
.long 12560,12544,119376,12872,12976,12960,119792,13288
.long 96,112,160128,412,512,528,160544,828
.long 928,944,160960,1244,1344,1360,161376,1660
.long 1776,1760,161808,2060,2192,2176,162224,2476
.long 2608,2592,162640,2892,3024,3008,163056,3308
.long 3424,3440,163456,3740,3840,3856,163872,4156
.long 4256,4272,164288,4572,4672,4688,164704,4988
.long 5104,5088,165136,5388,5520,5504,165552,5804
.long 5936,5920,165968,6220,6352,6336,166384,6636
.long 6752,6768,166784,7068,7168,7184,167200,7484
.long 7584,7600,167616,7900,8000,8016,168032,8316
.long 8432,8416,168464,8716,8848,8832,168880,9132
.long 9264,9248,169296,9548,9680,9664,169712,9964
.long 10080,10096,170112,10396,10496,10512,170528,10812
.long 10912,10928,170944,11228,11328,11344,171360,11644
.long 11760,11744,171792,12044,12176,12160,172208,12460
.long 12592,12576,172624,12876,13008,12992,173040,13292
.long 475008,172032,172992,302400,475392,172416,173376,302784
.long 129216,172800,173760,303168,129600,173184,174144,303552
.long 129984,173568,174528,0x7fffffff,130368,173952,516288,0x7fffffff
.long 130752,174336,516672,0x7fffffff,131136,516096,517056,0x7fffffff
.long 131520,516480,517440,0x7fffffff,473280,516864,517824,0x7fffffff
.long 473664,517248,518208,0x7fffffff,474048,517632,518592,0x7fffffff
.long 474432,518016,215040,0x7fffffff,474816,518400,215424,0x7fffffff
.long 475200,172224,215808,0x7fffffff,475584,172608,216192,0x7fffffff
.long 475024,172048,173008,302416,475408,172432,173392,302800
.long 129232,172816,173776,303184,129616,173200,174160,303568
.long 130000,173584,174544,0x7fffffff,130384,173968,516304,0x7fffffff
.long 130768,174352,516688,0x7fffffff,131152,516112,517072,0x7fffffff
.long 131536,516496,517456,0x7fffffff,473296,516880,517840,0x7fffffff
.long 473680,517264,518224,0x7fffffff,474064,517648,518608,0x7fffffff
.long 474448,518032,215056,0x7fffffff,474832,518416,215440,0x7fffffff
.long 475216,172240,215824,0x7fffffff,475600,172624,216208,0x7fffffff
.long 475040,172064,173024,302432,475424,172448,173408,302816
.long 129248,172832,173792,303200,129632,173216,174176,303584
.long 130016,173600,174560,0x7fffffff,130400,173984,516320,0x7fffffff
.long 130784,174368,516704,0x7fffffff,131168,516128,517088,0x7fffffff
.long 131552,516512,517472,0x7fffffff,473312,516896,517856,0x7fffffff
.long 473696,517280,518240,0x7fffffff,474080,517664,518624,0x7fffffff
.long 474464,518048,215072,0x7fffffff,474848,518432,215456,0x7fffffff
.long 475232,172256,215840,0x7fffffff,475616,172640,216224,0x7fffffff
.long 475056,172080,173040,302448,475440,172464,173424,302832
.long 129264,172848,173808,303216,129648,173232,174192,303600
.long 130032,173616,174576,0x7fffffff,130416,174000,516336,0x7fffffff
.long 130800,174384,516720,0x7fffffff,131184,516144,517104,0x7fffffff
.long 131568,516528,517488,0x7fffffff,473328,516912,517872,0x7fffffff
.long 473712,517296,518256,0x7fffffff,474096,517680,518640,0x7fffffff
.long 474480,518064,215088,0x7fffffff,474864,518448,215472,0x7fffffff
.long 475248,172272,215856,0x7fffffff,475632,172656,216240,0x7fffffff
.long 4096,36864,57344,448,4112,36880,57360,454
.long 4128,36896,57376,460,4144,36912,57392,466
.long 4160,36928,57408,472,4176,36944,57424,478
.long 4192,36960,57440,484,4208,36976,57456,490
.long 4224,36992,57472,496,4240,37008,57488,502
.long 4256,37024,57504,508,4272,37040,57520,642
.long 4288,37056,57536,648,4304,37072,57552,654
.long 4320,37088,57568,660,4336,37104,57584,666
.long 4352,37120,57600,452,4368,37136,57616,458
.long 4384,37152,57632,464,4400,37168,57648,470
.long 4416,37184,57664,476,4432,37200,57680,482
.long 4448,37216,57696,488,4464,37232,57712,494
.long 4480,37248,57728,500,4496,37264,57744,506
.long 4512,37280,57760,640,4528,37296,57776,646
.long 4544,37312,57792,652,4560,37328,57808,658
.long 4576,37344,57824,664,4592,37360,57840,670
.long 4608,37376,57856,450,4624,37392,57872,456
.long 4640,37408,57888,462,4656,37424,57904,468
.long 4672,37440,57920,474,4688,37456,57936,480
.long 4704,37472,57952,486,4720,37488,57968,492
.long 4736,37504,57984,498,4752,37520,58000,504
.long 4768,37536,58016,510,4784,37552,58032,644
.long 4800,37568,58048,650,4816,37584,58064,656
.long 4832,37600,58080,662,4848,37616,58096,668
.long 4864,37632,58112,452,4880,37648,58128,458
.long 4896,37664,58144,464,4912,37680,58160,470
.long 4928,37696,58176,476,4944,37712,58192,482
.long 4960,37728,58208,488,4976,37744,58224,494
.long 4992,37760,58240,500,5008,37776,58256,506
.long 5024,37792,58272,640,5040,37808,58288,646
.long 5056,37824,58304,652,5072,37840,58320,658
.long 5088,37856,58336,664,5104,37872,58352,670
.long 80264,80272,106904,163360,80680,80688,107320,163372
.long 81096,81104,107736,163384,81096,81104,108152,163396
.long 81512,81520,108552,163408,81944,81920,108968,163420
.long 82360,82336,109384,163432,82360,82336,109800,163444
.long 82776,82752,110232,163456,83192,83168,110648,163468
.long 83592,83600,111064,163480,83592,83600,111480,163492
.long 84008,84016,111880,163504,84424,84432,112296,163516
.long 84840,84848,112712,163528,84840,84848,113128,163540
.long 85272,85248,113560,163552,85688,85664,113976,163564
.long 86104,86080,114392,163576,86104,86080,114808,163588
.long 86520,86496,115208,163600,86920,86928,115624,163612
.long 87336,87344,116040,163624,87336,87344,116456,163636
.long 87752,87760,116888,163648,88168,88176,117304,163660
.long 88600,88576,117720,163672,88600,88576,118136,163684
.long 89016,88992,118536,163696,89432,89408,118952,163708
.long 89848,89824,119368,163720,89848,89824,119784,163732
.long 90248,90256,106908,163360,90664,90672,107324,163372
.long 91080,91088,107740,163384,91080,91088,108156,163396
.long 91496,91504,108556,163408,91928,91904,108972,163420
.long 92344,92320,109388,163432,92344,92320,109804,163444
.long 92760,92736,110236,163456,93176,93152,110652,163468
.long 93576,93584,111068,163480,93576,93584,111484,163492
.long 93992,94000,111884,163504,94408,94416,112300,163516
.long 94824,94832,112716,163528,94824,94832,113132,163540
.long 95256,95232,113564,163552,95672,95648,113980,163564
.long 96088,96064,114396,163576,96088,96064,114812,163588
.long 96504,96480,115212,163600,96904,96912,115628,163612
.long 97320,97328,116044,163624,97320,97328,116460,163636
.long 97736,97744,116892,163648,98152,98160,117308,163660
.long 98584,98560,117724,163672,98584,98560,118140,163684
.long 99000,98976,118540,163696,99416,99392,118956,163708
.long 99832,99808,119372,163720,99832,99808,119788,163732
.long 192,27008,0,0,200,27016,8,8
.long 208,27024,16,16,216,27032,24,24
.long 608,27424,192,192,616,27432,200,200
.long 624,27440,208,208,632,27448,216,216
.long 1024,27840,384,384,1032,27848,392,392
.long 1040,27856,400,400,1048,27864,408,408
.long 1440,28256,576,576,1448,28264,584,584
.long 1456,28272,592,592,1464,28280,600,600
.long 1872,28688,800,736,1880,28696,808,744
.long 1856,28672,816,752,1864,28680,824,760
.long 2288,29104,992,928,2296,29112,1000,936
.long 2272,29088,1008,944,2280,29096,1016,952
.long 2704,29520,1184,1120,2712,29528,1192,1128
.long 2688,29504,1200,1136,2696,29512,1208,1144
.long 3120,29936,1376,1312,3128,29944,1384,1320
.long 3104,29920,1392,1328,3112,29928,1400,1336
.long 3520,30336,1536,1536,3528,30344,1544,1544
.long 3536,30352,1552,1552,3544,30360,1560,1560
.long 3936,30752,1728,1728,3944,30760,1736,1736
.long 3952,30768,1744,1744,3960,30776,1752,1752
.long 4352,31168,1920,1920,4360,31176,1928,1928
.long 4368,31184,1936,1936,4376,31192,1944,1944
.long 4768,31584,2112,2112,4776,31592,2120,2120
.long 4784,31600,2128,2128,4792,31608,2136,2136
.long 5200,32016,2336,2272,5208,32024,2344,2280
.long 5184,32000,2352,2288,5192,32008,2360,2296
.long 5616,32432,2528,2464,5624,32440,2536,2472
.long 5600,32416,2544,2480,5608,32424,2552,2488
.long 6032,32848,2720,2656,6040,32856,2728,2664
.long 6016,32832,2736,2672,6024,32840,2744,2680
.long 6448,33264,2912,2848,6456,33272,2920,2856
.long 6432,33248,2928,2864,6440,33256,2936,2872
.long 161876,162048,162216,162560,161876,162048,162216,162572
.long 161876,162048,162216,162584,161876,162048,162216,162596
.long 161876,162048,162220,162608,161876,162048,162220,162620
.long 161876,162048,162220,162632,161876,162048,162220,162644
.long 161880,162048,162220,162656,161880,162048,162220,162668
.long 161880,162048,162220,162680,161880,162048,162220,162692
.long 161880,162052,162220,162704,161880,162052,162220,162716
.long 161880,162052,162220,162728,161880,162052,162220,162740
.long 161880,162052,162224,162568,161880,162052,162224,162580
.long 161880,162052,162224,162592,161880,162052,162224,162604
.long 161884,162052,162224,162616,161884,162052,162224,162628
.long 161884,162052,162224,162640,161884,162052,162224,162652
.long 161884,162056,162224,162664,161884,162056,162224,162676
.long 161884,162056,162224,162688,161884,162056,162224,162700
.long 161884,162056,162228,162712,161884,162056,162228,162724
.long 161884,162056,162228,162736,161884,162056,162228,162748
.long 161888,162056,162228,162564,161888,162056,162228,162576
.long 161888,162056,162228,162588,161888,162056,162228,162600
.long 161888,162060,162228,162612,161888,162060,162228,162624
.long 161888,162060,162228,162636,161888,162060,162228,162648
.long 161888,162060,162232,162660,161888,162060,162232,162672
.long 161888,162060,162232,162684,161888,162060,162232,162696
.long 161892,162060,162232,162708,161892,162060,162232,162720
.long 161892,162060,162232,162732,161892,162060,162232,162744
.long 161892,162064,162232,162568,161892,162064,162232,162580
.long 161892,162064,162232,162592,161892,162064,162232,162604
.long 161892,162064,162236,162616,161892,162064,162236,162628
.long 161892,162064,162236,162640,161892,162064,162236,162652
.long 161896,162064,162236,162664,161896,162064,162236,162676
.long 161896,162064,162236,162688,161896,162064,162236,162700
.long 161896,162068,162236,162712,161896,162068,162236,162724
.long 161896,162068,162236,162736,161896,162068,162236,162748
.long 4128,12288,20480,1024,4144,12304,20496,1040
.long 4096,12320,20512,1056,4112,12336,20528,1072
.long 4192,12352,20544,1088,4208,12368,20560,1104
.long 4160,12384,20576,1120,4176,12400,20592,1136
.long 4256,12416,20608,1152,4272,12432,20624,1168
.long 4224,12448,20640,1184,4240,12464,20656,1200
.long 4320,12480,20672,1216,4336,12496,20688,1232
.long 4288,12512,20704,1248,4304,12528,20720,1264
.long 4384,12544,20768,3072,4400,12560,20784,3088
.long 4352,12576,20736,3104,4368,12592,20752,3120
.long 4448,12608,20832,3136,4464,12624,20848,3152
.long 4416,12640,20800,3168,4432,12656,20816,3184
.long 4512,12672,20896,3200,4528,12688,20912,3216
.long 4480,12704,20864,3232,4496,12720,20880,3248
.long 4576,12736,20960,3264,4592,12752,20976,3280
.long 4544,12768,20928,3296,4560,12784,20944,3312
.long 4608,12800,21024,5120,4624,12816,21040,5136
.long 4640,12832,20992,5152,4656,12848,21008,5168
.long 4672,12864,21088,5184,4688,12880,21104,5200
.long 4704,12896,21056,5216,4720,12912,21072,5232
.long 4736,12928,21152,5248,4752,12944,21168,5264
.long 4768,12960,21120,5280,4784,12976,21136,5296
.long 4800,12992,21216,5312,4816,13008,21232,5328
.long 4832,13024,21184,5344,4848,13040,21200,5360
.long 4864,13088,21280,7168,4880,13104,21296,7184
.long 4896,13056,21248,7200,4912,13072,21264,7216
.long 4928,13152,21344,7232,4944,13168,21360,7248
.long 4960,13120,21312,7264,4976,13136,21328,7280
.long 4992,13216,21408,7296,5008,13232,21424,7312
.long 5024,13184,21376,7328,5040,13200,21392,7344
.long 5056,13280,21472,7360,5072,13296,21488,7376
.long 5088,13248,21440,7392,5104,13264,21456,7408
.long 16256,0,0,0,0x3f800000,0,0,0
.long 0,16256,0,0,0,0x3f800000,0,0
.long 0,0,16256,0,0,0,0x3f800000,0
.long 0,0,0,16256,0,0,0,0x3f800000
.long 0,0,0,0,0,0,0,0
.long 0,0,0,0,0,0,0,0
.long 0,0,0,0,0,0,0,0
.long 0,0,0,0,0,0,0,0
.long 0,0,0,0,0,0,0,0
.long 0,0,0,0,0,0,0,0
.long 0,0,0,0,0,0,0,0
.long 0,0,0,0,0,0,0,0
.long 16256,0,0,0,0x3f800000,0,0,0
.long 0,16256,0,0,0,0x3f800000,0,0
.long 0,0,16256,0,0,0,0x3f800000,0
.long 0,0,0,16256,0,0,0,0x3f800000
.long 0,0,0,0,0,0,0,0
.long 0,0,0,0,0,0,0,0
.long 0,0,0,0,0,0,0,0
.long 0,0,0,0,0,0,0,0
.long 0,0,0,0,0,0,0,0
.long 0,0,0,0,0,0,0,0
.long 0,0,0,0,0,0,0,0
.long 0,0,0,0,0,0,0,0
.long 0,0,0,0,0,0,0,0
.long 0,0,0,0,0,0,0,0
.long 0,0,0,0,0,0,0,0
.long 0,0,0,0,0,0,0,0
.long 0,0,0,0,0,0,0,0
.long 0,0,0,0,0,0,0,0
.long 0,0,0,0,0,0,0,0
.long 0,0,0,0,0,0,0,0
.long 0,0,0,0,0,0,0,0
.long 0,0,0,0,0,0,0,0
.long 0,0,0,0,0,0,0,0
.long 0,0,0,0,0,0,0,0
.long 0,0,0,0,0,0,0,0
.long 0,0,0,0,0,0,0,0
.long 0,0,0,0,0,0,0,0
.long 0,0,0,0,0,0,0,0
.long 0,0,0,0,0,0,0,0
.long 0,0,0,0,0,0,0,0
.long 0,0,0,0,0,0,0,0
.long 0,0,0,0,0,0,0,0
.long 0,0,0,0,0,0,0,0
.long 0,0,0,0,0,0,0,0
.long 0,0,0,0,0,0,0,0
.long 0,0,0,0,0,0,0,0
.long 16256,0,0,0,0x3f800000,0,0,0
.long 0,16256,0,0,0,0x3f800000,0,0
.long 0,0,16256,0,0,0,0x3f800000,0
.long 0,0,0,16256,0,0,0,0x3f800000
.long 0,0,0,0,0,0,0,0
.long 0,0,0,0,0,0,0,0
.long 0,0,0,0,0,0,0,0
.long 0,0,0,0,0,0,0,0
.long 0,0,0,0,0,0,0,0
.long 0,0,0,0,0,0,0,0
.long 0,0,0,0,0,0,0,0
.long 0,0,0,0,0,0,0,0
.long 16256,0,0,0,0x3f800000,0,0,0
.long 0,16256,0,0,0,0x3f800000,0,0
.long 0,0,16256,0,0,0,0x3f800000,0
.long 0,0,0,16256,0,0,0,0x3f800000
.long 99840,99840,3200,163360,100048,99856,3600,163360
.long 100256,99872,4000,163360,100464,99888,4400,163360
.long 100672,99904,3264,163360,100880,99920,3664,163360
.long 101088,99936,4064,163360,101296,99952,4464,163360
.long 101504,99968,3328,163360,101712,99984,3728,163360
.long 101920,100000,4128,163360,102128,100016,4528,163360
.long 102336,100048,12480,163360,102544,100064,12496,163360
.long 102752,100080,12512,163360,102960,100096,12528,163360
.long 99848,100112,3216,163376,100056,100128,3616,163376
.long 100264,100144,4016,163376,100472,100160,4416,163376
.long 100680,100176,3280,163376,100888,100192,3680,163376
.long 101096,100208,4080,163376,101304,100224,4480,163376
.long 101512,100256,3344,163376,101720,100272,3744,163376
.long 101928,100288,4144,163376,102136,100304,4544,163376
.long 102344,100320,12736,163376,102552,100336,12752,163376
.long 102760,100352,12768,163376,102968,100368,12784,163376
.long 99856,100384,3232,163392,100064,100400,3632,163392
.long 100272,100416,4032,163392,100480,100432,4432,163392
.long 100688,100464,3296,163392,100896,100480,3696,163392
.long 101104,100496,4096,163392,101312,100512,4496,163392
.long 101520,100528,3360,163392,101728,100544,3760,163392
.long 101936,100560,4160,163392,102144,100576,4560,163392
.long 102352,100592,12992,163392,102560,100608,13008,163392
.long 102768,100624,13024,163392,102976,100640,13040,163392
.long 99864,100464,3248,163408,100072,100480,3648,163408
.long 100280,100496,4048,163408,100488,100512,4448,163408
.long 100696,100528,3312,163408,100904,100544,3712,163408
.long 101112,100560,4112,163408,101320,100576,4512,163408
.long 101528,100592,3376,163408,101736,100608,3776,163408
.long 101944,100624,4176,163408,102152,100640,4576,163408
.long 102360,100464,13248,163408,102568,100480,13264,163408
.long 102776,100496,13280,163408,102984,100512,13296,163408
.long 475008,129984,172032,173568,475024,130000,172048,173584
.long 475040,130016,172064,173600,475056,130032,172080,173616
.long 475072,130048,172096,173632,475088,130064,172112,173648
.long 475104,130080,172128,173664,475120,130096,172144,173680
.long 475136,130112,172160,173696,475152,130128,172176,173712
.long 475168,130144,172192,173728,475184,130160,172208,173744
.long 475392,130368,172416,173952,475408,130384,172432,173968
.long 475424,130400,172448,173984,475440,130416,172464,174000
.long 475456,130432,172480,174016,475472,130448,172496,174032
.long 475488,130464,172512,174048,475504,130480,172528,174064
.long 475520,130496,172544,174080,475536,130512,172560,174096
.long 475552,130528,172576,174112,475568,130544,172592,174128
.long 129216,130752,172800,174336,129232,130768,172816,174352
.long 129248,130784,172832,174368,129264,130800,172848,174384
.long 129280,130816,172864,174400,129296,130832,172880,174416
.long 129312,130848,172896,174432,129328,130864,172912,174448
.long 129344,130880,172928,174464,129360,130896,172944,174480
.long 129376,130912,172960,174496,129392,130928,172976,174512
.long 129600,131136,173184,516096,129616,131152,173200,516112
.long 129632,131168,173216,516128,129648,131184,173232,516144
.long 129664,131200,173248,516160,129680,131216,173264,516176
.long 129696,131232,173280,516192,129712,131248,173296,516208
.long 129728,131264,173312,516224,129744,131280,173328,516240
.long 129760,131296,173344,516256,129776,131312,173360,516272
.long 0x7fffffff,0x7fffffff,0x7fffffff,0x7fffffff,0x7fffffff,0x7fffffff,0x7fffffff,0x7fffffff
.long 0x7fffffff,0x7fffffff,0x7fffffff,0x7fffffff,0x7fffffff,0x7fffffff,0x7fffffff,0x7fffffff
.long 0x7fffffff,0x7fffffff,0x7fffffff,0x7fffffff,0x7fffffff,0x7fffffff,0x7fffffff,0x7fffffff
.long 0x7fffffff,0x7fffffff,0x7fffffff,0x7fffffff,0x7fffffff,0x7fffffff,0x7fffffff,0x7fffffff
.long 0x7fffffff,0x7fffffff,0x7fffffff,0x7fffffff,0x7fffffff,0x7fffffff,0x7fffffff,0x7fffffff
.long 0x7fffffff,0x7fffffff,0x7fffffff,0x7fffffff,0x7fffffff,0x7fffffff,0x7fffffff,0x7fffffff
.long 0x7fffffff,0x7fffffff,0x7fffffff,0x7fffffff,0x7fffffff,0x7fffffff,0x7fffffff,0x7fffffff
.long 0x7fffffff,0x7fffffff,0x7fffffff,0x7fffffff,0x7fffffff,0x7fffffff,0x7fffffff,0x7fffffff
.long 172992,174528,302400,0,173008,174544,302416,32
.long 173024,174560,302432,64,173040,174576,302448,96
.long 173056,174592,302464,128,173072,174608,302480,160
.long 173088,174624,302496,192,173104,174640,302512,224
.long 173120,174656,302528,256,173136,174672,302544,288
.long 173152,174688,302560,320,173168,174704,302576,352
.long 173376,516288,302784,400,173392,516304,302800,432
.long 173408,516320,302816,464,173424,516336,302832,496
.long 173440,516352,302848,528,173456,516368,302864,560
.long 173472,516384,302880,592,173488,516400,302896,624
.long 173504,516416,302912,656,173520,516432,302928,688
.long 173536,516448,302944,720,173552,516464,302960,752
.long 173760,516672,303168,800,173776,516688,303184,832
.long 173792,516704,303200,864,173808,516720,303216,896
.long 173824,516736,303232,928,173840,516752,303248,960
.long 173856,516768,303264,992,173872,516784,303280,1024
.long 173888,516800,303296,1056,173904,516816,303312,1088
.long 173920,516832,303328,1120,173936,516848,303344,1152
.long 174144,517056,303552,1200,174160,517072,303568,1232
.long 174176,517088,303584,1264,174192,517104,303600,1296
.long 174208,517120,303616,1328,174224,517136,303632,1360
.long 174240,517152,303648,1392,174256,517168,303664,1424
.long 174272,517184,303680,1456,174288,517200,303696,1488
.long 174304,517216,303712,1520,174320,517232,303728,1552
.long 0x7fffffff,0x7fffffff,0x7fffffff,1200,0x7fffffff,0x7fffffff,0x7fffffff,1232
.long 0x7fffffff,0x7fffffff,0x7fffffff,1264,0x7fffffff,0x7fffffff,0x7fffffff,1296
.long 0x7fffffff,0x7fffffff,0x7fffffff,1328,0x7fffffff,0x7fffffff,0x7fffffff,1360
.long 0x7fffffff,0x7fffffff,0x7fffffff,1392,0x7fffffff,0x7fffffff,0x7fffffff,1424
.long 0x7fffffff,0x7fffffff,0x7fffffff,1456,0x7fffffff,0x7fffffff,0x7fffffff,1488
.long 0x7fffffff,0x7fffffff,0x7fffffff,1520,0x7fffffff,0x7fffffff,0x7fffffff,1552
.long 0x7fffffff,0x7fffffff,0x7fffffff,1200,0x7fffffff,0x7fffffff,0x7fffffff,1232
.long 0x7fffffff,0x7fffffff,0x7fffffff,1264,0x7fffffff,0x7fffffff,0x7fffffff,1296
.long 150568,150568,40,30728,150360,150360,104,30792
.long 149112,160760,168,30856,148904,160552,232,30920
.long 150776,150776,312,31000,150568,150568,376,31064
.long 149320,160968,440,31128,149112,160760,440,31128
.long 152024,152024,30728,61480,151816,151816,30792,61544
.long 150568,150568,30856,61608,150360,150360,30920,61672
.long 152232,152232,31000,61752,152024,152024,31064,61816
.long 150776,150776,31128,61880,150568,150568,31128,61880
.long 150984,150984,104,30792,150776,150776,168,30856
.long 149528,161176,232,30920,149320,160968,312,31000
.long 151192,151192,376,31064,150984,150984,440,31128
.long 149736,161384,504,31192,149528,161176,504,31192
.long 152440,152440,30792,61544,152232,152232,30856,61608
.long 150984,150984,30920,61672,150776,150776,31000,61752
.long 152648,152648,31064,61816,152440,152440,31128,61880
.long 151192,151192,31192,61944,150984,150984,31192,61944
.long 151400,151400,168,30856,151192,151192,232,30920
.long 149944,161592,312,31000,149736,161384,376,31064
.long 151608,151608,440,31128,151400,151400,504,31192
.long 150152,161800,552,31240,149944,161592,552,31240
.long 152856,152856,30856,61608,152648,152648,30920,61672
.long 151400,151400,31000,61752,151192,151192,31064,61816
.long 153064,153064,31128,61880,152856,152856,31192,61944
.long 151608,151608,31240,61992,151400,151400,31240,61992
.long 151816,151816,232,30920,151608,151608,312,31000
.long 150360,162008,376,31064,150152,161800,440,31128
.long 152024,152024,504,31192,151816,151816,552,31240
.long 150568,162216,616,31304,150360,162008,616,31304
.long 153272,153272,30920,61672,153064,153064,31000,61752
.long 151816,151816,31064,61816,151608,151608,31128,61880
.long 153480,153480,31192,61944,153272,153272,31240,61992
.long 152024,152024,31304,62056,151816,151816,31304,62056
.long 0xc0c0100,0xc0c0c0c,0xc0c0302,0xc0c0c0c,0x1000c0c,0xc0c0c0c,0x3020c0c,0xc0c0c0c
.long 0xc0c0c0c,0xc0c0100,0xc0c0c0c,0xc0c0302,0xc0c0c0c,0x1000c0c,0xc0c0c0c,0x3020c0c
.long 0xc0c0c0c,0xc0c0c0c,0xc0c0302,0xc0c0c0c,0xc0c0c0c,0xc0c0c0c,0x3020c0c,0xc0c0c0c
.long 0xc0c0c0c,0xc0c0c0c,0xc0c0c0c,0xc0c0302,0xc0c0c0c,0xc0c0c0c,0xc0c0c0c,0x3020c0c
.long 0xc0c0100,0xc0c0c0c,0xc0c0302,0xc0c0c0c,0x1000c0c,0xc0c0c0c,0x3020c0c,0xc0c0c0c
.long 0xc0c0c0c,0xc0c0100,0xc0c0c0c,0xc0c0302,0xc0c0c0c,0x1000c0c,0xc0c0c0c,0x3020c0c
.long 0xc0c0c0c,0xc0c0c0c,0xc0c0302,0xc0c0c0c,0xc0c0c0c,0xc0c0c0c,0x3020c0c,0xc0c0c0c
.long 0xc0c0c0c,0xc0c0c0c,0xc0c0c0c,0xc0c0302,0xc0c0c0c,0xc0c0c0c,0xc0c0c0c,0x3020c0c
.long 0xc0c0100,0xc0c0c0c,0xc0c0302,0xc0c0c0c,0x1000c0c,0xc0c0c0c,0x3020c0c,0xc0c0c0c
.long 0xc0c0c0c,0xc0c0100,0xc0c0c0c,0xc0c0302,0xc0c0c0c,0x1000c0c,0xc0c0c0c,0x3020c0c
.long 0xc0c0100,0xc0c0c0c,0xc0c0302,0xc0c0c0c,0x1000c0c,0xc0c0c0c,0x3020c0c,0xc0c0c0c
.long 0xc0c0c0c,0xc0c0100,0xc0c0c0c,0xc0c0302,0xc0c0c0c,0x1000c0c,0xc0c0c0c,0x3020c0c
.long 0xc0c0100,0xc0c0c0c,0xc0c0302,0xc0c0c0c,0x1000c0c,0xc0c0c0c,0x3020c0c,0xc0c0c0c
.long 0xc0c0c0c,0xc0c0100,0xc0c0c0c,0xc0c0302,0xc0c0c0c,0x1000c0c,0xc0c0c0c,0x3020c0c
.long 0xc0c0100,0xc0c0c0c,0xc0c0302,0xc0c0c0c,0x1000c0c,0xc0c0c0c,0x3020c0c,0xc0c0c0c
.long 0xc0c0c0c,0xc0c0100,0xc0c0c0c,0xc0c0302,0xc0c0c0c,0x1000c0c,0xc0c0c0c,0x3020c0c
.long 0xc0c0100,0xc0c0c0c,0xc0c0302,0xc0c0c0c,0x1000c0c,0xc0c0c0c,0x3020c0c,0xc0c0c0c
.long 0xc0c0c0c,0xc0c0100,0xc0c0c0c,0xc0c0302,0xc0c0c0c,0x1000c0c,0xc0c0c0c,0x3020c0c
.long 0xc0c0100,0xc0c0c0c,0xc0c0302,0xc0c0c0c,0x1000c0c,0xc0c0c0c,0x3020c0c,0xc0c0c0c
.long 0xc0c0c0c,0xc0c0100,0xc0c0c0c,0xc0c0302,0xc0c0c0c,0x1000c0c,0xc0c0c0c,0x3020c0c
.long 0xc0c0100,0xc0c0c0c,0xc0c0302,0xc0c0c0c,0x1000c0c,0xc0c0c0c,0x3020c0c,0xc0c0c0c
.long 0xc0c0c0c,0xc0c0100,0xc0c0c0c,0xc0c0302,0xc0c0c0c,0x1000c0c,0xc0c0c0c,0x3020c0c
.long 0xc0c0100,0xc0c0c0c,0xc0c0302,0xc0c0c0c,0x1000c0c,0xc0c0c0c,0x3020c0c,0xc0c0c0c
.long 0xc0c0c0c,0xc0c0100,0xc0c0c0c,0xc0c0302,0xc0c0c0c,0x1000c0c,0xc0c0c0c,0x3020c0c
.long 0xc0c0100,0xc0c0c0c,0xc0c0c0c,0xc0c0c0c,0x1000c0c,0xc0c0c0c,0xc0c0c0c,0xc0c0c0c
.long 0xc0c0c0c,0xc0c0100,0xc0c0c0c,0xc0c0c0c,0xc0c0c0c,0x1000c0c,0xc0c0c0c,0xc0c0c0c
.long 0xc0c0100,0xc0c0c0c,0xc0c0302,0xc0c0c0c,0x1000c0c,0xc0c0c0c,0x3020c0c,0xc0c0c0c
.long 0xc0c0c0c,0xc0c0100,0xc0c0c0c,0xc0c0302,0xc0c0c0c,0x1000c0c,0xc0c0c0c,0x3020c0c
.long 0xc0c0100,0xc0c0c0c,0xc0c0c0c,0xc0c0c0c,0x1000c0c,0xc0c0c0c,0xc0c0c0c,0xc0c0c0c
.long 0xc0c0c0c,0xc0c0100,0xc0c0c0c,0xc0c0c0c,0xc0c0c0c,0x1000c0c,0xc0c0c0c,0xc0c0c0c
.long 0xc0c0100,0xc0c0c0c,0xc0c0302,0xc0c0c0c,0x1000c0c,0xc0c0c0c,0x3020c0c,0xc0c0c0c
.long 0xc0c0c0c,0xc0c0100,0xc0c0c0c,0xc0c0302,0xc0c0c0c,0x1000c0c,0xc0c0c0c,0x3020c0c
.long 40,11688,23336,34984,248,11896,23544,35192
.long 456,12104,23752,35400,664,12312,23960,35608
.long 872,12520,24168,35816,1080,12728,24376,36024
.long 1288,12936,24584,36232,160880,160880,160880,160880
.long 1496,13144,24792,160784,1704,13352,25000,160800
.long 1912,13560,25208,160816,2120,13768,25416,160832
.long 2328,13976,25624,160848,2536,14184,25832,160864
.long 2744,14392,26040,160880,160768,160768,160768,160768
.long 2952,14600,26248,36440,3160,14808,26456,36648
.long 3368,15016,26664,36856,3576,15224,26872,37064
.long 3784,15432,27080,37272,3992,15640,27288,37480
.long 4200,15848,27496,37688,160880,160880,160880,160880
.long 4408,16056,27704,160784,4616,16264,27912,160800
.long 4824,16472,28120,160816,5032,16680,28328,160832
.long 5240,16888,28536,160848,5448,17096,28744,160864
.long 5656,17304,28952,160880,160768,160768,160768,160768
.long 5864,17512,29160,37896,6072,17720,29368,38104
.long 6280,17928,29576,38312,6488,18136,29784,38520
.long 6696,18344,29992,38728,6904,18552,30200,38936
.long 7112,18760,30408,39144,160880,160880,160880,160880
.long 7320,18968,30616,160784,7528,19176,30824,160800
.long 7736,19384,31032,160816,7944,19592,31240,160832
.long 8152,19800,31448,160848,8360,20008,31656,160864
.long 8568,20216,31864,160880,160768,160768,160768,160768
.long 8776,20424,32072,39352,8984,20632,32280,39560
.long 9192,20840,32488,39768,9400,21048,32696,159784
.long 9608,21256,32904,159976,9816,21464,33112,160168
.long 10024,21672,33320,160360,160880,160880,160880,160880
.long 10232,21880,33528,160784,10440,22088,33736,160800
.long 10648,22296,33944,160816,10856,22504,34152,160832
.long 11064,22712,34360,160848,11272,22920,34568,160864
.long 11480,23128,34776,160880,160768,160768,160768,160768
.long 6656,82944,159744,160512,6864,82952,159936,160512
.long 7072,82960,160128,160512,7280,82968,160320,160512
.long 9984,83008,160512,160512,10192,83016,160512,160512
.long 10400,83024,160512,160512,10608,83032,160512,160512
.long 7488,83072,160512,159744,7696,83080,160512,159936
.long 7904,83088,160512,160128,8112,83096,160512,160320
.long 10816,83136,160512,160512,11024,83144,160512,160512
.long 11232,83152,160512,160512,11440,83160,160512,160512
.long 8320,82976,160512,160512,8528,82984,160512,160512
.long 8736,82992,160512,160512,8944,83000,160512,160512
.long 11648,83040,159744,160512,11856,83048,159936,160512
.long 12064,83056,160128,160512,12272,83064,160320,160512
.long 9152,83104,160512,160512,9360,83112,160512,160512
.long 9568,83120,160512,160512,9776,83128,160512,160512
.long 12480,83168,160512,159744,12688,83176,160512,159936
.long 12896,83184,160512,160128,13104,83192,160512,160320
.long 6672,83456,159760,160512,6880,83464,159952,160512
.long 7088,83472,160144,160512,7296,83480,160336,160512
.long 10000,83520,160512,160512,10208,83528,160512,160512
.long 10416,83536,160512,160512,10624,83544,160512,160512
.long 7504,83584,160512,159760,7712,83592,160512,159952
.long 7920,83600,160512,160144,8128,83608,160512,160336
.long 10832,83648,160512,160512,11040,83656,160512,160512
.long 11248,83664,160512,160512,11456,83672,160512,160512
.long 8336,83488,160512,160512,8544,83496,160512,160512
.long 8752,83504,160512,160512,8960,83512,160512,160512
.long 11664,83552,159760,160512,11872,83560,159952,160512
.long 12080,83568,160144,160512,12288,83576,160336,160512
.long 9168,83616,160512,160512,9376,83624,160512,160512
.long 9584,83632,160512,160512,9792,83640,160512,160512
.long 12496,83680,160512,159760,12704,83688,160512,159952
.long 12912,83696,160512,160144,13120,83704,160512,160336
.long 13376,13392,120192,13720,13792,13808,120608,14136
.long 14208,14224,121024,14552,14624,14640,121440,14968
.long 15056,15040,121872,15368,15472,15456,122288,15784
.long 15888,15872,122704,16200,16304,16288,123120,16616
.long 16704,16720,123520,17048,17120,17136,123936,17464
.long 17536,17552,124352,17880,17952,17968,124768,18296
.long 18384,18368,125200,18696,18800,18784,125616,19112
.long 19216,19200,126032,19528,19632,19616,126448,19944
.long 20032,20048,126848,20376,20448,20464,127264,20792
.long 20864,20880,127680,21208,21280,21296,128096,21624
.long 21712,21696,128528,22024,22128,22112,128944,22440
.long 22544,22528,129360,22856,22960,22944,129776,23272
.long 23360,23376,130176,23704,23776,23792,130592,24120
.long 24192,24208,131008,24536,24608,24624,131424,24952
.long 25040,25024,131856,25352,25456,25440,132272,25768
.long 25872,25856,132688,26184,26288,26272,133104,26600
.long 13408,13424,173440,13724,13824,13840,173856,14140
.long 14240,14256,174272,14556,14656,14672,174688,14972
.long 15088,15072,175120,15372,15504,15488,175536,15788
.long 15920,15904,175952,16204,16336,16320,176368,16620
.long 16736,16752,176768,17052,17152,17168,177184,17468
.long 17568,17584,177600,17884,17984,18000,178016,18300
.long 18416,18400,178448,18700,18832,18816,178864,19116
.long 19248,19232,179280,19532,19664,19648,179696,19948
.long 20064,20080,180096,20380,20480,20496,180512,20796
.long 20896,20912,180928,21212,21312,21328,181344,21628
.long 21744,21728,181776,22028,22160,22144,182192,22444
.long 22576,22560,182608,22860,22992,22976,183024,23276
.long 23392,23408,183424,23708,23808,23824,183840,24124
.long 24224,24240,184256,24540,24640,24656,184672,24956
.long 25072,25056,185104,25356,25488,25472,185520,25772
.long 25904,25888,185936,26188,26320,26304,186352,26604
.long 475104,172128,173088,302496,475488,172512,173472,302880
.long 129312,172896,173856,303264,129696,173280,174240,303648
.long 130080,173664,174624,0x7fffffff,130464,174048,516384,0x7fffffff
.long 130848,174432,516768,0x7fffffff,131232,516192,517152,0x7fffffff
.long 131616,516576,517536,0x7fffffff,473376,516960,517920,0x7fffffff
.long 473760,517344,518304,0x7fffffff,474144,517728,518688,0x7fffffff
.long 474528,518112,215136,0x7fffffff,474912,518496,215520,0x7fffffff
.long 475296,172320,215904,0x7fffffff,475680,172704,216288,0x7fffffff
.long 475120,172144,173104,302512,475504,172528,173488,302896
.long 129328,172912,173872,303280,129712,173296,174256,303664
.long 130096,173680,174640,0x7fffffff,130480,174064,516400,0x7fffffff
.long 130864,174448,516784,0x7fffffff,131248,516208,517168,0x7fffffff
.long 131632,516592,517552,0x7fffffff,473392,516976,517936,0x7fffffff
.long 473776,517360,518320,0x7fffffff,474160,517744,518704,0x7fffffff
.long 474544,518128,215152,0x7fffffff,474928,518512,215536,0x7fffffff
.long 475312,172336,215920,0x7fffffff,475696,172720,216304,0x7fffffff
.long 475136,172160,173120,302528,475520,172544,173504,302912
.long 129344,172928,173888,303296,129728,173312,174272,303680
.long 130112,173696,174656,0x7fffffff,130496,174080,516416,0x7fffffff
.long 130880,174464,516800,0x7fffffff,131264,516224,517184,0x7fffffff
.long 131648,516608,517568,0x7fffffff,473408,516992,517952,0x7fffffff
.long 473792,517376,518336,0x7fffffff,474176,517760,518720,0x7fffffff
.long 474560,518144,215168,0x7fffffff,474944,518528,215552,0x7fffffff
.long 475328,172352,215936,0x7fffffff,475712,172736,216320,0x7fffffff
.long 475152,172176,173136,302544,475536,172560,173520,302928
.long 129360,172944,173904,303312,129744,173328,174288,303696
.long 130128,173712,174672,0x7fffffff,130512,174096,516432,0x7fffffff
.long 130896,174480,516816,0x7fffffff,131280,516240,517200,0x7fffffff
.long 131664,516624,517584,0x7fffffff,473424,517008,517968,0x7fffffff
.long 473808,517392,518352,0x7fffffff,474192,517776,518736,0x7fffffff
.long 474576,518160,215184,0x7fffffff,474960,518544,215568,0x7fffffff
.long 475344,172368,215952,0x7fffffff,475728,172752,216336,0x7fffffff
.long 5120,37888,58368,672,5136,37904,58384,678
.long 5152,37920,58400,684,5168,37936,58416,690
.long 5184,37952,58432,696,5200,37968,58448,702
.long 5216,37984,58464,132,5232,38000,58480,138
.long 5248,38016,58496,144,5264,38032,58512,150
.long 5280,38048,58528,156,5296,38064,58544,162
.long 5312,38080,58560,168,5328,38096,58576,174
.long 5344,38112,58592,180,5360,38128,58608,186
.long 5376,38144,58624,676,5392,38160,58640,682
.long 5408,38176,58656,688,5424,38192,58672,694
.long 5440,38208,58688,700,5456,38224,58704,130
.long 5472,38240,58720,136,5488,38256,58736,142
.long 5504,38272,58752,148,5520,38288,58768,154
.long 5536,38304,58784,160,5552,38320,58800,166
.long 5568,38336,58816,172,5584,38352,58832,178
.long 5600,38368,58848,184,5616,38384,58864,190
.long 5632,38400,58880,674,5648,38416,58896,680
.long 5664,38432,58912,686,5680,38448,58928,692
.long 5696,38464,58944,698,5712,38480,58960,128
.long 5728,38496,58976,134,5744,38512,58992,140
.long 5760,38528,59008,146,5776,38544,59024,152
.long 5792,38560,59040,158,5808,38576,59056,164
.long 5824,38592,59072,170,5840,38608,59088,176
.long 5856,38624,59104,182,5872,38640,59120,188
.long 5888,38656,59136,676,5904,38672,59152,682
.long 5920,38688,59168,688,5936,38704,59184,694
.long 5952,38720,59200,700,5968,38736,59216,130
.long 5984,38752,59232,136,6000,38768,59248,142
.long 6016,38784,59264,148,6032,38800,59280,154
.long 6048,38816,59296,160,6064,38832,59312,166
.long 6080,38848,59328,172,6096,38864,59344,178
.long 6112,38880,59360,184,6128,38896,59376,190
.long 100232,100240,120216,163360,100648,100656,120632,163372
.long 101064,101072,121048,163384,101064,101072,121464,163396
.long 101480,101488,121864,163408,101912,101888,122280,163420
.long 102328,102304,122696,163432,102328,102304,123112,163444
.long 102744,102720,123544,163456,103160,103136,123960,163468
.long 103560,103568,124376,163480,103560,103568,124792,163492
.long 103976,103984,125192,163504,104392,104400,125608,163516
.long 104808,104816,126024,163528,104808,104816,126440,163540
.long 105240,105216,126872,163552,105656,105632,127288,163564
.long 106072,106048,127704,163576,106072,106048,128120,163588
.long 106488,106464,128520,163600,106888,106896,128936,163612
.long 107304,107312,129352,163624,107304,107312,129768,163636
.long 107720,107728,130200,163648,108136,108144,130616,163660
.long 108568,108544,131032,163672,108568,108544,131448,163684
.long 108984,108960,131848,163696,109400,109376,132264,163708
.long 109816,109792,132680,163720,109816,109792,133096,163732
.long 110216,110224,120220,163360,110632,110640,120636,163372
.long 111048,111056,121052,163384,111048,111056,121468,163396
.long 111464,111472,121868,163408,111896,111872,122284,163420
.long 112312,112288,122700,163432,112312,112288,123116,163444
.long 112728,112704,123548,163456,113144,113120,123964,163468
.long 113544,113552,124380,163480,113544,113552,124796,163492
.long 113960,113968,125196,163504,114376,114384,125612,163516
.long 114792,114800,126028,163528,114792,114800,126444,163540
.long 115224,115200,126876,163552,115640,115616,127292,163564
.long 116056,116032,127708,163576,116056,116032,128124,163588
.long 116472,116448,128524,163600,116872,116880,128940,163612
.long 117288,117296,129356,163624,117288,117296,129772,163636
.long 117704,117712,130204,163648,118120,118128,130620,163660
.long 118552,118528,131036,163672,118552,118528,131452,163684
.long 118968,118944,131852,163696,119384,119360,132268,163708
.long 119800,119776,132684,163720,119800,119776,133100,163732
.long 192,27008,96,96,200,27016,104,104
.long 208,27024,112,112,216,27032,120,120
.long 608,27424,288,288,616,27432,296,296
.long 624,27440,304,304,632,27448,312,312
.long 1024,27840,480,480,1032,27848,488,488
.long 1040,27856,496,496,1048,27864,504,504
.long 1440,28256,672,672,1448,28264,680,680
.long 1456,28272,688,688,1464,28280,696,696
.long 1872,28688,832,896,1880,28696,840,904
.long 1856,28672,848,912,1864,28680,856,920
.long 2288,29104,1024,1088,2296,29112,1032,1096
.long 2272,29088,1040,1104,2280,29096,1048,1112
.long 2704,29520,1216,1280,2712,29528,1224,1288
.long 2688,29504,1232,1296,2696,29512,1240,1304
.long 3120,29936,1408,1472,3128,29944,1416,1480
.long 3104,29920,1424,1488,3112,29928,1432,1496
.long 3520,30336,1632,1632,3528,30344,1640,1640
.long 3536,30352,1648,1648,3544,30360,1656,1656
.long 3936,30752,1824,1824,3944,30760,1832,1832
.long 3952,30768,1840,1840,3960,30776,1848,1848
.long 4352,31168,2016,2016,4360,31176,2024,2024
.long 4368,31184,2032,2032,4376,31192,2040,2040
.long 4768,31584,2208,2208,4776,31592,2216,2216
.long 4784,31600,2224,2224,4792,31608,2232,2232
.long 5200,32016,2368,2432,5208,32024,2376,2440
.long 5184,32000,2384,2448,5192,32008,2392,2456
.long 5616,32432,2560,2624,5624,32440,2568,2632
.long 5600,32416,2576,2640,5608,32424,2584,2648
.long 6032,32848,2752,2816,6040,32856,2760,2824
.long 6016,32832,2768,2832,6024,32840,2776,2840
.long 6448,33264,2944,3008,6456,33272,2952,3016
.long 6432,33248,2960,3024,6440,33256,2968,3032
.long 161896,162068,162240,162752,161896,162068,162240,162764
.long 161896,162068,162240,162776,161896,162068,162240,162788
.long 161900,162068,162240,162800,161900,162068,162240,162812
.long 161900,162068,162240,162824,161900,162068,162240,162836
.long 161900,162072,162240,162848,161900,162072,162240,162860
.long 161900,162072,162240,162872,161900,162072,162240,162884
.long 161900,162072,162244,162896,161900,162072,162244,162908
.long 161900,162072,162244,162920,161900,162072,162244,162932
.long 161904,162072,162244,162760,161904,162072,162244,162772
.long 161904,162072,162244,162784,161904,162072,162244,162796
.long 161904,162076,162244,162808,161904,162076,162244,162820
.long 161904,162076,162244,162832,161904,162076,162244,162844
.long 161904,162076,162248,162856,161904,162076,162248,162868
.long 161904,162076,162248,162880,161904,162076,162248,162892
.long 161908,162076,162248,162904,161908,162076,162248,162916
.long 161908,162076,162248,162928,161908,162076,162248,162940
.long 161908,162080,162248,162756,161908,162080,162248,162768
.long 161908,162080,162248,162780,161908,162080,162248,162792
.long 161908,162080,162252,162804,161908,162080,162252,162816
.long 161908,162080,162252,162828,161908,162080,162252,162840
.long 161912,162080,162252,162852,161912,162080,162252,162864
.long 161912,162080,162252,162876,161912,162080,162252,162888
.long 161912,162084,162252,162900,161912,162084,162252,162912
.long 161912,162084,162252,162924,161912,162084,162252,162936
.long 161912,162084,162256,162760,161912,162084,162256,162772
.long 161912,162084,162256,162784,161912,162084,162256,162796
.long 161916,162084,162256,162808,161916,162084,162256,162820
.long 161916,162084,162256,162832,161916,162084,162256,162844
.long 161916,162088,162256,162856,161916,162088,162256,162868
.long 161916,162088,162256,162880,161916,162088,162256,162892
.long 161916,162088,162260,162904,161916,162088,162260,162916
.long 161916,162088,162260,162928,161916,162088,162260,162940
.long 5120,13344,21504,1280,5136,13360,21520,1296
.long 5152,13312,21536,1312,5168,13328,21552,1328
.long 5184,13408,21568,1344,5200,13424,21584,1360
.long 5216,13376,21600,1376,5232,13392,21616,1392
.long 5248,13472,21632,1408,5264,13488,21648,1424
.long 5280,13440,21664,1440,5296,13456,21680,1456
.long 5312,13536,21696,1472,5328,13552,21712,1488
.long 5344,13504,21728,1504,5360,13520,21744,1520
.long 5408,13600,21760,3328,5424,13616,21776,3344
.long 5376,13568,21792,3360,5392,13584,21808,3376
.long 5472,13664,21824,3392,5488,13680,21840,3408
.long 5440,13632,21856,3424,5456,13648,21872,3440
.long 5536,13728,21888,3456,5552,13744,21904,3472
.long 5504,13696,21920,3488,5520,13712,21936,3504
.long 5600,13792,21952,3520,5616,13808,21968,3536
.long 5568,13760,21984,3552,5584,13776,22000,3568
.long 5664,13824,22016,5376,5680,13840,22032,5392
.long 5632,13856,22048,5408,5648,13872,22064,5424
.long 5728,13888,22080,5440,5744,13904,22096,5456
.long 5696,13920,22112,5472,5712,13936,22128,5488
.long 5792,13952,22144,5504,5808,13968,22160,5520
.long 5760,13984,22176,5536,5776,14000,22192,5552
.long 5856,14016,22208,5568,5872,14032,22224,5584
.long 5824,14048,22240,5600,5840,14064,22256,5616
.long 5920,14080,22304,7424,5936,14096,22320,7440
.long 5888,14112,22272,7456,5904,14128,22288,7472
.long 5984,14144,22368,7488,6000,14160,22384,7504
.long 5952,14176,22336,7520,5968,14192,22352,7536
.long 6048,14208,22432,7552,6064,14224,22448,7568
.long 6016,14240,22400,7584,6032,14256,22416,7600
.long 6112,14272,22496,7616,6128,14288,22512,7632
.long 6080,14304,22464,7648,6096,14320,22480,7664
.long 16256,0,0,0,0x3f800000,0,0,0
.long 0,16256,0,0,0,0x3f800000,0,0
.long 0,0,16256,0,0,0,0x3f800000,0
.long 0,0,0,16256,0,0,0,0x3f800000
.long 0,0,0,0,0,0,0,0
.long 0,0,0,0,0,0,0,0
.long 0,0,0,0,0,0,0,0
.long 0,0,0,0,0,0,0,0
.long 0,0,0,0,0,0,0,0
.long 0,0,0,0,0,0,0,0
.long 0,0,0,0,0,0,0,0
.long 0,0,0,0,0,0,0,0
.long 16256,0,0,0,0x3f800000,0,0,0
.long 0,16256,0,0,0,0x3f800000,0,0
.long 0,0,16256,0,0,0,0x3f800000,0
.long 0,0,0,16256,0,0,0,0x3f800000
.long 0,0,0,0,0,0,0,0
.long 0,0,0,0,0,0,0,0
.long 0,0,0,0,0,0,0,0
.long 0,0,0,0,0,0,0,0
.long 0,0,0,0,0,0,0,0
.long 0,0,0,0,0,0,0,0
.long 0,0,0,0,0,0,0,0
.long 0,0,0,0,0,0,0,0
.long 0,0,0,0,0,0,0,0
.long 0,0,0,0,0,0,0,0
.long 0,0,0,0,0,0,0,0
.long 0,0,0,0,0,0,0,0
.long 0,0,0,0,0,0,0,0
.long 0,0,0,0,0,0,0,0
.long 0,0,0,0,0,0,0,0
.long 0,0,0,0,0,0,0,0
.long 0,0,0,0,0,0,0,0
.long 0,0,0,0,0,0,0,0
.long 0,0,0,0,0,0,0,0
.long 0,0,0,0,0,0,0,0
.long 0,0,0,0,0,0,0,0
.long 0,0,0,0,0,0,0,0
.long 0,0,0,0,0,0,0,0
.long 0,0,0,0,0,0,0,0
.long 0,0,0,0,0,0,0,0
.long 0,0,0,0,0,0,0,0
.long 0,0,0,0,0,0,0,0
.long 0,0,0,0,0,0,0,0
.long 0,0,0,0,0,0,0,0
.long 0,0,0,0,0,0,0,0
.long 0,0,0,0,0,0,0,0
.long 0,0,0,0,0,0,0,0
.long 16256,0,0,0,0x3f800000,0,0,0
.long 0,16256,0,0,0,0x3f800000,0,0
.long 0,0,16256,0,0,0,0x3f800000,0
.long 0,0,0,16256,0,0,0,0x3f800000
.long 0,0,0,0,0,0,0,0
.long 0,0,0,0,0,0,0,0
.long 0,0,0,0,0,0,0,0
.long 0,0,0,0,0,0,0,0
.long 0,0,0,0,0,0,0,0
.long 0,0,0,0,0,0,0,0
.long 0,0,0,0,0,0,0,0
.long 0,0,0,0,0,0,0,0
.long 16256,0,0,0,0x3f800000,0,0,0
.long 0,16256,0,0,0,0x3f800000,0,0
.long 0,0,16256,0,0,0,0x3f800000,0
.long 0,0,0,16256,0,0,0,0x3f800000
.long 99936,101504,3392,163552,100144,101520,3792,163552
.long 100352,101536,4192,163552,100560,101552,4592,163552
.long 100768,101568,3456,163552,100976,101584,3856,163552
.long 101184,101600,4256,163552,101392,101616,4656,163552
.long 101600,101632,3520,163552,101808,101648,3920,163552
.long 102016,101664,4320,163552,102224,101680,4720,163552
.long 102432,101712,13504,163552,102640,101728,13520,163552
.long 102848,101744,13536,163552,103056,101760,13552,163552
.long 99944,101776,3408,163568,100152,101792,3808,163568
.long 100360,101808,4208,163568,100568,101824,4608,163568
.long 100776,101840,3472,163568,100984,101856,3872,163568
.long 101192,101872,4272,163568,101400,101888,4672,163568
.long 101608,101920,3536,163568,101816,101936,3936,163568
.long 102024,101952,4336,163568,102232,101968,4736,163568
.long 102440,101984,13760,163568,102648,102000,13776,163568
.long 102856,102016,13792,163568,103064,102032,13808,163568
.long 99952,102048,3424,163584,100160,102064,3824,163584
.long 100368,102080,4224,163584,100576,102096,4624,163584
.long 100784,102128,3488,163584,100992,102144,3888,163584
.long 101200,102160,4288,163584,101408,102176,4688,163584
.long 101616,102192,3552,163584,101824,102208,3952,163584
.long 102032,102224,4352,163584,102240,102240,4752,163584
.long 102448,102256,14016,163584,102656,102272,14032,163584
.long 102864,102288,14048,163584,103072,102304,14064,163584
.long 99960,102128,3440,163600,100168,102144,3840,163600
.long 100376,102160,4240,163600,100584,102176,4640,163600
.long 100792,102192,3504,163600,101000,102208,3904,163600
.long 101208,102224,4304,163600,101416,102240,4704,163600
.long 101624,102256,3568,163600,101832,102272,3968,163600
.long 102040,102288,4368,163600,102248,102304,4768,163600
.long 102456,102128,14272,163600,102664,102144,14288,163600
.long 102872,102160,14304,163600,103080,102176,14320,163600
.long 131520,474432,516480,518016,131536,474448,516496,518032
.long 131552,474464,516512,518048,131568,474480,516528,518064
.long 131584,474496,516544,518080,131600,474512,516560,518096
.long 131616,474528,516576,518112,131632,474544,516592,518128
.long 131648,474560,516608,518144,131664,474576,516624,518160
.long 131680,474592,516640,518176,131696,474608,516656,518192
.long 473280,474816,516864,518400,473296,474832,516880,518416
.long 473312,474848,516896,518432,473328,474864,516912,518448
.long 473344,474880,516928,518464,473360,474896,516944,518480
.long 473376,474912,516960,518496,473392,474928,516976,518512
.long 473408,474944,516992,518528,473424,474960,517008,518544
.long 473440,474976,517024,518560,473456,474992,517040,518576
.long 473664,475200,517248,172224,473680,475216,517264,172240
.long 473696,475232,517280,172256,473712,475248,517296,172272
.long 473728,475264,517312,172288,473744,475280,517328,172304
.long 473760,475296,517344,172320,473776,475312,517360,172336
.long 473792,475328,517376,172352,473808,475344,517392,172368
.long 473824,475360,517408,172384,473840,475376,517424,172400
.long 474048,475584,517632,172608,474064,475600,517648,172624
.long 474080,475616,517664,172640,474096,475632,517680,172656
.long 474112,475648,517696,172672,474128,475664,517712,172688
.long 474144,475680,517728,172704,474160,475696,517744,172720
.long 474176,475712,517760,172736,474192,475728,517776,172752
.long 474208,475744,517792,172768,474224,475760,517808,172784
.long 0x7fffffff,0x7fffffff,0x7fffffff,0x7fffffff,0x7fffffff,0x7fffffff,0x7fffffff,0x7fffffff
.long 0x7fffffff,0x7fffffff,0x7fffffff,0x7fffffff,0x7fffffff,0x7fffffff,0x7fffffff,0x7fffffff
.long 0x7fffffff,0x7fffffff,0x7fffffff,0x7fffffff,0x7fffffff,0x7fffffff,0x7fffffff,0x7fffffff
.long 0x7fffffff,0x7fffffff,0x7fffffff,0x7fffffff,0x7fffffff,0x7fffffff,0x7fffffff,0x7fffffff
.long 0x7fffffff,0x7fffffff,0x7fffffff,0x7fffffff,0x7fffffff,0x7fffffff,0x7fffffff,0x7fffffff
.long 0x7fffffff,0x7fffffff,0x7fffffff,0x7fffffff,0x7fffffff,0x7fffffff,0x7fffffff,0x7fffffff
.long 0x7fffffff,0x7fffffff,0x7fffffff,0x7fffffff,0x7fffffff,0x7fffffff,0x7fffffff,0x7fffffff
.long 0x7fffffff,0x7fffffff,0x7fffffff,0x7fffffff,0x7fffffff,0x7fffffff,0x7fffffff,0x7fffffff
.long 517440,215040,302400,0,517456,215056,302416,32
.long 517472,215072,302432,64,517488,215088,302448,96
.long 517504,215104,302464,128,517520,215120,302480,160
.long 517536,215136,302496,192,517552,215152,302512,224
.long 517568,215168,302528,256,517584,215184,302544,288
.long 517600,215200,302560,320,517616,215216,302576,352
.long 517824,215424,302784,400,517840,215440,302800,432
.long 517856,215456,302816,464,517872,215472,302832,496
.long 517888,215488,302848,528,517904,215504,302864,560
.long 517920,215520,302880,592,517936,215536,302896,624
.long 517952,215552,302912,656,517968,215568,302928,688
.long 517984,215584,302944,720,518000,215600,302960,752
.long 518208,215808,303168,800,518224,215824,303184,832
.long 518240,215840,303200,864,518256,215856,303216,896
.long 518272,215872,303232,928,518288,215888,303248,960
.long 518304,215904,303264,992,518320,215920,303280,1024
.long 518336,215936,303296,1056,518352,215952,303312,1088
.long 518368,215968,303328,1120,518384,215984,303344,1152
.long 518592,216192,303552,1200,518608,216208,303568,1232
.long 518624,216224,303584,1264,518640,216240,303600,1296
.long 518656,216256,303616,1328,518672,216272,303632,1360
.long 518688,216288,303648,1392,518704,216304,303664,1424
.long 518720,216320,303680,1456,518736,216336,303696,1488
.long 518752,216352,303712,1520,518768,216368,303728,1552
.long 0x7fffffff,0x7fffffff,0x7fffffff,1200,0x7fffffff,0x7fffffff,0x7fffffff,1232
.long 0x7fffffff,0x7fffffff,0x7fffffff,1264,0x7fffffff,0x7fffffff,0x7fffffff,1296
.long 0x7fffffff,0x7fffffff,0x7fffffff,1328,0x7fffffff,0x7fffffff,0x7fffffff,1360
.long 0x7fffffff,0x7fffffff,0x7fffffff,1392,0x7fffffff,0x7fffffff,0x7fffffff,1424
.long 0x7fffffff,0x7fffffff,0x7fffffff,1456,0x7fffffff,0x7fffffff,0x7fffffff,1488
.long 0x7fffffff,0x7fffffff,0x7fffffff,1520,0x7fffffff,0x7fffffff,0x7fffffff,1552
.long 0x7fffffff,0x7fffffff,0x7fffffff,1200,0x7fffffff,0x7fffffff,0x7fffffff,1232
.long 0x7fffffff,0x7fffffff,0x7fffffff,1264,0x7fffffff,0x7fffffff,0x7fffffff,1296
.long 150576,150576,48,30736,150368,150368,112,30800
.long 149120,160768,176,30864,148912,160560,240,30928
.long 150784,150784,288,30976,150576,150576,352,31040
.long 149328,160976,416,31104,149120,160768,416,31104
.long 152032,152032,30736,61488,151824,151824,30800,61552
.long 150576,150576,30864,61616,150368,150368,30928,61680
.long 152240,152240,30976,61728,152032,152032,31040,61792
.long 150784,150784,31104,61856,150576,150576,31104,61856
.long 150992,150992,112,30800,150784,150784,176,30864
.long 149536,161184,240,30928,149328,160976,288,30976
.long 151200,151200,352,31040,150992,150992,416,31104
.long 149744,161392,480,31168,149536,161184,480,31168
.long 152448,152448,30800,61552,152240,152240,30864,61616
.long 150992,150992,30928,61680,150784,150784,30976,61728
.long 152656,152656,31040,61792,152448,152448,31104,61856
.long 151200,151200,31168,61920,150992,150992,31168,61920
.long 151408,151408,176,30864,151200,151200,240,30928
.long 149952,161600,288,30976,149744,161392,352,31040
.long 151616,151616,416,31104,151408,151408,480,31168
.long 150160,161808,560,31248,149952,161600,560,31248
.long 152864,152864,30864,61616,152656,152656,30928,61680
.long 151408,151408,30976,61728,151200,151200,31040,61792
.long 153072,153072,31104,61856,152864,152864,31168,61920
.long 151616,151616,31248,62000,151408,151408,31248,62000
.long 151824,151824,240,30928,151616,151616,288,30976
.long 150368,162016,352,31040,150160,161808,416,31104
.long 152032,152032,480,31168,151824,151824,560,31248
.long 150576,162224,624,31312,150368,162016,624,31312
.long 153280,153280,30928,61680,153072,153072,30976,61728
.long 151824,151824,31040,61792,151616,151616,31104,61856
.long 153488,153488,31168,61920,153280,153280,31248,62000
.long 152032,152032,31312,62064,151824,151824,31312,62064
.long 0xc0c0100,0xc0c0c0c,0xc0c0302,0xc0c0c0c,0x1000c0c,0xc0c0c0c,0x3020c0c,0xc0c0c0c
.long 0xc0c0c0c,0xc0c0100,0xc0c0c0c,0xc0c0302,0xc0c0c0c,0x1000c0c,0xc0c0c0c,0x3020c0c
.long 0xc0c0c0c,0xc0c0c0c,0xc0c0302,0xc0c0c0c,0xc0c0c0c,0xc0c0c0c,0x3020c0c,0xc0c0c0c
.long 0xc0c0c0c,0xc0c0c0c,0xc0c0c0c,0xc0c0302,0xc0c0c0c,0xc0c0c0c,0xc0c0c0c,0x3020c0c
.long 0xc0c0100,0xc0c0c0c,0xc0c0302,0xc0c0c0c,0x1000c0c,0xc0c0c0c,0x3020c0c,0xc0c0c0c
.long 0xc0c0c0c,0xc0c0100,0xc0c0c0c,0xc0c0302,0xc0c0c0c,0x1000c0c,0xc0c0c0c,0x3020c0c
.long 0xc0c0c0c,0xc0c0c0c,0xc0c0302,0xc0c0c0c,0xc0c0c0c,0xc0c0c0c,0x3020c0c,0xc0c0c0c
.long 0xc0c0c0c,0xc0c0c0c,0xc0c0c0c,0xc0c0302,0xc0c0c0c,0xc0c0c0c,0xc0c0c0c,0x3020c0c
.long 0xc0c0100,0xc0c0c0c,0xc0c0302,0xc0c0c0c,0x1000c0c,0xc0c0c0c,0x3020c0c,0xc0c0c0c
.long 0xc0c0c0c,0xc0c0100,0xc0c0c0c,0xc0c0302,0xc0c0c0c,0x1000c0c,0xc0c0c0c,0x3020c0c
.long 0xc0c0100,0xc0c0c0c,0xc0c0302,0xc0c0c0c,0x1000c0c,0xc0c0c0c,0x3020c0c,0xc0c0c0c
.long 0xc0c0c0c,0xc0c0100,0xc0c0c0c,0xc0c0302,0xc0c0c0c,0x1000c0c,0xc0c0c0c,0x3020c0c
.long 0xc0c0100,0xc0c0c0c,0xc0c0302,0xc0c0c0c,0x1000c0c,0xc0c0c0c,0x3020c0c,0xc0c0c0c
.long 0xc0c0c0c,0xc0c0100,0xc0c0c0c,0xc0c0302,0xc0c0c0c,0x1000c0c,0xc0c0c0c,0x3020c0c
.long 0xc0c0100,0xc0c0c0c,0xc0c0302,0xc0c0c0c,0x1000c0c,0xc0c0c0c,0x3020c0c,0xc0c0c0c
.long 0xc0c0c0c,0xc0c0100,0xc0c0c0c,0xc0c0302,0xc0c0c0c,0x1000c0c,0xc0c0c0c,0x3020c0c
.long 0xc0c0100,0xc0c0c0c,0xc0c0302,0xc0c0c0c,0x1000c0c,0xc0c0c0c,0x3020c0c,0xc0c0c0c
.long 0xc0c0c0c,0xc0c0100,0xc0c0c0c,0xc0c0302,0xc0c0c0c,0x1000c0c,0xc0c0c0c,0x3020c0c
.long 0xc0c0100,0xc0c0c0c,0xc0c0302,0xc0c0c0c,0x1000c0c,0xc0c0c0c,0x3020c0c,0xc0c0c0c
.long 0xc0c0c0c,0xc0c0100,0xc0c0c0c,0xc0c0302,0xc0c0c0c,0x1000c0c,0xc0c0c0c,0x3020c0c
.long 0xc0c0100,0xc0c0c0c,0xc0c0302,0xc0c0c0c,0x1000c0c,0xc0c0c0c,0x3020c0c,0xc0c0c0c
.long 0xc0c0c0c,0xc0c0100,0xc0c0c0c,0xc0c0302,0xc0c0c0c,0x1000c0c,0xc0c0c0c,0x3020c0c
.long 0xc0c0100,0xc0c0c0c,0xc0c0302,0xc0c0c0c,0x1000c0c,0xc0c0c0c,0x3020c0c,0xc0c0c0c
.long 0xc0c0c0c,0xc0c0100,0xc0c0c0c,0xc0c0302,0xc0c0c0c,0x1000c0c,0xc0c0c0c,0x3020c0c
.long 0xc0c0100,0xc0c0c0c,0xc0c0c0c,0xc0c0c0c,0x1000c0c,0xc0c0c0c,0xc0c0c0c,0xc0c0c0c
.long 0xc0c0c0c,0xc0c0100,0xc0c0c0c,0xc0c0c0c,0xc0c0c0c,0x1000c0c,0xc0c0c0c,0xc0c0c0c
.long 0xc0c0100,0xc0c0c0c,0xc0c0302,0xc0c0c0c,0x1000c0c,0xc0c0c0c,0x3020c0c,0xc0c0c0c
.long 0xc0c0c0c,0xc0c0100,0xc0c0c0c,0xc0c0302,0xc0c0c0c,0x1000c0c,0xc0c0c0c,0x3020c0c
.long 0xc0c0100,0xc0c0c0c,0xc0c0c0c,0xc0c0c0c,0x1000c0c,0xc0c0c0c,0xc0c0c0c,0xc0c0c0c
.long 0xc0c0c0c,0xc0c0100,0xc0c0c0c,0xc0c0c0c,0xc0c0c0c,0x1000c0c,0xc0c0c0c,0xc0c0c0c
.long 0xc0c0100,0xc0c0c0c,0xc0c0302,0xc0c0c0c,0x1000c0c,0xc0c0c0c,0x3020c0c,0xc0c0c0c
.long 0xc0c0c0c,0xc0c0100,0xc0c0c0c,0xc0c0302,0xc0c0c0c,0x1000c0c,0xc0c0c0c,0x3020c0c
.long 48,11696,23344,34992,256,11904,23552,35200
.long 464,12112,23760,35408,672,12320,23968,35616
.long 880,12528,24176,35824,1088,12736,24384,36032
.long 1296,12944,24592,36240,160888,160888,160888,160888
.long 1504,13152,24800,160792,1712,13360,25008,160808
.long 1920,13568,25216,160824,2128,13776,25424,160840
.long 2336,13984,25632,160856,2544,14192,25840,160872
.long 2752,14400,26048,160888,160776,160776,160776,160776
.long 2960,14608,26256,36448,3168,14816,26464,36656
.long 3376,15024,26672,36864,3584,15232,26880,37072
.long 3792,15440,27088,37280,4000,15648,27296,37488
.long 4208,15856,27504,37696,160888,160888,160888,160888
.long 4416,16064,27712,160792,4624,16272,27920,160808
.long 4832,16480,28128,160824,5040,16688,28336,160840
.long 5248,16896,28544,160856,5456,17104,28752,160872
.long 5664,17312,28960,160888,160776,160776,160776,160776
.long 5872,17520,29168,37904,6080,17728,29376,38112
.long 6288,17936,29584,38320,6496,18144,29792,38528
.long 6704,18352,30000,38736,6912,18560,30208,38944
.long 7120,18768,30416,39152,160888,160888,160888,160888
.long 7328,18976,30624,160792,7536,19184,30832,160808
.long 7744,19392,31040,160824,7952,19600,31248,160840
.long 8160,19808,31456,160856,8368,20016,31664,160872
.long 8576,20224,31872,160888,160776,160776,160776,160776
.long 8784,20432,32080,39360,8992,20640,32288,39568
.long 9200,20848,32496,39776,9408,21056,32704,159792
.long 9616,21264,32912,159984,9824,21472,33120,160176
.long 10032,21680,33328,160368,160888,160888,160888,160888
.long 10240,21888,33536,160792,10448,22096,33744,160808
.long 10656,22304,33952,160824,10864,22512,34160,160840
.long 11072,22720,34368,160856,11280,22928,34576,160872
.long 11488,23136,34784,160888,160776,160776,160776,160776
.long 6656,89088,159744,160512,6864,89096,159936,160512
.long 7072,89104,160128,160512,7280,89112,160320,160512
.long 9984,89152,160512,160512,10192,89160,160512,160512
.long 10400,89168,160512,160512,10608,89176,160512,160512
.long 7488,89216,160512,159744,7696,89224,160512,159936
.long 7904,89232,160512,160128,8112,89240,160512,160320
.long 10816,89280,160512,160512,11024,89288,160512,160512
.long 11232,89296,160512,160512,11440,89304,160512,160512
.long 8320,89120,160512,160512,8528,89128,160512,160512
.long 8736,89136,160512,160512,8944,89144,160512,160512
.long 11648,89184,159744,160512,11856,89192,159936,160512
.long 12064,89200,160128,160512,12272,89208,160320,160512
.long 9152,89248,160512,160512,9360,89256,160512,160512
.long 9568,89264,160512,160512,9776,89272,160512,160512
.long 12480,89312,160512,159744,12688,89320,160512,159936
.long 12896,89328,160512,160128,13104,89336,160512,160320
.long 6672,89600,159760,160512,6880,89608,159952,160512
.long 7088,89616,160144,160512,7296,89624,160336,160512
.long 10000,89664,160512,160512,10208,89672,160512,160512
.long 10416,89680,160512,160512,10624,89688,160512,160512
.long 7504,89728,160512,159760,7712,89736,160512,159952
.long 7920,89744,160512,160144,8128,89752,160512,160336
.long 10832,89792,160512,160512,11040,89800,160512,160512
.long 11248,89808,160512,160512,11456,89816,160512,160512
.long 8336,89632,160512,160512,8544,89640,160512,160512
.long 8752,89648,160512,160512,8960,89656,160512,160512
.long 11664,89696,159760,160512,11872,89704,159952,160512
.long 12080,89712,160144,160512,12288,89720,160336,160512
.long 9168,89760,160512,160512,9376,89768,160512,160512
.long 9584,89776,160512,160512,9792,89784,160512,160512
.long 12496,89824,160512,159760,12704,89832,160512,159952
.long 12912,89840,160512,160144,13120,89848,160512,160336
.long 26688,26704,133504,27032,27104,27120,133920,27448
.long 27520,27536,134336,27864,27936,27952,134752,28280
.long 28368,28352,135184,28680,28784,28768,135600,29096
.long 29200,29184,136016,29512,29616,29600,136432,29928
.long 30016,30032,136832,30360,30432,30448,137248,30776
.long 30848,30864,137664,31192,31264,31280,138080,31608
.long 31696,31680,138512,32008,32112,32096,138928,32424
.long 32528,32512,139344,32840,32944,32928,139760,33256
.long 33344,33360,140160,33688,33760,33776,140576,34104
.long 34176,34192,140992,34520,34592,34608,141408,34936
.long 35024,35008,141840,35336,35440,35424,142256,35752
.long 35856,35840,142672,36168,36272,36256,143088,36584
.long 36672,36688,143488,37016,37088,37104,143904,37432
.long 37504,37520,144320,37848,37920,37936,144736,38264
.long 38352,38336,145168,38664,38768,38752,145584,39080
.long 39184,39168,146000,39496,39600,39584,146416,39912
.long 26720,26736,186752,27036,27136,27152,187168,27452
.long 27552,27568,187584,27868,27968,27984,188000,28284
.long 28400,28384,188432,28684,28816,28800,188848,29100
.long 29232,29216,189264,29516,29648,29632,189680,29932
.long 30048,30064,190080,30364,30464,30480,190496,30780
.long 30880,30896,190912,31196,31296,31312,191328,31612
.long 31728,31712,191760,32012,32144,32128,192176,32428
.long 32560,32544,192592,32844,32976,32960,193008,33260
.long 33376,33392,193408,33692,33792,33808,193824,34108
.long 34208,34224,194240,34524,34624,34640,194656,34940
.long 35056,35040,195088,35340,35472,35456,195504,35756
.long 35888,35872,195920,36172,36304,36288,196336,36588
.long 36704,36720,196736,37020,37120,37136,197152,37436
.long 37536,37552,197568,37852,37952,37968,197984,38268
.long 38384,38368,198416,38668,38800,38784,198832,39084
.long 39216,39200,199248,39500,39632,39616,199664,39916
.long 216576,217536,258624,302400,216960,559296,259008,302784
.long 217344,559680,259392,303168,559104,560064,259776,303552
.long 559488,560448,260160,0x7fffffff,559872,560832,260544,0x7fffffff
.long 560256,561216,301056,0x7fffffff,560640,561600,301440,0x7fffffff
.long 561024,258048,301824,0x7fffffff,561408,258432,302208,0x7fffffff
.long 215232,258816,302592,0x7fffffff,215616,259200,302976,0x7fffffff
.long 216000,259584,303360,0x7fffffff,216384,259968,301248,0x7fffffff
.long 216768,260352,301632,0x7fffffff,217152,258240,302016,0x7fffffff
.long 216592,217552,258640,302416,216976,559312,259024,302800
.long 217360,559696,259408,303184,559120,560080,259792,303568
.long 559504,560464,260176,0x7fffffff,559888,560848,260560,0x7fffffff
.long 560272,561232,301072,0x7fffffff,560656,561616,301456,0x7fffffff
.long 561040,258064,301840,0x7fffffff,561424,258448,302224,0x7fffffff
.long 215248,258832,302608,0x7fffffff,215632,259216,302992,0x7fffffff
.long 216016,259600,303376,0x7fffffff,216400,259984,301264,0x7fffffff
.long 216784,260368,301648,0x7fffffff,217168,258256,302032,0x7fffffff
.long 216608,217568,258656,302432,216992,559328,259040,302816
.long 217376,559712,259424,303200,559136,560096,259808,303584
.long 559520,560480,260192,0x7fffffff,559904,560864,260576,0x7fffffff
.long 560288,561248,301088,0x7fffffff,560672,561632,301472,0x7fffffff
.long 561056,258080,301856,0x7fffffff,561440,258464,302240,0x7fffffff
.long 215264,258848,302624,0x7fffffff,215648,259232,303008,0x7fffffff
.long 216032,259616,303392,0x7fffffff,216416,260000,301280,0x7fffffff
.long 216800,260384,301664,0x7fffffff,217184,258272,302048,0x7fffffff
.long 216624,217584,258672,302448,217008,559344,259056,302832
.long 217392,559728,259440,303216,559152,560112,259824,303600
.long 559536,560496,260208,0x7fffffff,559920,560880,260592,0x7fffffff
.long 560304,561264,301104,0x7fffffff,560688,561648,301488,0x7fffffff
.long 561072,258096,301872,0x7fffffff,561456,258480,302256,0x7fffffff
.long 215280,258864,302640,0x7fffffff,215664,259248,303024,0x7fffffff
.long 216048,259632,303408,0x7fffffff,216432,260016,301296,0x7fffffff
.long 216816,260400,301680,0x7fffffff,217200,258288,302064,0x7fffffff
.long 18432,38912,59392,320,18448,38928,59408,326
.long 18464,38944,59424,332,18480,38960,59440,338
.long 18496,38976,59456,344,18512,38992,59472,350
.long 18528,39008,59488,356,18544,39024,59504,362
.long 18560,39040,59520,368,18576,39056,59536,374
.long 18592,39072,59552,380,18608,39088,59568,514
.long 18624,39104,59584,520,18640,39120,59600,526
.long 18656,39136,59616,532,18672,39152,59632,538
.long 18688,39168,59648,324,18704,39184,59664,330
.long 18720,39200,59680,336,18736,39216,59696,342
.long 18752,39232,59712,348,18768,39248,59728,354
.long 18784,39264,59744,360,18800,39280,59760,366
.long 18816,39296,59776,372,18832,39312,59792,378
.long 18848,39328,59808,512,18864,39344,59824,518
.long 18880,39360,59840,524,18896,39376,59856,530
.long 18912,39392,59872,536,18928,39408,59888,542
.long 18944,39424,59904,322,18960,39440,59920,328
.long 18976,39456,59936,334,18992,39472,59952,340
.long 19008,39488,59968,346,19024,39504,59984,352
.long 19040,39520,60000,358,19056,39536,60016,364
.long 19072,39552,60032,370,19088,39568,60048,376
.long 19104,39584,60064,382,19120,39600,60080,516
.long 19136,39616,60096,522,19152,39632,60112,528
.long 19168,39648,60128,534,19184,39664,60144,540
.long 19200,39680,60160,324,19216,39696,60176,330
.long 19232,39712,60192,336,19248,39728,60208,342
.long 19264,39744,60224,348,19280,39760,60240,354
.long 19296,39776,60256,360,19312,39792,60272,366
.long 19328,39808,60288,372,19344,39824,60304,378
.long 19360,39840,60320,512,19376,39856,60336,518
.long 19392,39872,60352,524,19408,39888,60368,530
.long 19424,39904,60384,536,19440,39920,60400,542
.long 120200,120208,133528,163360,120616,120624,133944,163372
.long 121032,121040,134360,163384,121032,121040,134776,163396
.long 121448,121456,135176,163408,121880,121856,135592,163420
.long 122296,122272,136008,163432,122296,122272,136424,163444
.long 122712,122688,136856,163456,123128,123104,137272,163468
.long 123528,123536,137688,163480,123528,123536,138104,163492
.long 123944,123952,138504,163504,124360,124368,138920,163516
.long 124776,124784,139336,163528,124776,124784,139752,163540
.long 125208,125184,140184,163552,125624,125600,140600,163564
.long 126040,126016,141016,163576,126040,126016,141432,163588
.long 126456,126432,141832,163600,126856,126864,142248,163612
.long 127272,127280,142664,163624,127272,127280,143080,163636
.long 127688,127696,143512,163648,128104,128112,143928,163660
.long 128536,128512,144344,163672,128536,128512,144760,163684
.long 128952,128928,145160,163696,129368,129344,145576,163708
.long 129784,129760,145992,163720,129784,129760,146408,163732
.long 130184,130192,133532,163360,130600,130608,133948,163372
.long 131016,131024,134364,163384,131016,131024,134780,163396
.long 131432,131440,135180,163408,131864,131840,135596,163420
.long 132280,132256,136012,163432,132280,132256,136428,163444
.long 132696,132672,136860,163456,133112,133088,137276,163468
.long 133512,133520,137692,163480,133512,133520,138108,163492
.long 133928,133936,138508,163504,134344,134352,138924,163516
.long 134760,134768,139340,163528,134760,134768,139756,163540
.long 135192,135168,140188,163552,135608,135584,140604,163564
.long 136024,136000,141020,163576,136024,136000,141436,163588
.long 136440,136416,141836,163600,136840,136848,142252,163612
.long 137256,137264,142668,163624,137256,137264,143084,163636
.long 137672,137680,143516,163648,138088,138096,143932,163660
.long 138520,138496,144348,163672,138520,138496,144764,163684
.long 138936,138912,145164,163696,139352,139328,145580,163708
.long 139768,139744,145996,163720,139768,139744,146412,163732
.long 288,40320,0,0,296,40328,8,8
.long 304,40336,16,16,312,40344,24,24
.long 704,40736,192,192,712,40744,200,200
.long 720,40752,208,208,728,40760,216,216
.long 1120,41152,384,384,1128,41160,392,392
.long 1136,41168,400,400,1144,41176,408,408
.long 1536,41568,576,576,1544,41576,584,584
.long 1552,41584,592,592,1560,41592,600,600
.long 1968,42000,800,736,1976,42008,808,744
.long 1952,41984,816,752,1960,41992,824,760
.long 2384,42416,992,928,2392,42424,1000,936
.long 2368,42400,1008,944,2376,42408,1016,952
.long 2800,42832,1184,1120,2808,42840,1192,1128
.long 2784,42816,1200,1136,2792,42824,1208,1144
.long 3216,43248,1376,1312,3224,43256,1384,1320
.long 3200,43232,1392,1328,3208,43240,1400,1336
.long 3616,43648,1536,1536,3624,43656,1544,1544
.long 3632,43664,1552,1552,3640,43672,1560,1560
.long 4032,44064,1728,1728,4040,44072,1736,1736
.long 4048,44080,1744,1744,4056,44088,1752,1752
.long 4448,44480,1920,1920,4456,44488,1928,1928
.long 4464,44496,1936,1936,4472,44504,1944,1944
.long 4864,44896,2112,2112,4872,44904,2120,2120
.long 4880,44912,2128,2128,4888,44920,2136,2136
.long 5296,45328,2336,2272,5304,45336,2344,2280
.long 5280,45312,2352,2288,5288,45320,2360,2296
.long 5712,45744,2528,2464,5720,45752,2536,2472
.long 5696,45728,2544,2480,5704,45736,2552,2488
.long 6128,46160,2720,2656,6136,46168,2728,2664
.long 6112,46144,2736,2672,6120,46152,2744,2680
.long 6544,46576,2912,2848,6552,46584,2920,2856
.long 6528,46560,2928,2864,6536,46568,2936,2872
.long 161920,162088,162260,162944,161920,162088,162260,162956
.long 161920,162088,162260,162968,161920,162088,162260,162980
.long 161920,162092,162260,162992,161920,162092,162260,163004
.long 161920,162092,162260,163016,161920,162092,162260,163028
.long 161920,162092,162264,163040,161920,162092,162264,163052
.long 161920,162092,162264,163064,161920,162092,162264,163076
.long 161924,162092,162264,163088,161924,162092,162264,163100
.long 161924,162092,162264,163112,161924,162092,162264,163124
.long 161924,162096,162264,162952,161924,162096,162264,162964
.long 161924,162096,162264,162976,161924,162096,162264,162988
.long 161924,162096,162268,163000,161924,162096,162268,163012
.long 161924,162096,162268,163024,161924,162096,162268,163036
.long 161928,162096,162268,163048,161928,162096,162268,163060
.long 161928,162096,162268,163072,161928,162096,162268,163084
.long 161928,162100,162268,163096,161928,162100,162268,163108
.long 161928,162100,162268,163120,161928,162100,162268,163132
.long 161928,162100,162272,162948,161928,162100,162272,162960
.long 161928,162100,162272,162972,161928,162100,162272,162984
.long 161932,162100,162272,162996,161932,162100,162272,163008
.long 161932,162100,162272,163020,161932,162100,162272,163032
.long 161932,162104,162272,163044,161932,162104,162272,163056
.long 161932,162104,162272,163068,161932,162104,162272,163080
.long 161932,162104,162276,163092,161932,162104,162276,163104
.long 161932,162104,162276,163116,161932,162104,162276,163128
.long 161936,162104,162276,162952,161936,162104,162276,162964
.long 161936,162104,162276,162976,161936,162104,162276,162988
.long 161936,162108,162276,163000,161936,162108,162276,163012
.long 161936,162108,162276,163024,161936,162108,162276,163036
.long 161936,162108,162280,163048,161936,162108,162280,163060
.long 161936,162108,162280,163072,161936,162108,162280,163084
.long 161940,162108,162280,163096,161940,162108,162280,163108
.long 161940,162108,162280,163120,161940,162108,162280,163132
.long 6144,14336,22560,1536,6160,14352,22576,1552
.long 6176,14368,22528,1568,6192,14384,22544,1584
.long 6208,14400,22624,1600,6224,14416,22640,1616
.long 6240,14432,22592,1632,6256,14448,22608,1648
.long 6272,14464,22688,1664,6288,14480,22704,1680
.long 6304,14496,22656,1696,6320,14512,22672,1712
.long 6336,14528,22752,1728,6352,14544,22768,1744
.long 6368,14560,22720,1760,6384,14576,22736,1776
.long 6400,14624,22816,3584,6416,14640,22832,3600
.long 6432,14592,22784,3616,6448,14608,22800,3632
.long 6464,14688,22880,3648,6480,14704,22896,3664
.long 6496,14656,22848,3680,6512,14672,22864,3696
.long 6528,14752,22944,3712,6544,14768,22960,3728
.long 6560,14720,22912,3744,6576,14736,22928,3760
.long 6592,14816,23008,3776,6608,14832,23024,3792
.long 6624,14784,22976,3808,6640,14800,22992,3824
.long 6656,14880,23040,5632,6672,14896,23056,5648
.long 6688,14848,23072,5664,6704,14864,23088,5680
.long 6720,14944,23104,5696,6736,14960,23120,5712
.long 6752,14912,23136,5728,6768,14928,23152,5744
.long 6784,15008,23168,5760,6800,15024,23184,5776
.long 6816,14976,23200,5792,6832,14992,23216,5808
.long 6848,15072,23232,5824,6864,15088,23248,5840
.long 6880,15040,23264,5856,6896,15056,23280,5872
.long 6944,15136,23296,7680,6960,15152,23312,7696
.long 6912,15104,23328,7712,6928,15120,23344,7728
.long 7008,15200,23360,7744,7024,15216,23376,7760
.long 6976,15168,23392,7776,6992,15184,23408,7792
.long 7072,15264,23424,7808,7088,15280,23440,7824
.long 7040,15232,23456,7840,7056,15248,23472,7856
.long 7136,15328,23488,7872,7152,15344,23504,7888
.long 7104,15296,23520,7904,7120,15312,23536,7920
.long 16256,0,0,0,0x3f800000,0,0,0
.long 0,16256,0,0,0,0x3f800000,0,0
.long 0,0,16256,0,0,0,0x3f800000,0
.long 0,0,0,16256,0,0,0,0x3f800000
.long 0,0,0,0,0,0,0,0
.long 0,0,0,0,0,0,0,0
.long 0,0,0,0,0,0,0,0
.long 0,0,0,0,0,0,0,0
.long 0,0,0,0,0,0,0,0
.long 0,0,0,0,0,0,0,0
.long 0,0,0,0,0,0,0,0
.long 0,0,0,0,0,0,0,0
.long 16256,0,0,0,0x3f800000,0,0,0
.long 0,16256,0,0,0,0x3f800000,0,0
.long 0,0,16256,0,0,0,0x3f800000,0
.long 0,0,0,16256,0,0,0,0x3f800000
.long 0,0,0,0,0,0,0,0
.long 0,0,0,0,0,0,0,0
.long 0,0,0,0,0,0,0,0
.long 0,0,0,0,0,0,0,0
.long 0,0,0,0,0,0,0,0
.long 0,0,0,0,0,0,0,0
.long 0,0,0,0,0,0,0,0
.long 0,0,0,0,0,0,0,0
.long 0,0,0,0,0,0,0,0
.long 0,0,0,0,0,0,0,0
.long 0,0,0,0,0,0,0,0
.long 0,0,0,0,0,0,0,0
.long 0,0,0,0,0,0,0,0
.long 0,0,0,0,0,0,0,0
.long 0,0,0,0,0,0,0,0
.long 0,0,0,0,0,0,0,0
.long 0,0,0,0,0,0,0,0
.long 0,0,0,0,0,0,0,0
.long 0,0,0,0,0,0,0,0
.long 0,0,0,0,0,0,0,0
.long 0,0,0,0,0,0,0,0
.long 0,0,0,0,0,0,0,0
.long 0,0,0,0,0,0,0,0
.long 0,0,0,0,0,0,0,0
.long 0,0,0,0,0,0,0,0
.long 0,0,0,0,0,0,0,0
.long 0,0,0,0,0,0,0,0
.long 0,0,0,0,0,0,0,0
.long 0,0,0,0,0,0,0,0
.long 0,0,0,0,0,0,0,0
.long 0,0,0,0,0,0,0,0
.long 0,0,0,0,0,0,0,0
.long 16256,0,0,0,0x3f800000,0,0,0
.long 0,16256,0,0,0,0x3f800000,0,0
.long 0,0,16256,0,0,0,0x3f800000,0
.long 0,0,0,16256,0,0,0,0x3f800000
.long 0,0,0,0,0,0,0,0
.long 0,0,0,0,0,0,0,0
.long 0,0,0,0,0,0,0,0
.long 0,0,0,0,0,0,0,0
.long 0,0,0,0,0,0,0,0
.long 0,0,0,0,0,0,0,0
.long 0,0,0,0,0,0,0,0
.long 0,0,0,0,0,0,0,0
.long 16256,0,0,0,0x3f800000,0,0,0
.long 0,16256,0,0,0,0x3f800000,0,0
.long 0,0,16256,0,0,0,0x3f800000,0
.long 0,0,0,16256,0,0,0,0x3f800000
.long 109824,109824,4800,163360,110032,109840,5200,163360
.long 110240,109856,5600,163360,110448,109872,6000,163360
.long 110656,109888,4864,163360,110864,109904,5264,163360
.long 111072,109920,5664,163360,111280,109936,6064,163360
.long 111488,109952,4928,163360,111696,109968,5328,163360
.long 111904,109984,5728,163360,112112,110000,6128,163360
.long 112320,110032,14528,163360,112528,110048,14544,163360
.long 112736,110064,14560,163360,112944,110080,14576,163360
.long 109832,110096,4816,163376,110040,110112,5216,163376
.long 110248,110128,5616,163376,110456,110144,6016,163376
.long 110664,110160,4880,163376,110872,110176,5280,163376
.long 111080,110192,5680,163376,111288,110208,6080,163376
.long 111496,110240,4944,163376,111704,110256,5344,163376
.long 111912,110272,5744,163376,112120,110288,6144,163376
.long 112328,110304,14784,163376,112536,110320,14800,163376
.long 112744,110336,14816,163376,112952,110352,14832,163376
.long 109840,110368,4832,163392,110048,110384,5232,163392
.long 110256,110400,5632,163392,110464,110416,6032,163392
.long 110672,110448,4896,163392,110880,110464,5296,163392
.long 111088,110480,5696,163392,111296,110496,6096,163392
.long 111504,110512,4960,163392,111712,110528,5360,163392
.long 111920,110544,5760,163392,112128,110560,6160,163392
.long 112336,110576,15040,163392,112544,110592,15056,163392
.long 112752,110608,15072,163392,112960,110624,15088,163392
.long 109848,110448,4848,163408,110056,110464,5248,163408
.long 110264,110480,5648,163408,110472,110496,6048,163408
.long 110680,110512,4912,163408,110888,110528,5312,163408
.long 111096,110544,5712,163408,111304,110560,6112,163408
.long 111512,110576,4976,163408,111720,110592,5376,163408
.long 111928,110608,5776,163408,112136,110624,6176,163408
.long 112344,110448,15296,163408,112552,110464,15312,163408
.long 112760,110480,15328,163408,112968,110496,15344,163408
.long 216576,559488,217536,560448,216592,559504,217552,560464
.long 216608,559520,217568,560480,216624,559536,217584,560496
.long 216640,559552,217600,560512,216656,559568,217616,560528
.long 216672,559584,217632,560544,216688,559600,217648,560560
.long 216704,559616,217664,560576,216720,559632,217680,560592
.long 216736,559648,217696,560608,216752,559664,217712,560624
.long 216960,559872,559296,560832,216976,559888,559312,560848
.long 216992,559904,559328,560864,217008,559920,559344,560880
.long 217024,559936,559360,560896,217040,559952,559376,560912
.long 217056,559968,559392,560928,217072,559984,559408,560944
.long 217088,560000,559424,560960,217104,560016,559440,560976
.long 217120,560032,559456,560992,217136,560048,559472,561008
.long 217344,560256,559680,561216,217360,560272,559696,561232
.long 217376,560288,559712,561248,217392,560304,559728,561264
.long 217408,560320,559744,561280,217424,560336,559760,561296
.long 217440,560352,559776,561312,217456,560368,559792,561328
.long 217472,560384,559808,561344,217488,560400,559824,561360
.long 217504,560416,559840,561376,217520,560432,559856,561392
.long 559104,560640,560064,561600,559120,560656,560080,561616
.long 559136,560672,560096,561632,559152,560688,560112,561648
.long 559168,560704,560128,561664,559184,560720,560144,561680
.long 559200,560736,560160,561696,559216,560752,560176,561712
.long 559232,560768,560192,561728,559248,560784,560208,561744
.long 559264,560800,560224,561760,559280,560816,560240,561776
.long 0x7fffffff,0x7fffffff,0x7fffffff,0x7fffffff,0x7fffffff,0x7fffffff,0x7fffffff,0x7fffffff
.long 0x7fffffff,0x7fffffff,0x7fffffff,0x7fffffff,0x7fffffff,0x7fffffff,0x7fffffff,0x7fffffff
.long 0x7fffffff,0x7fffffff,0x7fffffff,0x7fffffff,0x7fffffff,0x7fffffff,0x7fffffff,0x7fffffff
.long 0x7fffffff,0x7fffffff,0x7fffffff,0x7fffffff,0x7fffffff,0x7fffffff,0x7fffffff,0x7fffffff
.long 0x7fffffff,0x7fffffff,0x7fffffff,0x7fffffff,0x7fffffff,0x7fffffff,0x7fffffff,0x7fffffff
.long 0x7fffffff,0x7fffffff,0x7fffffff,0x7fffffff,0x7fffffff,0x7fffffff,0x7fffffff,0x7fffffff
.long 0x7fffffff,0x7fffffff,0x7fffffff,0x7fffffff,0x7fffffff,0x7fffffff,0x7fffffff,0x7fffffff
.long 0x7fffffff,0x7fffffff,0x7fffffff,0x7fffffff,0x7fffffff,0x7fffffff,0x7fffffff,0x7fffffff
.long 258624,260160,302400,0,258640,260176,302416,32
.long 258656,260192,302432,64,258672,260208,302448,96
.long 258688,260224,302464,128,258704,260240,302480,160
.long 258720,260256,302496,192,258736,260272,302512,224
.long 258752,260288,302528,256,258768,260304,302544,288
.long 258784,260320,302560,320,258800,260336,302576,352
.long 259008,260544,302784,400,259024,260560,302800,432
.long 259040,260576,302816,464,259056,260592,302832,496
.long 259072,260608,302848,528,259088,260624,302864,560
.long 259104,260640,302880,592,259120,260656,302896,624
.long 259136,260672,302912,656,259152,260688,302928,688
.long 259168,260704,302944,720,259184,260720,302960,752
.long 259392,301056,303168,800,259408,301072,303184,832
.long 259424,301088,303200,864,259440,301104,303216,896
.long 259456,301120,303232,928,259472,301136,303248,960
.long 259488,301152,303264,992,259504,301168,303280,1024
.long 259520,301184,303296,1056,259536,301200,303312,1088
.long 259552,301216,303328,1120,259568,301232,303344,1152
.long 259776,301440,303552,1200,259792,301456,303568,1232
.long 259808,301472,303584,1264,259824,301488,303600,1296
.long 259840,301504,303616,1328,259856,301520,303632,1360
.long 259872,301536,303648,1392,259888,301552,303664,1424
.long 259904,301568,303680,1456,259920,301584,303696,1488
.long 259936,301600,303712,1520,259952,301616,303728,1552
.long 0x7fffffff,0x7fffffff,0x7fffffff,1200,0x7fffffff,0x7fffffff,0x7fffffff,1232
.long 0x7fffffff,0x7fffffff,0x7fffffff,1264,0x7fffffff,0x7fffffff,0x7fffffff,1296
.long 0x7fffffff,0x7fffffff,0x7fffffff,1328,0x7fffffff,0x7fffffff,0x7fffffff,1360
.long 0x7fffffff,0x7fffffff,0x7fffffff,1392,0x7fffffff,0x7fffffff,0x7fffffff,1424
.long 0x7fffffff,0x7fffffff,0x7fffffff,1456,0x7fffffff,0x7fffffff,0x7fffffff,1488
.long 0x7fffffff,0x7fffffff,0x7fffffff,1520,0x7fffffff,0x7fffffff,0x7fffffff,1552
.long 0x7fffffff,0x7fffffff,0x7fffffff,1200,0x7fffffff,0x7fffffff,0x7fffffff,1232
.long 0x7fffffff,0x7fffffff,0x7fffffff,1264,0x7fffffff,0x7fffffff,0x7fffffff,1296
.long 150584,150584,56,30744,150376,150376,120,30808
.long 149128,160776,184,30872,148920,160568,248,30936
.long 150792,150792,296,30984,150584,150584,360,31048
.long 149336,160984,424,31112,149128,160776,424,31112
.long 152040,152040,30744,61496,151832,151832,30808,61560
.long 150584,150584,30872,61624,150376,150376,30936,61688
.long 152248,152248,30984,61736,152040,152040,31048,61800
.long 150792,150792,31112,61864,150584,150584,31112,61864
.long 151000,151000,120,30808,150792,150792,184,30872
.long 149544,161192,248,30936,149336,160984,296,30984
.long 151208,151208,360,31048,151000,151000,424,31112
.long 149752,161400,488,31176,149544,161192,488,31176
.long 152456,152456,30808,61560,152248,152248,30872,61624
.long 151000,151000,30936,61688,150792,150792,30984,61736
.long 152664,152664,31048,61800,152456,152456,31112,61864
.long 151208,151208,31176,61928,151000,151000,31176,61928
.long 151416,151416,184,30872,151208,151208,248,30936
.long 149960,161608,296,30984,149752,161400,360,31048
.long 151624,151624,424,31112,151416,151416,488,31176
.long 150168,161816,568,31256,149960,161608,568,31256
.long 152872,152872,30872,61624,152664,152664,30936,61688
.long 151416,151416,30984,61736,151208,151208,31048,61800
.long 153080,153080,31112,61864,152872,152872,31176,61928
.long 151624,151624,31256,62008,151416,151416,31256,62008
.long 151832,151832,248,30936,151624,151624,296,30984
.long 150376,162024,360,31048,150168,161816,424,31112
.long 152040,152040,488,31176,151832,151832,568,31256
.long 150584,162232,632,31320,150376,162024,632,31320
.long 153288,153288,30936,61688,153080,153080,30984,61736
.long 151832,151832,31048,61800,151624,151624,31112,61864
.long 153496,153496,31176,61928,153288,153288,31256,62008
.long 152040,152040,31320,62072,151832,151832,31320,62072
.long 0xc0c0100,0xc0c0c0c,0xc0c0302,0xc0c0c0c,0x1000c0c,0xc0c0c0c,0x3020c0c,0xc0c0c0c
.long 0xc0c0c0c,0xc0c0100,0xc0c0c0c,0xc0c0302,0xc0c0c0c,0x1000c0c,0xc0c0c0c,0x3020c0c
.long 0xc0c0c0c,0xc0c0c0c,0xc0c0302,0xc0c0c0c,0xc0c0c0c,0xc0c0c0c,0x3020c0c,0xc0c0c0c
.long 0xc0c0c0c,0xc0c0c0c,0xc0c0c0c,0xc0c0302,0xc0c0c0c,0xc0c0c0c,0xc0c0c0c,0x3020c0c
.long 0xc0c0100,0xc0c0c0c,0xc0c0302,0xc0c0c0c,0x1000c0c,0xc0c0c0c,0x3020c0c,0xc0c0c0c
.long 0xc0c0c0c,0xc0c0100,0xc0c0c0c,0xc0c0302,0xc0c0c0c,0x1000c0c,0xc0c0c0c,0x3020c0c
.long 0xc0c0c0c,0xc0c0c0c,0xc0c0302,0xc0c0c0c,0xc0c0c0c,0xc0c0c0c,0x3020c0c,0xc0c0c0c
.long 0xc0c0c0c,0xc0c0c0c,0xc0c0c0c,0xc0c0302,0xc0c0c0c,0xc0c0c0c,0xc0c0c0c,0x3020c0c
.long 0xc0c0100,0xc0c0c0c,0xc0c0302,0xc0c0c0c,0x1000c0c,0xc0c0c0c,0x3020c0c,0xc0c0c0c
.long 0xc0c0c0c,0xc0c0100,0xc0c0c0c,0xc0c0302,0xc0c0c0c,0x1000c0c,0xc0c0c0c,0x3020c0c
.long 0xc0c0100,0xc0c0c0c,0xc0c0302,0xc0c0c0c,0x1000c0c,0xc0c0c0c,0x3020c0c,0xc0c0c0c
.long 0xc0c0c0c,0xc0c0100,0xc0c0c0c,0xc0c0302,0xc0c0c0c,0x1000c0c,0xc0c0c0c,0x3020c0c
.long 0xc0c0100,0xc0c0c0c,0xc0c0302,0xc0c0c0c,0x1000c0c,0xc0c0c0c,0x3020c0c,0xc0c0c0c
.long 0xc0c0c0c,0xc0c0100,0xc0c0c0c,0xc0c0302,0xc0c0c0c,0x1000c0c,0xc0c0c0c,0x3020c0c
.long 0xc0c0100,0xc0c0c0c,0xc0c0302,0xc0c0c0c,0x1000c0c,0xc0c0c0c,0x3020c0c,0xc0c0c0c
.long 0xc0c0c0c,0xc0c0100,0xc0c0c0c,0xc0c0302,0xc0c0c0c,0x1000c0c,0xc0c0c0c,0x3020c0c
.long 0xc0c0100,0xc0c0c0c,0xc0c0302,0xc0c0c0c,0x1000c0c,0xc0c0c0c,0x3020c0c,0xc0c0c0c
.long 0xc0c0c0c,0xc0c0100,0xc0c0c0c,0xc0c0302,0xc0c0c0c,0x1000c0c,0xc0c0c0c,0x3020c0c
.long 0xc0c0100,0xc0c0c0c,0xc0c0302,0xc0c0c0c,0x1000c0c,0xc0c0c0c,0x3020c0c,0xc0c0c0c
.long 0xc0c0c0c,0xc0c0100,0xc0c0c0c,0xc0c0302,0xc0c0c0c,0x1000c0c,0xc0c0c0c,0x3020c0c
.long 0xc0c0100,0xc0c0c0c,0xc0c0302,0xc0c0c0c,0x1000c0c,0xc0c0c0c,0x3020c0c,0xc0c0c0c
.long 0xc0c0c0c,0xc0c0100,0xc0c0c0c,0xc0c0302,0xc0c0c0c,0x1000c0c,0xc0c0c0c,0x3020c0c
.long 0xc0c0100,0xc0c0c0c,0xc0c0302,0xc0c0c0c,0x1000c0c,0xc0c0c0c,0x3020c0c,0xc0c0c0c
.long 0xc0c0c0c,0xc0c0100,0xc0c0c0c,0xc0c0302,0xc0c0c0c,0x1000c0c,0xc0c0c0c,0x3020c0c
.long 0xc0c0100,0xc0c0c0c,0xc0c0c0c,0xc0c0c0c,0x1000c0c,0xc0c0c0c,0xc0c0c0c,0xc0c0c0c
.long 0xc0c0c0c,0xc0c0100,0xc0c0c0c,0xc0c0c0c,0xc0c0c0c,0x1000c0c,0xc0c0c0c,0xc0c0c0c
.long 0xc0c0100,0xc0c0c0c,0xc0c0302,0xc0c0c0c,0x1000c0c,0xc0c0c0c,0x3020c0c,0xc0c0c0c
.long 0xc0c0c0c,0xc0c0100,0xc0c0c0c,0xc0c0302,0xc0c0c0c,0x1000c0c,0xc0c0c0c,0x3020c0c
.long 0xc0c0100,0xc0c0c0c,0xc0c0c0c,0xc0c0c0c,0x1000c0c,0xc0c0c0c,0xc0c0c0c,0xc0c0c0c
.long 0xc0c0c0c,0xc0c0100,0xc0c0c0c,0xc0c0c0c,0xc0c0c0c,0x1000c0c,0xc0c0c0c,0xc0c0c0c
.long 0xc0c0100,0xc0c0c0c,0xc0c0302,0xc0c0c0c,0x1000c0c,0xc0c0c0c,0x3020c0c,0xc0c0c0c
.long 0xc0c0c0c,0xc0c0100,0xc0c0c0c,0xc0c0302,0xc0c0c0c,0x1000c0c,0xc0c0c0c,0x3020c0c
.long 56,11704,23352,35000,264,11912,23560,35208
.long 472,12120,23768,35416,680,12328,23976,35624
.long 888,12536,24184,35832,1096,12744,24392,36040
.long 1304,12952,24600,36248,160880,160880,160880,160880
.long 1512,13160,24808,160784,1720,13368,25016,160800
.long 1928,13576,25224,160816,2136,13784,25432,160832
.long 2344,13992,25640,160848,2552,14200,25848,160864
.long 2760,14408,26056,160880,160768,160768,160768,160768
.long 2968,14616,26264,36456,3176,14824,26472,36664
.long 3384,15032,26680,36872,3592,15240,26888,37080
.long 3800,15448,27096,37288,4008,15656,27304,37496
.long 4216,15864,27512,37704,160880,160880,160880,160880
.long 4424,16072,27720,160784,4632,16280,27928,160800
.long 4840,16488,28136,160816,5048,16696,28344,160832
.long 5256,16904,28552,160848,5464,17112,28760,160864
.long 5672,17320,28968,160880,160768,160768,160768,160768
.long 5880,17528,29176,37912,6088,17736,29384,38120
.long 6296,17944,29592,38328,6504,18152,29800,38536
.long 6712,18360,30008,38744,6920,18568,30216,38952
.long 7128,18776,30424,39160,160880,160880,160880,160880
.long 7336,18984,30632,160784,7544,19192,30840,160800
.long 7752,19400,31048,160816,7960,19608,31256,160832
.long 8168,19816,31464,160848,8376,20024,31672,160864
.long 8584,20232,31880,160880,160768,160768,160768,160768
.long 8792,20440,32088,39368,9000,20648,32296,39576
.long 9208,20856,32504,39784,9416,21064,32712,159800
.long 9624,21272,32920,159992,9832,21480,33128,160184
.long 10040,21688,33336,160376,160880,160880,160880,160880
.long 10248,21896,33544,160784,10456,22104,33752,160800
.long 10664,22312,33960,160816,10872,22520,34168,160832
.long 11080,22728,34376,160848,11288,22936,34584,160864
.long 11496,23144,34792,160880,160768,160768,160768,160768
.long 6656,95232,159744,160512,6864,95240,159936,160512
.long 7072,95248,160128,160512,7280,95256,160320,160512
.long 9984,95296,160512,160512,10192,95304,160512,160512
.long 10400,95312,160512,160512,10608,95320,160512,160512
.long 7488,95360,160512,159744,7696,95368,160512,159936
.long 7904,95376,160512,160128,8112,95384,160512,160320
.long 10816,95424,160512,160512,11024,95432,160512,160512
.long 11232,95440,160512,160512,11440,95448,160512,160512
.long 8320,95264,160512,160512,8528,95272,160512,160512
.long 8736,95280,160512,160512,8944,95288,160512,160512
.long 11648,95328,159744,160512,11856,95336,159936,160512
.long 12064,95344,160128,160512,12272,95352,160320,160512
.long 9152,95392,160512,160512,9360,95400,160512,160512
.long 9568,95408,160512,160512,9776,95416,160512,160512
.long 12480,95456,160512,159744,12688,95464,160512,159936
.long 12896,95472,160512,160128,13104,95480,160512,160320
.long 6672,95744,159760,160512,6880,95752,159952,160512
.long 7088,95760,160144,160512,7296,95768,160336,160512
.long 10000,95808,160512,160512,10208,95816,160512,160512
.long 10416,95824,160512,160512,10624,95832,160512,160512
.long 7504,95872,160512,159760,7712,95880,160512,159952
.long 7920,95888,160512,160144,8128,95896,160512,160336
.long 10832,95936,160512,160512,11040,95944,160512,160512
.long 11248,95952,160512,160512,11456,95960,160512,160512
.long 8336,95776,160512,160512,8544,95784,160512,160512
.long 8752,95792,160512,160512,8960,95800,160512,160512
.long 11664,95840,159760,160512,11872,95848,159952,160512
.long 12080,95856,160144,160512,12288,95864,160336,160512
.long 9168,95904,160512,160512,9376,95912,160512,160512
.long 9584,95920,160512,160512,9792,95928,160512,160512
.long 12496,95968,160512,159760,12704,95976,160512,159952
.long 12912,95984,160512,160144,13120,95992,160512,160336
.long 40000,40016,146816,40344,40416,40432,147232,40760
.long 40832,40848,147648,41176,41248,41264,148064,41592
.long 41680,41664,148496,41992,42096,42080,148912,42408
.long 42512,42496,149328,42824,42928,42912,149744,43240
.long 43328,43344,150144,43672,43744,43760,150560,44088
.long 44160,44176,150976,44504,44576,44592,151392,44920
.long 45008,44992,151824,45320,45424,45408,152240,45736
.long 45840,45824,152656,46152,46256,46240,153072,46568
.long 46656,46672,153472,47000,47072,47088,153888,47416
.long 47488,47504,154304,47832,47904,47920,154720,48248
.long 48336,48320,155152,48648,48752,48736,155568,49064
.long 49168,49152,155984,49480,49584,49568,156400,49896
.long 49984,50000,156800,50328,50400,50416,157216,50744
.long 50816,50832,157632,51160,51232,51248,158048,51576
.long 51664,51648,158480,51976,52080,52064,158896,52392
.long 52496,52480,159312,52808,52912,52896,159728,53224
.long 40032,40048,200064,40348,40448,40464,200480,40764
.long 40864,40880,200896,41180,41280,41296,201312,41596
.long 41712,41696,201744,41996,42128,42112,202160,42412
.long 42544,42528,202576,42828,42960,42944,202992,43244
.long 43360,43376,203392,43676,43776,43792,203808,44092
.long 44192,44208,204224,44508,44608,44624,204640,44924
.long 45040,45024,205072,45324,45456,45440,205488,45740
.long 45872,45856,205904,46156,46288,46272,206320,46572
.long 46688,46704,206720,47004,47104,47120,207136,47420
.long 47520,47536,207552,47836,47936,47952,207968,48252
.long 48368,48352,208400,48652,48784,48768,208816,49068
.long 49200,49184,209232,49484,49616,49600,209648,49900
.long 50016,50032,210048,50332,50432,50448,210464,50748
.long 50848,50864,210880,51164,51264,51280,211296,51580
.long 51696,51680,211728,51980,52112,52096,212144,52396
.long 52528,52512,212560,52812,52944,52928,212976,53228
.long 216672,217632,258720,302496,217056,559392,259104,302880
.long 217440,559776,259488,303264,559200,560160,259872,303648
.long 559584,560544,260256,0x7fffffff,559968,560928,260640,0x7fffffff
.long 560352,561312,301152,0x7fffffff,560736,561696,301536,0x7fffffff
.long 561120,258144,301920,0x7fffffff,561504,258528,302304,0x7fffffff
.long 215328,258912,302688,0x7fffffff,215712,259296,303072,0x7fffffff
.long 216096,259680,303456,0x7fffffff,216480,260064,301344,0x7fffffff
.long 216864,260448,301728,0x7fffffff,217248,258336,302112,0x7fffffff
.long 216688,217648,258736,302512,217072,559408,259120,302896
.long 217456,559792,259504,303280,559216,560176,259888,303664
.long 559600,560560,260272,0x7fffffff,559984,560944,260656,0x7fffffff
.long 560368,561328,301168,0x7fffffff,560752,561712,301552,0x7fffffff
.long 561136,258160,301936,0x7fffffff,561520,258544,302320,0x7fffffff
.long 215344,258928,302704,0x7fffffff,215728,259312,303088,0x7fffffff
.long 216112,259696,303472,0x7fffffff,216496,260080,301360,0x7fffffff
.long 216880,260464,301744,0x7fffffff,217264,258352,302128,0x7fffffff
.long 216704,217664,258752,302528,217088,559424,259136,302912
.long 217472,559808,259520,303296,559232,560192,259904,303680
.long 559616,560576,260288,0x7fffffff,560000,560960,260672,0x7fffffff
.long 560384,561344,301184,0x7fffffff,560768,561728,301568,0x7fffffff
.long 561152,258176,301952,0x7fffffff,561536,258560,302336,0x7fffffff
.long 215360,258944,302720,0x7fffffff,215744,259328,303104,0x7fffffff
.long 216128,259712,303488,0x7fffffff,216512,260096,301376,0x7fffffff
.long 216896,260480,301760,0x7fffffff,217280,258368,302144,0x7fffffff
.long 216720,217680,258768,302544,217104,559440,259152,302928
.long 217488,559824,259536,303312,559248,560208,259920,303696
.long 559632,560592,260304,0x7fffffff,560016,560976,260688,0x7fffffff
.long 560400,561360,301200,0x7fffffff,560784,561744,301584,0x7fffffff
.long 561168,258192,301968,0x7fffffff,561552,258576,302352,0x7fffffff
.long 215376,258960,302736,0x7fffffff,215760,259344,303120,0x7fffffff
.long 216144,259728,303504,0x7fffffff,216528,260112,301392,0x7fffffff
.long 216912,260496,301776,0x7fffffff,217296,258384,302160,0x7fffffff
.long 19456,39936,60416,544,19472,39952,60432,550
.long 19488,39968,60448,556,19504,39984,60464,562
.long 19520,40000,60480,568,19536,40016,60496,574
.long 19552,40032,60512,708,19568,40048,60528,714
.long 19584,40064,60544,720,19600,40080,60560,726
.long 19616,40096,60576,732,19632,40112,60592,738
.long 19648,40128,60608,744,19664,40144,60624,750
.long 19680,40160,60640,756,19696,40176,60656,762
.long 19712,40192,60672,548,19728,40208,60688,554
.long 19744,40224,60704,560,19760,40240,60720,566
.long 19776,40256,60736,572,19792,40272,60752,706
.long 19808,40288,60768,712,19824,40304,60784,718
.long 19840,40320,60800,724,19856,40336,60816,730
.long 19872,40352,60832,736,19888,40368,60848,742
.long 19904,40384,60864,748,19920,40400,60880,754
.long 19936,40416,60896,760,19952,40432,60912,766
.long 19968,40448,60928,546,19984,40464,60944,552
.long 20000,40480,60960,558,20016,40496,60976,564
.long 20032,40512,60992,570,20048,40528,61008,704
.long 20064,40544,61024,710,20080,40560,61040,716
.long 20096,40576,61056,722,20112,40592,61072,728
.long 20128,40608,61088,734,20144,40624,61104,740
.long 20160,40640,61120,746,20176,40656,61136,752
.long 20192,40672,61152,758,20208,40688,61168,764
.long 20224,40704,61184,548,20240,40720,61200,554
.long 20256,40736,61216,560,20272,40752,61232,566
.long 20288,40768,61248,572,20304,40784,61264,706
.long 20320,40800,61280,712,20336,40816,61296,718
.long 20352,40832,61312,724,20368,40848,61328,730
.long 20384,40864,61344,736,20400,40880,61360,742
.long 20416,40896,61376,748,20432,40912,61392,754
.long 20448,40928,61408,760,20464,40944,61424,766
.long 140168,140176,146840,163360,140584,140592,147256,163372
.long 141000,141008,147672,163384,141000,141008,148088,163396
.long 141416,141424,148488,163408,141848,141824,148904,163420
.long 142264,142240,149320,163432,142264,142240,149736,163444
.long 142680,142656,150168,163456,143096,143072,150584,163468
.long 143496,143504,151000,163480,143496,143504,151416,163492
.long 143912,143920,151816,163504,144328,144336,152232,163516
.long 144744,144752,152648,163528,144744,144752,153064,163540
.long 145176,145152,153496,163552,145592,145568,153912,163564
.long 146008,145984,154328,163576,146008,145984,154744,163588
.long 146424,146400,155144,163600,146824,146832,155560,163612
.long 147240,147248,155976,163624,147240,147248,156392,163636
.long 147656,147664,156824,163648,148072,148080,157240,163660
.long 148504,148480,157656,163672,148504,148480,158072,163684
.long 148920,148896,158472,163696,149336,149312,158888,163708
.long 149752,149728,159304,163720,149752,149728,159720,163732
.long 150152,150160,146844,163360,150568,150576,147260,163372
.long 150984,150992,147676,163384,150984,150992,148092,163396
.long 151400,151408,148492,163408,151832,151808,148908,163420
.long 152248,152224,149324,163432,152248,152224,149740,163444
.long 152664,152640,150172,163456,153080,153056,150588,163468
.long 153480,153488,151004,163480,153480,153488,151420,163492
.long 153896,153904,151820,163504,154312,154320,152236,163516
.long 154728,154736,152652,163528,154728,154736,153068,163540
.long 155160,155136,153500,163552,155576,155552,153916,163564
.long 155992,155968,154332,163576,155992,155968,154748,163588
.long 156408,156384,155148,163600,156808,156816,155564,163612
.long 157224,157232,155980,163624,157224,157232,156396,163636
.long 157640,157648,156828,163648,158056,158064,157244,163660
.long 158488,158464,157660,163672,158488,158464,158076,163684
.long 158904,158880,158476,163696,159320,159296,158892,163708
.long 159736,159712,159308,163720,159736,159712,159724,163732
.long 288,40320,96,96,296,40328,104,104
.long 304,40336,112,112,312,40344,120,120
.long 704,40736,288,288,712,40744,296,296
.long 720,40752,304,304,728,40760,312,312
.long 1120,41152,480,480,1128,41160,488,488
.long 1136,41168,496,496,1144,41176,504,504
.long 1536,41568,672,672,1544,41576,680,680
.long 1552,41584,688,688,1560,41592,696,696
.long 1968,42000,832,896,1976,42008,840,904
.long 1952,41984,848,912,1960,41992,856,920
.long 2384,42416,1024,1088,2392,42424,1032,1096
.long 2368,42400,1040,1104,2376,42408,1048,1112
.long 2800,42832,1216,1280,2808,42840,1224,1288
.long 2784,42816,1232,1296,2792,42824,1240,1304
.long 3216,43248,1408,1472,3224,43256,1416,1480
.long 3200,43232,1424,1488,3208,43240,1432,1496
.long 3616,43648,1632,1632,3624,43656,1640,1640
.long 3632,43664,1648,1648,3640,43672,1656,1656
.long 4032,44064,1824,1824,4040,44072,1832,1832
.long 4048,44080,1840,1840,4056,44088,1848,1848
.long 4448,44480,2016,2016,4456,44488,2024,2024
.long 4464,44496,2032,2032,4472,44504,2040,2040
.long 4864,44896,2208,2208,4872,44904,2216,2216
.long 4880,44912,2224,2224,4888,44920,2232,2232
.long 5296,45328,2368,2432,5304,45336,2376,2440
.long 5280,45312,2384,2448,5288,45320,2392,2456
.long 5712,45744,2560,2624,5720,45752,2568,2632
.long 5696,45728,2576,2640,5704,45736,2584,2648
.long 6128,46160,2752,2816,6136,46168,2760,2824
.long 6112,46144,2768,2832,6120,46152,2776,2840
.long 6544,46576,2944,3008,6552,46584,2952,3016
.long 6528,46560,2960,3024,6536,46568,2968,3032
.long 161940,162112,162280,163136,161940,162112,162280,163148
.long 161940,162112,162280,163160,161940,162112,162280,163172
.long 161940,162112,162284,163184,161940,162112,162284,163196
.long 161940,162112,162284,163208,161940,162112,162284,163220
.long 161944,162112,162284,163232,161944,162112,162284,163244
.long 161944,162112,162284,163256,161944,162112,162284,163268
.long 161944,162116,162284,163280,161944,162116,162284,163292
.long 161944,162116,162284,163304,161944,162116,162284,163316
.long 161944,162116,162288,163144,161944,162116,162288,163156
.long 161944,162116,162288,163168,161944,162116,162288,163180
.long 161948,162116,162288,163192,161948,162116,162288,163204
.long 161948,162116,162288,163216,161948,162116,162288,163228
.long 161948,162120,162288,163240,161948,162120,162288,163252
.long 161948,162120,162288,163264,161948,162120,162288,163276
.long 161948,162120,162292,163288,161948,162120,162292,163300
.long 161948,162120,162292,163312,161948,162120,162292,163324
.long 161952,162120,162292,163140,161952,162120,162292,163152
.long 161952,162120,162292,163164,161952,162120,162292,163176
.long 161952,162124,162292,163188,161952,162124,162292,163200
.long 161952,162124,162292,163212,161952,162124,162292,163224
.long 161952,162124,162296,163236,161952,162124,162296,163248
.long 161952,162124,162296,163260,161952,162124,162296,163272
.long 161956,162124,162296,163284,161956,162124,162296,163296
.long 161956,162124,162296,163308,161956,162124,162296,163320
.long 161956,162128,162296,163144,161956,162128,162296,163156
.long 161956,162128,162296,163168,161956,162128,162296,163180
.long 161956,162128,162300,163192,161956,162128,162300,163204
.long 161956,162128,162300,163216,161956,162128,162300,163228
.long 161960,162128,162300,163240,161960,162128,162300,163252
.long 161960,162128,162300,163264,161960,162128,162300,163276
.long 161960,162132,162300,163288,161960,162132,162300,163300
.long 161960,162132,162300,163312,161960,162132,162300,163324
.long 7200,15360,23552,1792,7216,15376,23568,1808
.long 7168,15392,23584,1824,7184,15408,23600,1840
.long 7264,15424,23616,1856,7280,15440,23632,1872
.long 7232,15456,23648,1888,7248,15472,23664,1904
.long 7328,15488,23680,1920,7344,15504,23696,1936
.long 7296,15520,23712,1952,7312,15536,23728,1968
.long 7392,15552,23744,1984,7408,15568,23760,2000
.long 7360,15584,23776,2016,7376,15600,23792,2032
.long 7456,15616,23840,3840,7472,15632,23856,3856
.long 7424,15648,23808,3872,7440,15664,23824,3888
.long 7520,15680,23904,3904,7536,15696,23920,3920
.long 7488,15712,23872,3936,7504,15728,23888,3952
.long 7584,15744,23968,3968,7600,15760,23984,3984
.long 7552,15776,23936,4000,7568,15792,23952,4016
.long 7648,15808,24032,4032,7664,15824,24048,4048
.long 7616,15840,24000,4064,7632,15856,24016,4080
.long 7680,15872,24096,5888,7696,15888,24112,5904
.long 7712,15904,24064,5920,7728,15920,24080,5936
.long 7744,15936,24160,5952,7760,15952,24176,5968
.long 7776,15968,24128,5984,7792,15984,24144,6000
.long 7808,16000,24224,6016,7824,16016,24240,6032
.long 7840,16032,24192,6048,7856,16048,24208,6064
.long 7872,16064,24288,6080,7888,16080,24304,6096
.long 7904,16096,24256,6112,7920,16112,24272,6128
.long 7936,16160,24352,7936,7952,16176,24368,7952
.long 7968,16128,24320,7968,7984,16144,24336,7984
.long 8000,16224,24416,8000,8016,16240,24432,8016
.long 8032,16192,24384,8032,8048,16208,24400,8048
.long 8064,16288,24480,8064,8080,16304,24496,8080
.long 8096,16256,24448,8096,8112,16272,24464,8112
.long 8128,16352,24544,8128,8144,16368,24560,8144
.long 8160,16320,24512,8160,8176,16336,24528,8176
.long 16256,0,0,0,0x3f800000,0,0,0
.long 0,16256,0,0,0,0x3f800000,0,0
.long 0,0,16256,0,0,0,0x3f800000,0
.long 0,0,0,16256,0,0,0,0x3f800000
.long 0,0,0,0,0,0,0,0
.long 0,0,0,0,0,0,0,0
.long 0,0,0,0,0,0,0,0
.long 0,0,0,0,0,0,0,0
.long 0,0,0,0,0,0,0,0
.long 0,0,0,0,0,0,0,0
.long 0,0,0,0,0,0,0,0
.long 0,0,0,0,0,0,0,0
.long 16256,0,0,0,0x3f800000,0,0,0
.long 0,16256,0,0,0,0x3f800000,0,0
.long 0,0,16256,0,0,0,0x3f800000,0
.long 0,0,0,16256,0,0,0,0x3f800000
.long 0,0,0,0,0,0,0,0
.long 0,0,0,0,0,0,0,0
.long 0,0,0,0,0,0,0,0
.long 0,0,0,0,0,0,0,0
.long 0,0,0,0,0,0,0,0
.long 0,0,0,0,0,0,0,0
.long 0,0,0,0,0,0,0,0
.long 0,0,0,0,0,0,0,0
.long 0,0,0,0,0,0,0,0
.long 0,0,0,0,0,0,0,0
.long 0,0,0,0,0,0,0,0
.long 0,0,0,0,0,0,0,0
.long 0,0,0,0,0,0,0,0
.long 0,0,0,0,0,0,0,0
.long 0,0,0,0,0,0,0,0
.long 0,0,0,0,0,0,0,0
.long 0,0,0,0,0,0,0,0
.long 0,0,0,0,0,0,0,0
.long 0,0,0,0,0,0,0,0
.long 0,0,0,0,0,0,0,0
.long 0,0,0,0,0,0,0,0
.long 0,0,0,0,0,0,0,0
.long 0,0,0,0,0,0,0,0
.long 0,0,0,0,0,0,0,0
.long 0,0,0,0,0,0,0,0
.long 0,0,0,0,0,0,0,0
.long 0,0,0,0,0,0,0,0
.long 0,0,0,0,0,0,0,0
.long 0,0,0,0,0,0,0,0
.long 0,0,0,0,0,0,0,0
.long 0,0,0,0,0,0,0,0
.long 0,0,0,0,0,0,0,0
.long 16256,0,0,0,0x3f800000,0,0,0
.long 0,16256,0,0,0,0x3f800000,0,0
.long 0,0,16256,0,0,0,0x3f800000,0
.long 0,0,0,16256,0,0,0,0x3f800000
.long 0,0,0,0,0,0,0,0
.long 0,0,0,0,0,0,0,0
.long 0,0,0,0,0,0,0,0
.long 0,0,0,0,0,0,0,0
.long 0,0,0,0,0,0,0,0
.long 0,0,0,0,0,0,0,0
.long 0,0,0,0,0,0,0,0
.long 0,0,0,0,0,0,0,0
.long 16256,0,0,0,0x3f800000,0,0,0
.long 0,16256,0,0,0,0x3f800000,0,0
.long 0,0,16256,0,0,0,0x3f800000,0
.long 0,0,0,16256,0,0,0,0x3f800000
.long 109920,111488,4992,163552,110128,111504,5392,163552
.long 110336,111520,5792,163552,110544,111536,6192,163552
.long 110752,111552,5056,163552,110960,111568,5456,163552
.long 111168,111584,5856,163552,111376,111600,6256,163552
.long 111584,111616,5120,163552,111792,111632,5520,163552
.long 112000,111648,5920,163552,112208,111664,6320,163552
.long 112416,111696,15552,163552,112624,111712,15568,163552
.long 112832,111728,15584,163552,113040,111744,15600,163552
.long 109928,111760,5008,163568,110136,111776,5408,163568
.long 110344,111792,5808,163568,110552,111808,6208,163568
.long 110760,111824,5072,163568,110968,111840,5472,163568
.long 111176,111856,5872,163568,111384,111872,6272,163568
.long 111592,111904,5136,163568,111800,111920,5536,163568
.long 112008,111936,5936,163568,112216,111952,6336,163568
.long 112424,111968,15808,163568,112632,111984,15824,163568
.long 112840,112000,15840,163568,113048,112016,15856,163568
.long 109936,112032,5024,163584,110144,112048,5424,163584
.long 110352,112064,5824,163584,110560,112080,6224,163584
.long 110768,112112,5088,163584,110976,112128,5488,163584
.long 111184,112144,5888,163584,111392,112160,6288,163584
.long 111600,112176,5152,163584,111808,112192,5552,163584
.long 112016,112208,5952,163584,112224,112224,6352,163584
.long 112432,112240,16064,163584,112640,112256,16080,163584
.long 112848,112272,16096,163584,113056,112288,16112,163584
.long 109944,112112,5040,163600,110152,112128,5440,163600
.long 110360,112144,5840,163600,110568,112160,6240,163600
.long 110776,112176,5104,163600,110984,112192,5504,163600
.long 111192,112208,5904,163600,111400,112224,6304,163600
.long 111608,112240,5168,163600,111816,112256,5568,163600
.long 112024,112272,5968,163600,112232,112288,6368,163600
.long 112440,112112,16320,163600,112648,112128,16336,163600
.long 112856,112144,16352,163600,113064,112160,16368,163600
.long 561024,216000,258048,259584,561040,216016,258064,259600
.long 561056,216032,258080,259616,561072,216048,258096,259632
.long 561088,216064,258112,259648,561104,216080,258128,259664
.long 561120,216096,258144,259680,561136,216112,258160,259696
.long 561152,216128,258176,259712,561168,216144,258192,259728
.long 561184,216160,258208,259744,561200,216176,258224,259760
.long 561408,216384,258432,259968,561424,216400,258448,259984
.long 561440,216416,258464,260000,561456,216432,258480,260016
.long 561472,216448,258496,260032,561488,216464,258512,260048
.long 561504,216480,258528,260064,561520,216496,258544,260080
.long 561536,216512,258560,260096,561552,216528,258576,260112
.long 561568,216544,258592,260128,561584,216560,258608,260144
.long 215232,216768,258816,260352,215248,216784,258832,260368
.long 215264,216800,258848,260384,215280,216816,258864,260400
.long 215296,216832,258880,260416,215312,216848,258896,260432
.long 215328,216864,258912,260448,215344,216880,258928,260464
.long 215360,216896,258944,260480,215376,216912,258960,260496
.long 215392,216928,258976,260512,215408,216944,258992,260528
.long 215616,217152,259200,258240,215632,217168,259216,258256
.long 215648,217184,259232,258272,215664,217200,259248,258288
.long 215680,217216,259264,258304,215696,217232,259280,258320
.long 215712,217248,259296,258336,215728,217264,259312,258352
.long 215744,217280,259328,258368,215760,217296,259344,258384
.long 215776,217312,259360,258400,215792,217328,259376,258416
.long 0x7fffffff,0x7fffffff,0x7fffffff,0x7fffffff,0x7fffffff,0x7fffffff,0x7fffffff,0x7fffffff
.long 0x7fffffff,0x7fffffff,0x7fffffff,0x7fffffff,0x7fffffff,0x7fffffff,0x7fffffff,0x7fffffff
.long 0x7fffffff,0x7fffffff,0x7fffffff,0x7fffffff,0x7fffffff,0x7fffffff,0x7fffffff,0x7fffffff
.long 0x7fffffff,0x7fffffff,0x7fffffff,0x7fffffff,0x7fffffff,0x7fffffff,0x7fffffff,0x7fffffff
.long 0x7fffffff,0x7fffffff,0x7fffffff,0x7fffffff,0x7fffffff,0x7fffffff,0x7fffffff,0x7fffffff
.long 0x7fffffff,0x7fffffff,0x7fffffff,0x7fffffff,0x7fffffff,0x7fffffff,0x7fffffff,0x7fffffff
.long 0x7fffffff,0x7fffffff,0x7fffffff,0x7fffffff,0x7fffffff,0x7fffffff,0x7fffffff,0x7fffffff
.long 0x7fffffff,0x7fffffff,0x7fffffff,0x7fffffff,0x7fffffff,0x7fffffff,0x7fffffff,0x7fffffff
.long 301824,303360,302400,0,301840,303376,302416,32
.long 301856,303392,302432,64,301872,303408,302448,96
.long 301888,303424,302464,128,301904,303440,302480,160
.long 301920,303456,302496,192,301936,303472,302512,224
.long 301952,303488,302528,256,301968,303504,302544,288
.long 301984,303520,302560,320,302000,303536,302576,352
.long 302208,301248,302784,400,302224,301264,302800,432
.long 302240,301280,302816,464,302256,301296,302832,496
.long 302272,301312,302848,528,302288,301328,302864,560
.long 302304,301344,302880,592,302320,301360,302896,624
.long 302336,301376,302912,656,302352,301392,302928,688
.long 302368,301408,302944,720,302384,301424,302960,752
.long 302592,301632,303168,800,302608,301648,303184,832
.long 302624,301664,303200,864,302640,301680,303216,896
.long 302656,301696,303232,928,302672,301712,303248,960
.long 302688,301728,303264,992,302704,301744,303280,1024
.long 302720,301760,303296,1056,302736,301776,303312,1088
.long 302752,301792,303328,1120,302768,301808,303344,1152
.long 302976,302016,303552,1200,302992,302032,303568,1232
.long 303008,302048,303584,1264,303024,302064,303600,1296
.long 303040,302080,303616,1328,303056,302096,303632,1360
.long 303072,302112,303648,1392,303088,302128,303664,1424
.long 303104,302144,303680,1456,303120,302160,303696,1488
.long 303136,302176,303712,1520,303152,302192,303728,1552
.long 0x7fffffff,0x7fffffff,0x7fffffff,1200,0x7fffffff,0x7fffffff,0x7fffffff,1232
.long 0x7fffffff,0x7fffffff,0x7fffffff,1264,0x7fffffff,0x7fffffff,0x7fffffff,1296
.long 0x7fffffff,0x7fffffff,0x7fffffff,1328,0x7fffffff,0x7fffffff,0x7fffffff,1360
.long 0x7fffffff,0x7fffffff,0x7fffffff,1392,0x7fffffff,0x7fffffff,0x7fffffff,1424
.long 0x7fffffff,0x7fffffff,0x7fffffff,1456,0x7fffffff,0x7fffffff,0x7fffffff,1488
.long 0x7fffffff,0x7fffffff,0x7fffffff,1520,0x7fffffff,0x7fffffff,0x7fffffff,1552
.long 0x7fffffff,0x7fffffff,0x7fffffff,1200,0x7fffffff,0x7fffffff,0x7fffffff,1232
.long 0x7fffffff,0x7fffffff,0x7fffffff,1264,0x7fffffff,0x7fffffff,0x7fffffff,1296
.size L_tab, 131072
.globl standalone__modern_conv_block_slak__vision_kernel
.p2align 8
.type standalone__modern_conv_block_slak__vision_kernel,@function
standalone__modern_conv_block_slak__vision_kernel:
    s_load_dwordx16 s[4:19], s[0:1], 0
    s_load_dwordx2 s[20:21], s[0:1], 64
    s_cmp_ge_u32 s2, 256
    s_cbranch_scc1 L_end
    s_setprio 3
    s_getpc_b64 s[52:53]
L_pc:
    v_lshrrev_b32 v2, 6, v0
    v_and_b32_e64 v1, 63, v0
    s_sub_u32 s56, s52, L_pc-L_tab-4096
    s_subb_u32 s57, s53, 0
    v_lshlrev_b32_e64 v15, 4, v1
    v_readfirstlane_b32 s22, v2
    v_lshl_add_u32 v14, v2, 14, v15
    global_load_dwordx4 v[208:211], v14, s[56:57] offset:-4096
    global_load_dwordx4 v[212:215], v14, s[56:57] offset:-3072
    s_lshr_b32 s47, s2, 3
    s_lshl_b32 s23, s47, 3
    s_add_u32 s23, s23, s22
    s_add_u32 s23, s23, 128
    s_cmp_ge_u32 s23, 148
    s_cselect_b32 s63, 148, 0
    s_sub_u32 s23, s23, s63
    s_cmp_ge_u32 s23, 148
    s_cselect_b32 s63, 148, 0
    s_sub_u32 s23, s23, s63
    s_lshl_b32 s23, s23, 10
    v_lshl_add_u32 v3, v1, 7, s23
    v_min_u32 v3, L_end-L_tab, v3
    s_mov_b64 exec, 0xff
    global_load_dword v183, v3, s[56:57] offset:-4096
    s_mov_b64 exec, -1
    s_add_u32 s96, s56, 8192
    s_addc_u32 s97, s57, 0
    s_and_b32 s46, s2, 7
    s_lshr_b32 s44, s46, 1
    s_lshl_b32 s44, s44, 2
    s_lshr_b32 s23, s47, 3
    s_add_u32 s44, s44, s23
    s_mul_i32 s44, s44, 14
    s_and_b32 s45, s46, 1
    s_lshl_b32 s45, s45, 3
    s_and_b32 s23, s47, 7
    s_add_u32 s45, s45, s23
    s_mul_i32 s45, s45, 14
    s_and_b32 s50, s22, 3
    s_lshr_b32 s51, s22, 2
    s_mul_i32 s23, s50, 15
    v_lshrrev_b32 v194, 2, v1
    v_add_u32 v195, s23, v194
    v_mul_u32_u24 v196, 205, v195
    v_lshrrev_b32 v196, 12, v196
    v_mul_u32_u24 v197, 20, v196
    v_sub_u32 v197, v195, v197
    v_mul_u32_u24 v198, 13, v197
    v_lshrrev_b32 v198, 7, v198
    v_mul_u32_u24 v199, 10, v198
    v_sub_u32_e64 v199, v197, v199
    v_lshl_add_u32 v200, v199, 1, v198
    s_sub_u32 s23, s45, 3
    v_add_u32 v200, s23, v200
    v_bfe_u32 v199, v199, 2, 1
    v_and_b32 v201, 3, v1
    v_xor_b32 v199, v201, v199
    v_lshlrev_b32_e64 v199, 4, v199
    v_lshl_add_u32 v199, v196, 6, v199
    s_movk_i32 s23, 192
    v_mad_u32_u24 v199, v200, s23, v199
    s_movk_i32 s23, 223
    v_cmp_lt_u32 s[42:43], s23, v200
    v_mov_b32 v202, 0x7fffffff
    s_lshl_b32 s62, s51, 3
    s_add_u32 s54, s44, s62
    s_sub_u32 s54, s54, 4
    s_mul_i32 s54, s54, 43008
    s_mul_i32 s55, s62, 3840
    s_mul_i32 s23, s50, 960
    s_add_u32 s55, s55, s23
    v_cndmask_b32 v225, v199, v202, s[42:43]
    s_lshl_b32 s23, s51, 5
    v_xor_b32_e64 v224, s23, v225
    s_lshl_b32 s23, s22, 5
    s_add_u32 s23, s23, 512
    v_add_u32_e64 v189, s23, v1
    v_mul_u32_u24 v190, 5042, v0
    v_mul_u32_u24 v191, 5042, v189
    v_lshrrev_b32 v190, 16, v190
    v_lshrrev_b32 v191, 16, v191
    v_sub_u32 v192, v0, v190
    v_sub_u32 v193, v189, v191
    v_lshlrev_b32 v192, 4, v192
    v_lshlrev_b32 v193, 4, v193
    s_mov_b32 s30, 9408
    s_mov_b32 s31, 0x20000
    s_mov_b32 s26, 9633792
    s_mov_b32 s27, 0x20000
    s_lshl_b32 s23, s22, 10
    s_add_u32 m0, s23, 150528
    s_cmp_lt_u32 s2, 34
    s_cselect_b32 s58, s22, 0
    s_waitcnt lgkmcnt(0)
    s_mov_b32 s28, s6
    s_mov_b32 s29, s7
    s_mov_b32 s24, s4
    s_mov_b32 s25, s5
    buffer_load_dwordx4 v192, s[28:31], 0 offen lds
    s_lshl_b32 s23, s22, 9
    s_add_u32 m0, s23, 158720
    s_mov_b32 exec_hi, 0
    buffer_load_dwordx4 v193, s[28:31], 0 offen lds
    s_mov_b32 exec_hi, 0xfffffff
    s_add_u32 m0, s55, 0
    s_nop 0
    s_add_u32 s54, s54, 43008
    buffer_load_dwordx4 v224, s[24:27], s54 offen lds
    s_add_u32 m0, s55, 3840
    s_add_u32 s54, s54, 43008
    buffer_load_dwordx4 v224, s[24:27], s54 offen lds
    s_add_u32 m0, s55, 7680
    s_add_u32 s54, s54, 43008
    buffer_load_dwordx4 v224, s[24:27], s54 offen lds
    s_add_u32 m0, s55, 11520
    s_add_u32 s54, s54, 43008
    buffer_load_dwordx4 v224, s[24:27], s54 offen lds
    s_mov_b32 exec_hi, -1
    s_cmp_lg_u32 s58, 7
    s_cbranch_scc1 L_c_1
    v_mov_b32 v160, 0
    v_mov_b32 v161, 0
    v_mov_b32 v162, 0
    v_mov_b32 v163, 0
    s_lshl_b32 s23, s2, 10
    v_add_u32_e64 v203, s23, v15
    global_store_dwordx4 v203, v[160:163], s[20:21] sc0 sc1
L_c_1:
    s_setprio 2
    s_mov_b32 s32, s8
    s_mov_b32 s33, s9
    s_mov_b32 s34, 73728
    s_mov_b32 s35, 0x20000
    s_mov_b32 s36, s10
    s_mov_b32 s37, s11
    s_nop 0
    s_mov_b32 s38, 73728
    s_mov_b32 s39, 0x20000
    v_mul_u32_u24 v226, 768, v194
    v_lshl_add_u32 v226, v201, 4, v226
    s_mul_i32 s40, s51, 36864
    s_mul_i32 s23, s50, 192
    s_add_u32 s40, s40, s23
    s_mul_i32 s41, s50, 6144
    s_mul_i32 s23, s51, 3072
    s_add_u32 s41, s41, s23
    v_add_u32 v227, 150528, v15
    v_lshlrev_b32_e64 v241, 4, v0
    v_add_u32 v240, 150528, v241
    s_mov_b32 s48, 0xc09d30fc
    s_mov_b32 s49, 0xc09d30fc
    s_mov_b32 s60, 0x3c2aaaab
    s_mov_b32 s61, 0x3727c5ac
    s_mov_b32 s52, 0x3eeff558
    s_mov_b32 s42, 0x88888888
    s_mov_b32 s43, 0x88888888
    s_lshr_b32 s46, s22, 1
    s_mul_i32 s59, s44, 224
    s_add_u32 s59, s59, s45
    s_mul_i32 s59, s59, 192
    s_mov_b32 exec_hi, 0xfffffff
    s_add_u32 m0, s55, 15360
    s_add_u32 s54, s54, 43008
    buffer_load_dwordx4 v224, s[24:27], s54 offen lds
    s_add_u32 m0, s55, 19200
    s_add_u32 s54, s54, 43008
    buffer_load_dwordx4 v224, s[24:27], s54 offen lds
    s_mov_b32 exec_hi, -1
    v_mov_b32 v231, 0
    v_mov_b32 v232, 0
    s_cmp_ge_u32 s22, 2
    s_cbranch_scc1 L_c_2
    s_lshl_b32 s23, s2, 1
    s_and_b32 s44, s23, 0x3fc
    s_add_u32 s45, s44, 512
    s_min_u32 s45, s45, 764
    s_load_dword s44, s[14:15], s44
    s_load_dword s45, s[14:15], s45
    v_lshrrev_b32 v232, 2, v0
    v_min_u32 v231, 2, v201
    v_mad_u32_u24 v232, v232, 3, v231
    v_lshlrev_b32_e64 v232, 1, v232
    s_mul_i32 s23, s2, 192
    buffer_load_ushort v229, v232, s[36:39], s23 offen
    s_add_u32 s23, s23, 49152
    buffer_load_ushort v230, v232, s[36:39], s23 offen
    s_lshr_b32 s23, s2, 3
    s_and_b32 s23, s23, 3
    s_lshl_b32 s23, s23, 9
    s_add_u32 s23, s23, 32768
    v_lshl_add_u32 v231, v0, 2, s23
    v_mov_b32_e64 v232, 0
    s_and_b32 s23, s2, 1
    s_lshl_b32 s23, s23, 4
    s_waitcnt lgkmcnt(0)
    s_lshr_b32 s44, s44, s23
    s_lshr_b32 s45, s45, s23
    s_lshl_b32 s44, s44, 16
    s_lshl_b32 s45, s45, 16
L_c_2:
    s_waitcnt vmcnt(6)
    s_barrier
    ds_read_b64_tr_b16 v[46:47], v209 offset:0
    ds_read_b64_tr_b16 v[54:55], v209 offset:64
    ds_read_b64_tr_b16 v[62:63], v209 offset:128
    ds_read_b64_tr_b16 v[118:119], v208 offset:2912
    ds_read_b64_tr_b16 v[126:127], v208 offset:2976
    ds_read_b64_tr_b16 v[134:135], v208 offset:3040
    ds_read_b64_tr_b16 v[142:143], v208 offset:5824
    ds_read_b64_tr_b16 v[150:151], v208 offset:5888
    ds_read_b64_tr_b16 v[158:159], v208 offset:5952
    ds_read_b64_tr_b16 v[22:23], v208 offset:8736
    ds_read_b64_tr_b16 v[30:31], v208 offset:8800
    ds_read_b64_tr_b16 v[38:39], v208 offset:8864
    s_waitcnt lgkmcnt(11)
    v_perm_b32 v40, v46, v46, v212
    s_add_u32 m0, s55, 23040
    s_add_u32 s54, s54, 43008
    s_mov_b32 exec_hi, 0xfffffff
    buffer_load_dwordx4 v224, s[24:27], s54 offen lds
    s_mov_b32 exec_hi, -1
    v_perm_b32 v41, v46, v46, v213
    v_perm_b32 v42, v46, v46, v214
    v_perm_b32 v43, v46, v46, v215
    v_perm_b32 v44, v47, v47, v212
    v_perm_b32 v45, v47, v47, v213
    v_perm_b32 v46, v47, v47, v214
    v_perm_b32 v47, v47, v47, v215
    s_waitcnt lgkmcnt(8)
    s_nop 0
    v_perm_b32 v48, v54, v54, v212
    v_perm_b32 v49, v54, v54, v213
    v_perm_b32 v50, v54, v54, v214
    v_perm_b32 v51, v54, v54, v215
    v_perm_b32 v52, v55, v55, v212
    s_add_u32 m0, s55, 26880
    s_add_u32 s54, s54, 43008
    s_mov_b32 exec_hi, 0xfffffff
    buffer_load_dwordx4 v224, s[24:27], s54 offen lds
    s_mov_b32 exec_hi, -1
    s_nop 0
    v_perm_b32 v53, v55, v55, v213
    v_perm_b32 v54, v55, v55, v214
    v_perm_b32 v55, v55, v55, v215
    v_perm_b32 v56, v62, v62, v212
    v_perm_b32 v57, v62, v62, v213
    v_perm_b32 v58, v62, v62, v214
    v_perm_b32 v59, v62, v62, v215
    v_perm_b32 v60, v63, v63, v212
    v_perm_b32 v61, v63, v63, v213
    v_perm_b32 v62, v63, v63, v214
    v_perm_b32 v63, v63, v63, v215
    s_setprio 3
    s_waitcnt vmcnt(4) lgkmcnt(0)
    s_barrier
    s_nop 0
    ds_read_b64 v[64:65], v210 offset:0
    ds_read_b64 v[66:67], v210 offset:640
    ds_read_b64 v[68:69], v210 offset:3840
    ds_read_b64 v[70:71], v210 offset:4480
    ds_read_b64 v[72:73], v210 offset:1280
    ds_read_b64 v[74:75], v210 offset:1920
    ds_read_b64 v[76:77], v210 offset:5120
    ds_read_b64 v[78:79], v210 offset:5760
    v_perm_b32 v112, v118, v118, v212
    ds_read_b64 v[80:81], v210 offset:2560
    v_perm_b32 v113, v118, v118, v213
    v_perm_b32 v114, v118, v118, v214
    ds_read_b64 v[82:83], v210 offset:3200
    v_perm_b32 v115, v118, v118, v215
    v_perm_b32 v116, v119, v119, v212
    ds_read_b64 v[84:85], v210 offset:6400
    v_perm_b32 v117, v119, v119, v213
    v_perm_b32 v118, v119, v119, v214
    ds_read_b64 v[86:87], v210 offset:7040
    v_perm_b32 v119, v119, v119, v215
    s_setprio 2
    s_waitcnt lgkmcnt(10)
    v_mfma_f32_16x16x32_bf16 v[160:163], v[40:43], v[64:67], 0
    ds_read_b64 v[88:89], v210 offset:7680
    ds_read_b64 v[90:91], v210 offset:8320
    ds_read_b64 v[92:93], v210 offset:11520
    s_waitcnt lgkmcnt(11)
    v_mfma_f32_16x16x32_bf16 v[160:163], v[44:47], v[68:71], v[160:163]
    ds_read_b64 v[94:95], v210 offset:12160
    s_mul_i32 s63, s51, 7
    s_sub_u32 s63, 8, s63
    s_mul_i32 s62, s63, 43008
    s_add_u32 s54, s54, s62
    s_mul_i32 s63, s63, 3840
    s_add_u32 s55, s55, s63
    s_add_u32 m0, s55, 30720
    s_add_u32 s54, s54, 43008
    s_mov_b32 exec_hi, 0xfffffff
    buffer_load_dwordx4 v225, s[24:27], s54 offen lds
    s_mov_b32 exec_hi, -1
    s_setprio 1
    s_waitcnt lgkmcnt(4)
    v_mfma_f32_16x16x32_bf16 v[164:167], v[48:51], v[72:75], 0
    ds_read_b64 v[96:97], v210 offset:8960
    ds_read_b64 v[98:99], v210 offset:9600
    ds_read_b64 v[100:101], v210 offset:12800
    v_mfma_f32_16x16x32_bf16 v[164:167], v[52:55], v[76:79], v[164:167]
    ds_read_b64 v[102:103], v210 offset:13440
    s_add_u32 m0, s55, 38400
    s_add_u32 s54, s54, 86016
    s_mov_b32 exec_hi, 0xfffffff
    buffer_load_dwordx4 v225, s[24:27], s54 offen lds
    s_mov_b32 exec_hi, -1
    s_setprio 0
    v_mfma_f32_16x16x32_bf16 v[168:171], v[56:59], v[80:83], 0
    ds_read_b64 v[104:105], v210 offset:10240
    ds_read_b64 v[106:107], v210 offset:10880
    ds_read_b64 v[108:109], v210 offset:14080
    v_perm_b32 v120, v126, v126, v212
    v_perm_b32 v121, v126, v126, v213
    v_perm_b32 v122, v126, v126, v214
    v_perm_b32 v123, v126, v126, v215
    v_mfma_f32_16x16x32_bf16 v[168:171], v[60:63], v[84:87], v[168:171]
    ds_read_b64 v[110:111], v210 offset:14720
    s_add_u32 m0, s41, 76800
    s_add_u32 s63, s40, 0
    buffer_load_dwordx4 v226, s[32:35], s63 offen lds
    v_perm_b32 v124, v127, v127, v212
    v_perm_b32 v125, v127, v127, v213
    v_perm_b32 v126, v127, v127, v214
    v_perm_b32 v127, v127, v127, v215
    s_waitcnt vmcnt(3)
    s_cmp_lg_u32 s58, 7
    s_cbranch_scc1 L_c_3
    v_mov_b32 v234, 0
    v_mov_b32_e64 v235, 1
    s_mov_b64 exec, 1
    global_atomic_add v234, v235, s[18:19] sc1
    s_mov_b64 exec, -1
L_c_3:
    s_barrier
    s_setprio 3
    s_waitcnt lgkmcnt(1)
    v_mfma_f32_16x16x32_bf16 v[160:163], v[112:115], v[88:91], v[160:163]
    ds_read_b64 v[64:65], v210 offset:15360
    ds_read_b64 v[66:67], v210 offset:16000
    ds_read_b64 v[68:69], v210 offset:19200
    v_perm_b32 v128, v134, v134, v212
    v_perm_b32 v129, v134, v134, v213
    v_mfma_f32_16x16x32_bf16 v[172:175], v[40:43], v[88:91], 0
    ds_read_b64 v[70:71], v210 offset:19840
    ds_read_b64 v[72:73], v210 offset:16640
    v_perm_b32 v130, v134, v134, v214
    v_perm_b32 v131, v134, v134, v215
    v_mfma_f32_16x16x32_bf16 v[160:163], v[116:119], v[92:95], v[160:163]
    ds_read_b64 v[74:75], v210 offset:17280
    ds_read_b64 v[76:77], v210 offset:20480
    v_perm_b32 v132, v135, v135, v212
    v_perm_b32 v133, v135, v135, v213
    v_mfma_f32_16x16x32_bf16 v[172:175], v[44:47], v[92:95], v[172:175]
    ds_read_b64 v[78:79], v210 offset:21120
    s_add_u32 m0, s41, 77824
    s_add_u32 s63, s40, 12288
    buffer_load_dwordx4 v226, s[32:35], s63 offen lds
    v_perm_b32 v134, v135, v135, v214
    v_perm_b32 v135, v135, v135, v215
    v_mfma_f32_16x16x32_bf16 v[164:167], v[120:123], v[96:99], v[164:167]
    ds_read_b64 v[80:81], v210 offset:17920
    ds_read_b64 v[82:83], v210 offset:18560
    v_perm_b32 v136, v142, v142, v212
    v_perm_b32 v137, v142, v142, v213
    v_mfma_f32_16x16x32_bf16 v[176:179], v[48:51], v[96:99], 0
    ds_read_b64 v[84:85], v210 offset:21760
    v_perm_b32 v138, v142, v142, v214
    v_perm_b32 v139, v142, v142, v215
    v_mfma_f32_16x16x32_bf16 v[164:167], v[124:127], v[100:103], v[164:167]
    ds_read_b64 v[86:87], v210 offset:22400
    v_perm_b32 v140, v143, v143, v212
    v_perm_b32 v141, v143, v143, v213
    v_mfma_f32_16x16x32_bf16 v[176:179], v[52:55], v[100:103], v[176:179]
    s_add_u32 m0, s41, 78848
    s_add_u32 s63, s40, 24576
    buffer_load_dwordx4 v226, s[32:35], s63 offen lds
    v_perm_b32 v142, v143, v143, v214
    v_perm_b32 v143, v143, v143, v215
    s_setprio 2
    s_nop 0
    v_mfma_f32_16x16x32_bf16 v[168:171], v[128:131], v[104:107], v[168:171]
    ds_read_b64 v[88:89], v210 offset:23040
    ds_read_b64 v[90:91], v210 offset:23680
    v_perm_b32 v144, v150, v150, v212
    v_perm_b32 v145, v150, v150, v213
    v_mfma_f32_16x16x32_bf16 v[180:183], v[56:59], v[104:107], 0
    ds_read_b64 v[92:93], v210 offset:26880
    v_perm_b32 v146, v150, v150, v214
    v_perm_b32 v147, v150, v150, v215
    s_waitcnt lgkmcnt(4)
    s_nop 0
    v_mfma_f32_16x16x32_bf16 v[168:171], v[132:135], v[108:111], v[168:171]
    ds_read_b64 v[94:95], v210 offset:27520
    v_perm_b32 v148, v151, v151, v212
    v_perm_b32 v149, v151, v151, v213
    v_mfma_f32_16x16x32_bf16 v[180:183], v[60:63], v[108:111], v[180:183]
    global_load_dwordx4 v[216:219], v14, s[56:57] offset:-2048
    v_perm_b32 v150, v151, v151, v214
    v_perm_b32 v151, v151, v151, v215
    s_setprio 1
    s_nop 0
    v_mfma_f32_16x16x32_bf16 v[160:163], v[136:139], v[64:67], v[160:163]
    ds_read_b64 v[96:97], v210 offset:24320
    v_perm_b32 v152, v158, v158, v212
    v_mfma_f32_16x16x32_bf16 v[172:175], v[112:115], v[64:67], v[172:175]
    ds_read_b64 v[98:99], v210 offset:24960
    v_perm_b32 v153, v158, v158, v213
    v_perm_b32 v154, v158, v158, v214
    v_mfma_f32_16x16x32_bf16 v[184:187], v[40:43], v[64:67], 0
    ds_read_b64 v[100:101], v210 offset:28160
    v_perm_b32 v155, v158, v158, v215
    v_mfma_f32_16x16x32_bf16 v[160:163], v[140:143], v[68:71], v[160:163]
    ds_read_b64 v[102:103], v210 offset:28800
    v_perm_b32 v156, v159, v159, v212
    v_mfma_f32_16x16x32_bf16 v[172:175], v[116:119], v[68:71], v[172:175]
    global_load_dwordx4 v[248:251], v14, s[56:57] offset:-1024
    v_perm_b32 v157, v159, v159, v213
    v_perm_b32 v158, v159, v159, v214
    v_mfma_f32_16x16x32_bf16 v[184:187], v[44:47], v[68:71], v[184:187]
    v_perm_b32 v159, v159, v159, v215
    v_mfma_f32_16x16x32_bf16 v[164:167], v[144:147], v[72:75], v[164:167]
    ds_read_b64 v[104:105], v210 offset:25600
    v_perm_b32 v16, v22, v22, v212
    v_mfma_f32_16x16x32_bf16 v[176:179], v[120:123], v[72:75], v[176:179]
    ds_read_b64 v[106:107], v210 offset:26240
    v_perm_b32 v17, v22, v22, v213
    v_perm_b32 v18, v22, v22, v214
    v_mfma_f32_16x16x32_bf16 v[188:191], v[48:51], v[72:75], 0
    ds_read_b64 v[108:109], v210 offset:29440
    v_perm_b32 v19, v22, v22, v215
    v_mfma_f32_16x16x32_bf16 v[164:167], v[148:151], v[76:79], v[164:167]
    ds_read_b64 v[110:111], v210 offset:30080
    v_perm_b32 v20, v23, v23, v212
    v_mfma_f32_16x16x32_bf16 v[176:179], v[124:127], v[76:79], v[176:179]
    s_add_u32 m0, s41, 101376
    s_add_u32 s63, s40, 64
    buffer_load_dwordx4 v226, s[32:35], s63 offen lds
    v_perm_b32 v21, v23, v23, v213
    v_perm_b32 v22, v23, v23, v214
    v_mfma_f32_16x16x32_bf16 v[188:191], v[52:55], v[76:79], v[188:191]
    v_perm_b32 v23, v23, v23, v215
    s_setprio 0
    v_mfma_f32_16x16x32_bf16 v[168:171], v[152:155], v[80:83], v[168:171]
    s_add_u32 m0, s41, 102400
    s_add_u32 s63, s40, 12352
    buffer_load_dwordx4 v226, s[32:35], s63 offen lds
    v_perm_b32 v24, v30, v30, v212
    v_perm_b32 v25, v30, v30, v213
    v_mfma_f32_16x16x32_bf16 v[180:183], v[128:131], v[80:83], v[180:183]
    v_perm_b32 v26, v30, v30, v214
    v_mfma_f32_16x16x32_bf16 v[192:195], v[56:59], v[80:83], 0
    v_perm_b32 v27, v30, v30, v215
    v_perm_b32 v28, v31, v31, v212
    s_waitcnt lgkmcnt(1)
    s_nop 0
    v_mfma_f32_16x16x32_bf16 v[168:171], v[156:159], v[84:87], v[168:171]
    v_perm_b32 v29, v31, v31, v213
    v_mfma_f32_16x16x32_bf16 v[180:183], v[132:135], v[84:87], v[180:183]
    v_perm_b32 v30, v31, v31, v214
    v_perm_b32 v31, v31, v31, v215
    v_mfma_f32_16x16x32_bf16 v[192:195], v[60:63], v[84:87], v[192:195]
    v_mov_b32 v236, 0
    v_mov_b32 v237, 0
    v_mov_b32 v238, 0
    v_mov_b32 v239, 0
    s_mov_b64 exec, 0xfff
    ds_write_b128 v227, v[236:239] offset:9984
    s_mov_b64 exec, 7
    ds_write_b128 v227, v[236:239] offset:13216
    s_mov_b64 exec, -1
    s_waitcnt vmcnt(4) lgkmcnt(0)
    s_barrier
    s_setprio 3
    s_nop 0
    v_mfma_f32_16x16x32_bf16 v[160:163], v[16:19], v[88:91], v[160:163]
    ds_read_b64 v[64:65], v211 offset:0
    ds_read_b64 v[66:67], v211 offset:640
    v_perm_b32 v32, v38, v38, v212
    v_mfma_f32_16x16x32_bf16 v[172:175], v[136:139], v[88:91], v[172:175]
    ds_read_b64 v[68:69], v211 offset:3840
    v_perm_b32 v33, v38, v38, v213
    v_mfma_f32_16x16x32_bf16 v[184:187], v[112:115], v[88:91], v[184:187]
    ds_read_b64 v[70:71], v211 offset:4480
    v_perm_b32 v34, v38, v38, v214
    v_mfma_f32_16x16x32_bf16 v[196:199], v[40:43], v[88:91], 0
    ds_read_b64 v[72:73], v211 offset:1280
    v_perm_b32 v35, v38, v38, v215
    v_mfma_f32_16x16x32_bf16 v[160:163], v[20:23], v[92:95], v[160:163]
    ds_read_b64 v[74:75], v211 offset:1920
    v_perm_b32 v36, v39, v39, v212
    v_mfma_f32_16x16x32_bf16 v[172:175], v[140:143], v[92:95], v[172:175]
    ds_read_b64 v[76:77], v211 offset:5120
    v_perm_b32 v37, v39, v39, v213
    v_mfma_f32_16x16x32_bf16 v[184:187], v[116:119], v[92:95], v[184:187]
    ds_read_b64 v[78:79], v211 offset:5760
    v_perm_b32 v38, v39, v39, v214
    v_mfma_f32_16x16x32_bf16 v[196:199], v[44:47], v[92:95], v[196:199]
    s_add_u32 m0, s41, 103424
    s_add_u32 s63, s40, 24640
    buffer_load_dwordx4 v226, s[32:35], s63 offen lds
    v_perm_b32 v39, v39, v39, v215
    v_mfma_f32_16x16x32_bf16 v[164:167], v[24:27], v[96:99], v[164:167]
    ds_read_b64 v[80:81], v211 offset:2560
    v_add_f32_e64 v220, v160, v161
    v_mfma_f32_16x16x32_bf16 v[176:179], v[144:147], v[96:99], v[176:179]
    ds_read_b64 v[82:83], v211 offset:3200
    v_mul_f32_e64 v222, v160, v160
    v_mfma_f32_16x16x32_bf16 v[188:191], v[120:123], v[96:99], v[188:191]
    v_fmac_f32_e64 v222, v161, v161
    v_mfma_f32_16x16x32_bf16 v[200:203], v[48:51], v[96:99], 0
    ds_read_b64 v[84:85], v211 offset:6400
    v_add_f32_e64 v220, v220, v162
    v_mfma_f32_16x16x32_bf16 v[164:167], v[28:31], v[100:103], v[164:167]
    ds_read_b64 v[86:87], v211 offset:7040
    v_mfma_f32_16x16x32_bf16 v[176:179], v[148:151], v[100:103], v[176:179]
    v_fmac_f32_e64 v222, v162, v162
    v_mfma_f32_16x16x32_bf16 v[188:191], v[124:127], v[100:103], v[188:191]
    s_add_u32 m0, s41, 125952
    s_add_u32 s63, s40, 128
    buffer_load_dwordx4 v226, s[32:35], s63 offen lds
    v_add_f32_e64 v220, v220, v163
    v_mfma_f32_16x16x32_bf16 v[200:203], v[52:55], v[100:103], v[200:203]
    v_fmac_f32 v222, v163, v163
    s_setprio 2
    v_mfma_f32_16x16x32_bf16 v[168:171], v[32:35], v[104:107], v[168:171]
    ds_read_b64 v[88:89], v211 offset:7680
    v_add_f32_e64 v220, v220, v164
    v_mfma_f32_16x16x32_bf16 v[180:183], v[152:155], v[104:107], v[180:183]
    ds_read_b64 v[90:91], v211 offset:8320
    v_fmac_f32_e64 v222, v164, v164
    v_mfma_f32_16x16x32_bf16 v[192:195], v[128:131], v[104:107], v[192:195]
    v_add_f32_e64 v220, v220, v165
    v_mfma_f32_16x16x32_bf16 v[204:207], v[56:59], v[104:107], 0
    ds_read_b64 v[92:93], v211 offset:11520
    v_fmac_f32_e64 v222, v165, v165
    v_mfma_f32_16x16x32_bf16 v[168:171], v[36:39], v[108:111], v[168:171]
    ds_read_b64 v[94:95], v211 offset:12160
    v_add_f32_e64 v220, v220, v166
    v_mfma_f32_16x16x32_bf16 v[180:183], v[156:159], v[108:111], v[180:183]
    v_fmac_f32_e64 v222, v166, v166
    v_mfma_f32_16x16x32_bf16 v[192:195], v[132:135], v[108:111], v[192:195]
    s_add_u32 m0, s41, 126976
    s_add_u32 s63, s40, 12416
    buffer_load_dwordx4 v226, s[32:35], s63 offen lds
    v_add_f32_e64 v220, v220, v167
    v_mfma_f32_16x16x32_bf16 v[204:207], v[60:63], v[108:111], v[204:207]
    v_fmac_f32 v222, v167, v167
    s_waitcnt lgkmcnt(4)
    v_mfma_f32_16x16x32_bf16 v[172:175], v[16:19], v[64:67], v[172:175]
    ds_read_b64 v[96:97], v211 offset:8960
    ds_read_b64 v[98:99], v211 offset:9600
    v_add_f32_e64 v220, v220, v168
    v_mfma_f32_16x16x32_bf16 v[184:187], v[136:139], v[64:67], v[184:187]
    ds_read_b64 v[100:101], v211 offset:12800
    v_fmac_f32 v222, v168, v168
    v_add_f32 v220, v220, v169
    v_mfma_f32_16x16x32_bf16 v[196:199], v[112:115], v[64:67], v[196:199]
    ds_read_b64 v[102:103], v211 offset:13440
    v_fmac_f32_e64 v222, v169, v169
    v_mfma_f32_16x16x32_bf16 v[172:175], v[20:23], v[68:71], v[172:175]
    s_add_u32 m0, s41, 128000
    s_add_u32 s63, s40, 24704
    buffer_load_dwordx4 v226, s[32:35], s63 offen lds
    s_waitcnt vmcnt(6)
    ds_read_b64_tr_b16 v[40:41], v249 offset:0
    v_add_f32 v220, v220, v170
    v_mfma_f32_16x16x32_bf16 v[184:187], v[140:143], v[68:71], v[184:187]
    ds_read_b64_tr_b16 v[42:43], v249 offset:256
    v_fmac_f32 v222, v170, v170
    v_add_f32 v220, v220, v171
    v_mfma_f32_16x16x32_bf16 v[196:199], v[116:119], v[68:71], v[196:199]
    ds_read_b64_tr_b16 v[44:45], v249 offset:1024
    v_fmac_f32 v222, v171, v171
    s_setprio 1
    v_mfma_f32_16x16x32_bf16 v[176:179], v[24:27], v[72:75], v[176:179]
    ds_read_b64 v[104:105], v211 offset:10240
    ds_read_b64 v[106:107], v211 offset:10880
    v_add_f32_e64 v221, v172, v173
    v_mfma_f32_16x16x32_bf16 v[188:191], v[144:147], v[72:75], v[188:191]
    ds_read_b64 v[108:109], v211 offset:14080
    v_mul_f32_e64 v223, v172, v172
    v_mfma_f32_16x16x32_bf16 v[200:203], v[120:123], v[72:75], v[200:203]
    ds_read_b64 v[110:111], v211 offset:14720
    v_fmac_f32 v223, v173, v173
    v_add_f32 v221, v221, v174
    v_mfma_f32_16x16x32_bf16 v[176:179], v[28:31], v[76:79], v[176:179]
    global_load_dwordx4 v[252:255], v14, s[56:57] offset:0
    ds_read_b64_tr_b16 v[46:47], v249 offset:1280
    v_fmac_f32_e64 v223, v174, v174
    v_mfma_f32_16x16x32_bf16 v[188:191], v[148:151], v[76:79], v[188:191]
    ds_read_b64_tr_b16 v[48:49], v249 offset:2048
    v_add_f32_e64 v221, v221, v175
    v_mfma_f32_16x16x32_bf16 v[200:203], v[124:127], v[76:79], v[200:203]
    ds_read_b64_tr_b16 v[50:51], v249 offset:2304
    v_fmac_f32_e64 v223, v175, v175
    v_mfma_f32_16x16x32_bf16 v[180:183], v[32:35], v[80:83], v[180:183]
    ds_read_b64 v[64:65], v211 offset:15360
    ds_read_b64 v[66:67], v211 offset:16000
    v_add_f32_e64 v221, v221, v176
    v_mfma_f32_16x16x32_bf16 v[192:195], v[152:155], v[80:83], v[192:195]
    ds_read_b64 v[68:69], v211 offset:19200
    v_fmac_f32 v223, v176, v176
    v_add_f32 v221, v221, v177
    v_mfma_f32_16x16x32_bf16 v[204:207], v[128:131], v[80:83], v[204:207]
    ds_read_b64 v[70:71], v211 offset:19840
    v_fmac_f32_e64 v223, v177, v177
    v_mfma_f32_16x16x32_bf16 v[180:183], v[36:39], v[84:87], v[180:183]
    global_load_dwordx4 v[2:5], v14, s[56:57] offset:1024
    ds_read_b64_tr_b16 v[52:53], v249 offset:3072
    v_add_f32_e64 v221, v221, v178
    v_mfma_f32_16x16x32_bf16 v[192:195], v[156:159], v[84:87], v[192:195]
    ds_read_b64_tr_b16 v[54:55], v249 offset:3328
    v_fmac_f32 v223, v178, v178
    v_add_f32 v221, v221, v179
    v_mfma_f32_16x16x32_bf16 v[204:207], v[132:135], v[84:87], v[204:207]
    ds_read_b64_tr_b16 v[56:57], v249 offset:4096
    v_fmac_f32 v223, v179, v179
    s_waitcnt lgkmcnt(7)
    v_mfma_f32_16x16x32_bf16 v[184:187], v[16:19], v[88:91], v[184:187]
    ds_read_b64 v[72:73], v211 offset:16640
    ds_read_b64 v[74:75], v211 offset:17280
    v_add_f32 v221, v221, v180
    v_fmac_f32 v223, v180, v180
    v_mfma_f32_16x16x32_bf16 v[196:199], v[136:139], v[88:91], v[196:199]
    ds_read_b64 v[76:77], v211 offset:20480
    ds_read_b64 v[78:79], v211 offset:21120
    v_add_f32 v221, v221, v181
    v_fmac_f32 v223, v181, v181
    v_add_f32_e64 v221, v221, v182
    v_mfma_f32_16x16x32_bf16 v[184:187], v[20:23], v[92:95], v[184:187]
    ds_read_b64_tr_b16 v[58:59], v249 offset:4352
    ds_read_b64_tr_b16 v[60:61], v249 offset:5120
    v_fmac_f32 v223, v182, v182
    v_add_f32 v221, v221, v183
    v_mfma_f32_16x16x32_bf16 v[196:199], v[140:143], v[92:95], v[196:199]
    ds_read_b64_tr_b16 v[62:63], v249 offset:5376
    v_fmac_f32_e64 v223, v183, v183
    ds_write_b128 v240, v[220:223] offset:0
    s_setprio 0
    v_mfma_f32_16x16x32_bf16 v[188:191], v[24:27], v[96:99], v[188:191]
    ds_read_b64 v[80:81], v211 offset:17920
    v_add_f32 v220, v184, v185
    v_mul_f32_e64 v222, v184, v184
    v_mfma_f32_16x16x32_bf16 v[200:203], v[144:147], v[96:99], v[200:203]
    ds_read_b64 v[82:83], v211 offset:18560
    v_fmac_f32 v222, v185, v185
    v_add_f32 v220, v220, v186
    v_mfma_f32_16x16x32_bf16 v[188:191], v[28:31], v[100:103], v[188:191]
    ds_read_b64 v[84:85], v211 offset:21760
    v_fmac_f32_e64 v222, v186, v186
    v_mfma_f32_16x16x32_bf16 v[200:203], v[148:151], v[100:103], v[200:203]
    ds_read_b64 v[86:87], v211 offset:22400
    v_add_f32 v220, v220, v187
    v_fmac_f32 v222, v187, v187
    v_mfma_f32_16x16x32_bf16 v[192:195], v[32:35], v[104:107], v[192:195]
    s_nop 0
    v_add_f32 v220, v220, v188
    v_fmac_f32_e64 v222, v188, v188
    v_mfma_f32_16x16x32_bf16 v[204:207], v[152:155], v[104:107], v[204:207]
    v_add_f32 v220, v220, v189
    v_fmac_f32 v222, v189, v189
    v_mfma_f32_16x16x32_bf16 v[192:195], v[36:39], v[108:111], v[192:195]
    v_add_f32 v220, v220, v190
    v_fmac_f32 v222, v190, v190
    v_mfma_f32_16x16x32_bf16 v[204:207], v[156:159], v[108:111], v[204:207]
    v_add_f32 v220, v220, v191
    v_fmac_f32_e64 v222, v191, v191
    s_waitcnt vmcnt(5) lgkmcnt(4)
    s_barrier
    s_setprio 3
    v_mfma_f32_16x16x32_bf16 v[196:199], v[16:19], v[64:67], v[196:199]
    ds_read_b64_tr_b16 v[112:113], v249 offset:24576
    ds_read_b64_tr_b16 v[114:115], v249 offset:24832
    ds_read_b64_tr_b16 v[116:117], v249 offset:25600
    v_add_f32 v220, v220, v192
    v_fmac_f32 v222, v192, v192
    v_add_f32 v220, v220, v193
    v_fmac_f32 v222, v193, v193
    v_mfma_f32_16x16x32_bf16 v[196:199], v[20:23], v[68:71], v[196:199]
    ds_read_b64_tr_b16 v[118:119], v249 offset:25856
    ds_read_b64_tr_b16 v[120:121], v249 offset:26624
    ds_read_b64_tr_b16 v[122:123], v249 offset:26880
    v_add_f32 v220, v220, v194
    v_fmac_f32 v222, v194, v194
    v_add_f32 v220, v220, v195
    v_fmac_f32_e64 v222, v195, v195
    s_setprio 2
    v_mfma_f32_16x16x32_bf16 v[200:203], v[24:27], v[72:75], v[200:203]
    ds_read_b64_tr_b16 v[124:125], v249 offset:27648
    ds_read_b64_tr_b16 v[126:127], v249 offset:27904
    ds_read_b64_tr_b16 v[128:129], v249 offset:28672
    ds_read_b64_tr_b16 v[130:131], v249 offset:28928
    v_add_f32 v221, v196, v197
    v_mul_f32 v223, v196, v196
    v_fmac_f32 v223, v197, v197
    v_add_f32 v221, v221, v198
    v_mfma_f32_16x16x32_bf16 v[200:203], v[28:31], v[76:79], v[200:203]
    ds_read_b64_tr_b16 v[132:133], v249 offset:29696
    ds_read_b64_tr_b16 v[134:135], v249 offset:29952
    s_cmp_ge_u32 s22, 2
    s_cbranch_scc1 L_c_4
    global_load_dword v228, v232, s[18:19] sc1
L_c_4:
    v_fmac_f32 v223, v198, v198
    v_add_f32 v221, v221, v199
    v_fmac_f32_e64 v223, v199, v199
    ds_read_b128 v[88:91], v227 offset:2048
    ds_read_b128 v[92:95], v227 offset:3072
    ds_read_b128 v[96:99], v227 offset:4096
    ds_read_b128 v[100:103], v227 offset:5120
    ds_read_b128 v[104:107], v227 offset:6144
    ds_read_b128 v[108:111], v227 offset:7168
    s_setprio 1
    s_waitcnt lgkmcnt(9)
    v_mfma_f32_16x16x32_bf16 v[204:207], v[32:35], v[80:83], v[204:207]
    v_add_f32 v221, v221, v200
    v_fmac_f32 v223, v200, v200
    v_add_f32 v221, v221, v201
    v_fmac_f32 v223, v201, v201
    v_mfma_f32_16x16x32_bf16 v[204:207], v[36:39], v[84:87], v[204:207]
    v_add_f32 v221, v221, v202
    v_fmac_f32 v223, v202, v202
    v_add_f32 v221, v221, v203
    v_fmac_f32 v223, v203, v203
    ds_read_b128 v[80:83], v227 offset:0
    ds_read_b128 v[84:87], v227 offset:1024
    s_nop 1
    v_add_f32 v221, v221, v204
    v_fmac_f32 v223, v204, v204
    v_add_f32 v221, v221, v205
    v_fmac_f32 v223, v205, v205
    v_add_f32 v221, v221, v206
    v_fmac_f32 v223, v206, v206
    v_add_f32 v221, v221, v207
    v_fmac_f32_e64 v223, v207, v207
    ds_write_b128 v241, v[220:223] offset:57600
    s_waitcnt lgkmcnt(3)
    s_nop 0
    v_pk_add_f32 v[88:89], v[88:89], v[92:93]
    v_pk_add_f32 v[90:91], v[90:91], v[94:95]
    v_pk_add_f32 v[96:97], v[96:97], v[100:101]
    v_pk_add_f32 v[98:99], v[98:99], v[102:103]
    v_pk_add_f32 v[104:105], v[104:105], v[108:109]
    v_pk_add_f32 v[106:107], v[106:107], v[110:111]
    s_waitcnt lgkmcnt(1)
    s_nop 0
    v_pk_add_f32 v[80:81], v[80:81], v[84:85]
    v_pk_add_f32 v[82:83], v[82:83], v[86:87]
    v_pk_add_f32 v[96:97], v[96:97], v[104:105]
    v_pk_add_f32 v[98:99], v[98:99], v[106:107]
    v_pk_add_f32 v[80:81], v[80:81], v[88:89]
    v_pk_add_f32 v[82:83], v[82:83], v[90:91]
    v_pk_add_f32 v[80:81], v[80:81], v[96:97]
    v_pk_add_f32 v[82:83], v[82:83], v[98:99]
    v_pk_mul_f32 v[80:81], v[80:81], s[60:61] op_sel_hi:[1,0]
    v_pk_fma_f32 v[84:85], v[80:81], v[80:81], s[60:61] op_sel:[0,0,1] op_sel_hi:[1,1,1] neg_lo:[1,0,0] neg_hi:[1,0,0]
    v_pk_fma_f32 v[84:85], v[82:83], s[60:61], v[84:85] op_sel_hi:[1,0,1]
    v_rsq_f32_e64 v84, |v84|
    v_rsq_f32_e64 v85, |v85|
    s_nop 0
    s_nop 0
    v_pk_mul_f32 v[84:85], v[84:85], s[52:53] op_sel_hi:[1,0]
    v_pk_mul_f32 v[80:81], v[80:81], v[84:85]
    v_pk_fma_f32 v[160:161], v[160:161], v[84:85], v[80:81] op_sel:[0,0,0] op_sel_hi:[1,0,0] neg_lo:[0,0,1] neg_hi:[0,0,1]
    v_pk_fma_f32 v[162:163], v[162:163], v[84:85], v[80:81] op_sel:[0,0,0] op_sel_hi:[1,0,0] neg_lo:[0,0,1] neg_hi:[0,0,1]
    v_pk_fma_f32 v[164:165], v[164:165], v[84:85], v[80:81] op_sel:[0,0,0] op_sel_hi:[1,0,0] neg_lo:[0,0,1] neg_hi:[0,0,1]
    v_cvt_pk_bf16_f32 v160, v160, v161
    v_cvt_pk_bf16_f32 v161, v162, v163
    v_pk_fma_f32 v[166:167], v[166:167], v[84:85], v[80:81] op_sel:[0,0,0] op_sel_hi:[1,0,0] neg_lo:[0,0,1] neg_hi:[0,0,1]
    ds_write_b64 v216, v[160:161] offset:0
    v_pk_fma_f32 v[168:169], v[168:169], v[84:85], v[80:81] op_sel:[0,0,0] op_sel_hi:[1,0,0] neg_lo:[0,0,1] neg_hi:[0,0,1]
    v_cvt_pk_bf16_f32 v164, v164, v165
    v_cvt_pk_bf16_f32 v165, v166, v167
    v_pk_fma_f32 v[170:171], v[170:171], v[84:85], v[80:81] op_sel:[0,0,0] op_sel_hi:[1,0,0] neg_lo:[0,0,1] neg_hi:[0,0,1]
    ds_write_b64 v216, v[164:165] offset:64
    v_pk_fma_f32 v[172:173], v[172:173], v[84:85], v[80:81] op_sel:[0,1,1] op_sel_hi:[1,1,1] neg_lo:[0,0,1] neg_hi:[0,0,1]
    v_cvt_pk_bf16_f32 v168, v168, v169
    v_cvt_pk_bf16_f32 v169, v170, v171
    v_pk_fma_f32 v[174:175], v[174:175], v[84:85], v[80:81] op_sel:[0,1,1] op_sel_hi:[1,1,1] neg_lo:[0,0,1] neg_hi:[0,0,1]
    ds_write_b64 v216, v[168:169] offset:128
    v_pk_fma_f32 v[176:177], v[176:177], v[84:85], v[80:81] op_sel:[0,1,1] op_sel_hi:[1,1,1] neg_lo:[0,0,1] neg_hi:[0,0,1]
    v_cvt_pk_bf16_f32 v172, v172, v173
    v_cvt_pk_bf16_f32 v173, v174, v175
    v_pk_fma_f32 v[178:179], v[178:179], v[84:85], v[80:81] op_sel:[0,1,1] op_sel_hi:[1,1,1] neg_lo:[0,0,1] neg_hi:[0,0,1]
    ds_write_b64 v217, v[172:173] offset:0
    v_pk_fma_f32 v[180:181], v[180:181], v[84:85], v[80:81] op_sel:[0,1,1] op_sel_hi:[1,1,1] neg_lo:[0,0,1] neg_hi:[0,0,1]
    v_cvt_pk_bf16_f32 v176, v176, v177
    v_cvt_pk_bf16_f32 v177, v178, v179
    v_pk_fma_f32 v[182:183], v[182:183], v[84:85], v[80:81] op_sel:[0,1,1] op_sel_hi:[1,1,1] neg_lo:[0,0,1] neg_hi:[0,0,1]
    ds_write_b64 v217, v[176:177] offset:64
    v_cvt_pk_bf16_f32 v180, v180, v181
    v_cvt_pk_bf16_f32 v181, v182, v183
    ds_write_b64 v217, v[180:181] offset:128
    s_waitcnt vmcnt(2) lgkmcnt(0)
    s_barrier
    ds_read_b128 v[72:75], v15 offset:59648
    ds_read_b128 v[76:79], v15 offset:60672
    ds_read_b128 v[80:83], v15 offset:61696
    ds_read_b128 v[84:87], v15 offset:62720
    ds_read_b128 v[88:91], v15 offset:63744
    ds_read_b128 v[92:95], v15 offset:64768
    ds_read_b128 v[64:67], v15 offset:57600
    ds_read_b128 v[68:71], v15 offset:58624
    s_waitcnt lgkmcnt(6)
    v_pk_add_f32 v[72:73], v[72:73], v[76:77]
    ds_read_b128 v[16:19], v248 offset:0
    v_pk_add_f32 v[74:75], v[74:75], v[78:79]
    s_waitcnt lgkmcnt(5)
    v_pk_add_f32 v[80:81], v[80:81], v[84:85]
    v_pk_add_f32 v[82:83], v[82:83], v[86:87]
    s_waitcnt lgkmcnt(3)
    v_pk_add_f32 v[88:89], v[88:89], v[92:93]
    v_pk_add_f32 v[90:91], v[90:91], v[94:95]
    ds_read_b128 v[20:23], v248 offset:32
    s_waitcnt lgkmcnt(2)
    v_pk_add_f32 v[64:65], v[64:65], v[68:69]
    v_pk_add_f32 v[66:67], v[66:67], v[70:71]
    v_pk_add_f32 v[80:81], v[80:81], v[88:89]
    v_pk_add_f32 v[82:83], v[82:83], v[90:91]
    v_pk_add_f32 v[64:65], v[64:65], v[72:73]
    v_pk_add_f32 v[66:67], v[66:67], v[74:75]
    ds_read_b128 v[24:27], v248 offset:64
    v_pk_add_f32 v[64:65], v[64:65], v[80:81]
    v_pk_add_f32 v[66:67], v[66:67], v[82:83]
    v_pk_mul_f32 v[64:65], v[64:65], s[60:61] op_sel_hi:[1,0]
    v_pk_fma_f32 v[68:69], v[64:65], v[64:65], s[60:61] op_sel:[0,0,1] op_sel_hi:[1,1,1] neg_lo:[1,0,0] neg_hi:[1,0,0]
    v_pk_fma_f32 v[68:69], v[66:67], s[60:61], v[68:69] op_sel_hi:[1,0,1]
    ds_read_b128 v[28:31], v248 offset:96
    v_rsq_f32_e64 v68, |v68|
    v_rsq_f32_e64 v69, |v69|
    s_nop 0
    s_nop 0
    v_pk_mul_f32 v[68:69], v[68:69], s[52:53] op_sel_hi:[1,0]
    v_pk_mul_f32 v[64:65], v[64:65], v[68:69]
    v_pk_fma_f32 v[184:185], v[184:185], v[68:69], v[64:65] op_sel:[0,0,0] op_sel_hi:[1,0,0] neg_lo:[0,0,1] neg_hi:[0,0,1]
    v_pk_fma_f32 v[186:187], v[186:187], v[68:69], v[64:65] op_sel:[0,0,0] op_sel_hi:[1,0,0] neg_lo:[0,0,1] neg_hi:[0,0,1]
    ds_read_b128 v[32:35], v248 offset:128
    v_pk_fma_f32 v[188:189], v[188:189], v[68:69], v[64:65] op_sel:[0,0,0] op_sel_hi:[1,0,0] neg_lo:[0,0,1] neg_hi:[0,0,1]
    v_pk_fma_f32 v[190:191], v[190:191], v[68:69], v[64:65] op_sel:[0,0,0] op_sel_hi:[1,0,0] neg_lo:[0,0,1] neg_hi:[0,0,1]
    v_pk_fma_f32 v[192:193], v[192:193], v[68:69], v[64:65] op_sel:[0,0,0] op_sel_hi:[1,0,0] neg_lo:[0,0,1] neg_hi:[0,0,1]
    v_pk_fma_f32 v[194:195], v[194:195], v[68:69], v[64:65] op_sel:[0,0,0] op_sel_hi:[1,0,0] neg_lo:[0,0,1] neg_hi:[0,0,1]
    v_pk_fma_f32 v[196:197], v[196:197], v[68:69], v[64:65] op_sel:[0,1,1] op_sel_hi:[1,1,1] neg_lo:[0,0,1] neg_hi:[0,0,1]
    ds_read_b128 v[36:39], v248 offset:160
    v_pk_fma_f32 v[198:199], v[198:199], v[68:69], v[64:65] op_sel:[0,1,1] op_sel_hi:[1,1,1] neg_lo:[0,0,1] neg_hi:[0,0,1]
    v_pk_fma_f32 v[200:201], v[200:201], v[68:69], v[64:65] op_sel:[0,1,1] op_sel_hi:[1,1,1] neg_lo:[0,0,1] neg_hi:[0,0,1]
    v_pk_fma_f32 v[202:203], v[202:203], v[68:69], v[64:65] op_sel:[0,1,1] op_sel_hi:[1,1,1] neg_lo:[0,0,1] neg_hi:[0,0,1]
    v_pk_fma_f32 v[204:205], v[204:205], v[68:69], v[64:65] op_sel:[0,1,1] op_sel_hi:[1,1,1] neg_lo:[0,0,1] neg_hi:[0,0,1]
    v_pk_fma_f32 v[206:207], v[206:207], v[68:69], v[64:65] op_sel:[0,1,1] op_sel_hi:[1,1,1] neg_lo:[0,0,1] neg_hi:[0,0,1]
    s_waitcnt lgkmcnt(3)
    s_nop 0
    v_mfma_f32_32x32x16_bf16 v[160:175], v[16:19], v[40:43], 0
    ds_read_b64_tr_b16 v[136:137], v249 offset:49152
    ds_read_b64_tr_b16 v[138:139], v249 offset:49408
    v_cvt_pk_bf16_f32 v184, v184, v185
    v_cvt_pk_bf16_f32 v185, v186, v187
    ds_write_b64 v218, v[184:185] offset:0
    v_mfma_f32_32x32x16_bf16 v[160:175], v[20:23], v[44:47], v[160:175]
    ds_read_b64_tr_b16 v[140:141], v249 offset:50176
    ds_read_b64_tr_b16 v[142:143], v249 offset:50432
    v_cvt_pk_bf16_f32 v188, v188, v189
    v_cvt_pk_bf16_f32 v189, v190, v191
    ds_write_b64 v218, v[188:189] offset:64
    v_mfma_f32_32x32x16_bf16 v[160:175], v[24:27], v[48:51], v[160:175]
    ds_read_b64_tr_b16 v[144:145], v249 offset:51200
    ds_read_b64_tr_b16 v[146:147], v249 offset:51456
    v_cvt_pk_bf16_f32 v192, v192, v193
    v_cvt_pk_bf16_f32 v193, v194, v195
    ds_write_b64 v218, v[192:193] offset:128
    s_waitcnt lgkmcnt(9)
    s_nop 0
    v_mfma_f32_32x32x16_bf16 v[160:175], v[28:31], v[52:55], v[160:175]
    ds_read_b64_tr_b16 v[148:149], v249 offset:52224
    ds_read_b64_tr_b16 v[150:151], v249 offset:52480
    v_cvt_pk_bf16_f32 v196, v196, v197
    v_cvt_pk_bf16_f32 v197, v198, v199
    ds_write_b64 v219, v[196:197] offset:0
    v_mfma_f32_32x32x16_bf16 v[160:175], v[32:35], v[56:59], v[160:175]
    ds_read_b64_tr_b16 v[152:153], v249 offset:53248
    ds_read_b64_tr_b16 v[154:155], v249 offset:53504
    v_cvt_pk_bf16_f32 v200, v200, v201
    v_cvt_pk_bf16_f32 v201, v202, v203
    ds_write_b64 v219, v[200:201] offset:64
    v_mfma_f32_32x32x16_bf16 v[160:175], v[36:39], v[60:63], v[160:175]
    ds_read_b64_tr_b16 v[156:157], v249 offset:54272
    ds_read_b64_tr_b16 v[158:159], v249 offset:54528
    v_cvt_pk_bf16_f32 v204, v204, v205
    v_cvt_pk_bf16_f32 v205, v206, v207
    ds_write_b64 v219, v[204:205] offset:128
    s_cmp_ge_u32 s22, 2
    s_cbranch_scc1 L_c_5
    s_mov_b32 s62, 0x100000
    v_lshlrev_b32 v229, 16, v229
    v_lshlrev_b32 v230, 16, v230
    v_mul_f32 v229, s44, v229
    v_fmac_f32 v229, s45, v230
    s_waitcnt vmcnt(0)
    v_readfirstlane_b32 s23, v228
    v_cndmask_b32 v229, v229, 1.0, s[42:43]
    s_cmp_ge_u32 s23, 34
    s_cbranch_scc1 L_flagok
L_flagspin:
    s_sleep 2
    global_load_dword v228, v232, s[18:19] sc1
    s_waitcnt vmcnt(0)
    s_waitcnt vmcnt(0)
    v_readfirstlane_b32 s23, v228
    s_sub_u32 s62, s62, 1
    s_cmp_le_i32 s62, 0
    s_cbranch_scc1 L_flagok
    s_cmp_lt_u32 s23, 34
    s_cbranch_scc1 L_flagspin
L_flagok:
    global_atomic_add_f32 v231, v229, s[20:21]
L_c_5:
    s_waitcnt lgkmcnt(0)
    s_barrier
    s_nop 0
    ds_read_b128 v[64:67], v248 offset:13312
    ds_read_b128 v[68:71], v248 offset:13344
    ds_read_b128 v[72:75], v248 offset:13376
    ds_read_b128 v[76:79], v248 offset:13408
    ds_read_b128 v[80:83], v248 offset:13440
    ds_read_b128 v[84:87], v248 offset:13472
    ds_read_b128 v[88:91], v248 offset:26624
    ds_read_b128 v[92:95], v248 offset:26656
    ds_read_b128 v[96:99], v248 offset:26688
    ds_read_b128 v[100:103], v248 offset:26720
    ds_read_b128 v[104:107], v248 offset:26752
    ds_read_b128 v[108:111], v248 offset:26784
    s_setprio 3
    s_cmp_lg_u32 s51, 0
    s_cbranch_scc1 L_c_6
    s_nop 0
    ds_read_b128 v[192:195], v250 offset:0
    ds_read_b128 v[196:199], v250 offset:32
    ds_read_b128 v[200:203], v250 offset:64
L_c_6:
    v_pk_fma_f32 v[208:209], v[160:161], v[160:161], s[48:49] neg_lo:[1,0,0] neg_hi:[1,0,0]
    v_pk_fma_f32 v[210:211], v[162:163], v[162:163], s[48:49] neg_lo:[1,0,0] neg_hi:[1,0,0]
    v_pk_fma_f32 v[212:213], v[164:165], v[164:165], s[48:49] neg_lo:[1,0,0] neg_hi:[1,0,0]
    v_pk_fma_f32 v[214:215], v[166:167], v[166:167], s[48:49] neg_lo:[1,0,0] neg_hi:[1,0,0]
    v_pk_fma_f32 v[216:217], v[168:169], v[168:169], s[48:49] neg_lo:[1,0,0] neg_hi:[1,0,0]
    v_pk_fma_f32 v[218:219], v[170:171], v[170:171], s[48:49] neg_lo:[1,0,0] neg_hi:[1,0,0]
    v_pk_fma_f32 v[220:221], v[172:173], v[172:173], s[48:49] neg_lo:[1,0,0] neg_hi:[1,0,0]
    v_pk_fma_f32 v[222:223], v[174:175], v[174:175], s[48:49] neg_lo:[1,0,0] neg_hi:[1,0,0]
    v_pk_mul_f32 v[208:209], v[160:161], v[208:209]
    v_pk_mul_f32 v[210:211], v[162:163], v[210:211]
    v_pk_mul_f32 v[212:213], v[164:165], v[212:213]
    v_pk_mul_f32 v[214:215], v[166:167], v[214:215]
    v_pk_mul_f32 v[216:217], v[168:169], v[216:217]
    v_pk_mul_f32 v[218:219], v[170:171], v[218:219]
    v_pk_mul_f32 v[220:221], v[172:173], v[220:221]
    v_pk_mul_f32 v[222:223], v[174:175], v[222:223]
    s_waitcnt lgkmcnt(0)
    v_mfma_f32_32x32x16_bf16 v[176:191], v[64:67], v[40:43], 0
    v_exp_f32 v208, v208
    v_exp_f32 v209, v209
    v_exp_f32 v210, v210
    v_mfma_f32_32x32x16_bf16 v[176:191], v[68:71], v[44:47], v[176:191]
    v_exp_f32 v211, v211
    v_exp_f32 v212, v212
    v_exp_f32_e64 v213, v213
    v_mfma_f32_32x32x16_bf16 v[176:191], v[72:75], v[48:51], v[176:191]
    v_exp_f32 v214, v214
    v_exp_f32 v215, v215
    v_exp_f32 v216, v216
    v_exp_f32_e64 v217, v217
    s_cmp_lg_u32 s51, 0
    s_cbranch_scc1 L_c_7
    s_waitcnt lgkmcnt(0)
    v_mfma_f32_16x16x32_bf16 v[244:247], v[192:195], v[40:43], 0
    s_waitcnt lgkmcnt(0)
    v_mfma_f32_16x16x32_bf16 v[244:247], v[196:199], v[44:47], v[244:247]
    s_waitcnt lgkmcnt(0)
    v_mfma_f32_16x16x32_bf16 v[244:247], v[200:203], v[48:51], v[244:247]
    ds_read_b128 v[192:195], v250 offset:96
    ds_read_b128 v[196:199], v250 offset:128
    ds_read_b128 v[200:203], v250 offset:160
L_c_7:
    v_exp_f32 v218, v218
    v_exp_f32 v219, v219
    v_exp_f32 v220, v220
    v_exp_f32 v221, v221
    v_exp_f32 v222, v222
    v_exp_f32 v223, v223
    s_waitcnt lgkmcnt(0)
    s_barrier
    v_pk_add_f32 v[208:209], v[208:209], 1.0 op_sel_hi:[1,0]
    v_pk_add_f32 v[210:211], v[210:211], 1.0 op_sel_hi:[1,0]
    v_pk_add_f32 v[212:213], v[212:213], 1.0 op_sel_hi:[1,0]
    v_pk_add_f32 v[214:215], v[214:215], 1.0 op_sel_hi:[1,0]
    v_pk_add_f32 v[216:217], v[216:217], 1.0 op_sel_hi:[1,0]
    v_pk_add_f32 v[218:219], v[218:219], 1.0 op_sel_hi:[1,0]
    v_pk_add_f32 v[220:221], v[220:221], 1.0 op_sel_hi:[1,0]
    v_pk_add_f32 v[222:223], v[222:223], 1.0 op_sel_hi:[1,0]
    v_mfma_f32_32x32x16_bf16 v[176:191], v[76:79], v[52:55], v[176:191]
    v_rcp_f32 v208, v208
    v_rcp_f32 v209, v209
    v_rcp_f32_e64 v210, v210
    v_mfma_f32_32x32x16_bf16 v[176:191], v[80:83], v[56:59], v[176:191]
    v_rcp_f32 v211, v211
    v_rcp_f32 v212, v212
    v_rcp_f32_e64 v213, v213
    v_mfma_f32_32x32x16_bf16 v[176:191], v[84:87], v[60:63], v[176:191]
    v_rcp_f32 v214, v214
    v_rcp_f32 v215, v215
    v_rcp_f32 v216, v216
    v_rcp_f32 v217, v217
    s_cmp_lg_u32 s51, 0
    s_cbranch_scc1 L_c_8
    v_mfma_f32_16x16x32_bf16 v[244:247], v[192:195], v[52:55], v[244:247]
    v_mfma_f32_16x16x32_bf16 v[244:247], v[196:199], v[56:59], v[244:247]
    v_mfma_f32_16x16x32_bf16 v[244:247], v[200:203], v[60:63], v[244:247]
L_c_8:
    v_rcp_f32 v218, v218
    v_rcp_f32 v219, v219
    v_rcp_f32 v220, v220
    v_rcp_f32 v221, v221
    v_rcp_f32 v222, v222
    v_rcp_f32 v223, v223
    v_pk_mul_f32 v[160:161], v[160:161], v[208:209]
    v_pk_mul_f32 v[162:163], v[162:163], v[210:211]
    v_pk_mul_f32 v[232:233], v[160:161], v[160:161]
    v_pk_mul_f32 v[164:165], v[164:165], v[212:213]
    v_pk_fma_f32 v[232:233], v[162:163], v[162:163], v[232:233]
    v_pk_mul_f32 v[166:167], v[166:167], v[214:215]
    v_pk_fma_f32 v[232:233], v[164:165], v[164:165], v[232:233]
    v_pk_mul_f32 v[168:169], v[168:169], v[216:217]
    v_pk_fma_f32 v[232:233], v[166:167], v[166:167], v[232:233]
    v_pk_mul_f32 v[170:171], v[170:171], v[218:219]
    v_pk_fma_f32 v[232:233], v[168:169], v[168:169], v[232:233]
    v_pk_mul_f32 v[172:173], v[172:173], v[220:221]
    v_pk_fma_f32 v[232:233], v[170:171], v[170:171], v[232:233]
    v_pk_mul_f32 v[174:175], v[174:175], v[222:223]
    v_pk_fma_f32 v[232:233], v[172:173], v[172:173], v[232:233]
    v_pk_fma_f32 v[232:233], v[174:175], v[174:175], v[232:233]
    v_cvt_pk_bf16_f32 v224, v160, v161
    v_cvt_pk_bf16_f32 v225, v162, v163
    v_cvt_pk_bf16_f32 v226, v164, v165
    v_cvt_pk_bf16_f32 v227, v166, v167
    s_waitcnt vmcnt(1)
    s_nop 0
    ds_write_b128 v252, v[224:227] offset:0
    v_cvt_pk_bf16_f32 v228, v168, v169
    v_cvt_pk_bf16_f32 v229, v170, v171
    v_cvt_pk_bf16_f32 v230, v172, v173
    v_cvt_pk_bf16_f32 v231, v174, v175
    ds_write_b128 v253, v[228:231] offset:0
    s_cmp_lg_u32 s51, 1
    s_cbranch_scc1 L_c_9
    ds_read_b128 v[192:195], v250 offset:0
    ds_read_b128 v[196:199], v250 offset:32
    ds_read_b128 v[200:203], v250 offset:64
L_c_9:
    v_pk_fma_f32 v[208:209], v[176:177], v[176:177], s[48:49] neg_lo:[1,0,0] neg_hi:[1,0,0]
    global_load_dwordx4 v[6:9], v14, s[56:57] offset:2048
    v_pk_fma_f32 v[210:211], v[178:179], v[178:179], s[48:49] neg_lo:[1,0,0] neg_hi:[1,0,0]
    v_pk_fma_f32 v[212:213], v[180:181], v[180:181], s[48:49] neg_lo:[1,0,0] neg_hi:[1,0,0]
    v_pk_fma_f32 v[214:215], v[182:183], v[182:183], s[48:49] neg_lo:[1,0,0] neg_hi:[1,0,0]
    v_pk_fma_f32 v[216:217], v[184:185], v[184:185], s[48:49] neg_lo:[1,0,0] neg_hi:[1,0,0]
    v_pk_fma_f32 v[218:219], v[186:187], v[186:187], s[48:49] neg_lo:[1,0,0] neg_hi:[1,0,0]
    v_pk_fma_f32 v[220:221], v[188:189], v[188:189], s[48:49] neg_lo:[1,0,0] neg_hi:[1,0,0]
    v_pk_fma_f32 v[222:223], v[190:191], v[190:191], s[48:49] neg_lo:[1,0,0] neg_hi:[1,0,0]
    v_pk_mul_f32 v[208:209], v[176:177], v[208:209]
    v_pk_mul_f32 v[210:211], v[178:179], v[210:211]
    v_pk_mul_f32 v[212:213], v[180:181], v[212:213]
    v_pk_mul_f32 v[214:215], v[182:183], v[214:215]
    v_pk_mul_f32 v[216:217], v[184:185], v[216:217]
    v_pk_mul_f32 v[218:219], v[186:187], v[218:219]
    v_pk_mul_f32 v[220:221], v[188:189], v[220:221]
    v_pk_mul_f32 v[222:223], v[190:191], v[222:223]
    v_mfma_f32_32x32x16_bf16 v[160:175], v[88:91], v[40:43], 0
    v_exp_f32 v208, v208
    v_exp_f32 v209, v209
    v_exp_f32_e64 v210, v210
    v_mfma_f32_32x32x16_bf16 v[160:175], v[92:95], v[44:47], v[160:175]
    global_load_dwordx4 v[10:13], v14, s[56:57] offset:3072
    v_exp_f32 v211, v211
    v_exp_f32 v212, v212
    v_exp_f32_e64 v213, v213
    v_mfma_f32_32x32x16_bf16 v[160:175], v[96:99], v[48:51], v[160:175]
    v_exp_f32 v214, v214
    v_exp_f32 v215, v215
    v_exp_f32 v216, v216
    v_exp_f32_e64 v217, v217
    s_cmp_lg_u32 s51, 1
    s_cbranch_scc1 L_c_10
    s_waitcnt lgkmcnt(0)
    v_mfma_f32_16x16x32_bf16 v[244:247], v[192:195], v[136:139], 0
    s_waitcnt lgkmcnt(0)
    v_mfma_f32_16x16x32_bf16 v[244:247], v[196:199], v[140:143], v[244:247]
    s_waitcnt lgkmcnt(0)
    v_mfma_f32_16x16x32_bf16 v[244:247], v[200:203], v[144:147], v[244:247]
    ds_read_b128 v[192:195], v250 offset:96
    ds_read_b128 v[196:199], v250 offset:128
    ds_read_b128 v[200:203], v250 offset:160
L_c_10:
    v_exp_f32 v218, v218
    v_exp_f32 v219, v219
    v_exp_f32 v220, v220
    v_exp_f32 v221, v221
    v_exp_f32 v222, v222
    v_exp_f32 v223, v223
    v_pk_add_f32 v[208:209], v[208:209], 1.0 op_sel_hi:[1,0]
    v_pk_add_f32 v[210:211], v[210:211], 1.0 op_sel_hi:[1,0]
    v_pk_add_f32 v[212:213], v[212:213], 1.0 op_sel_hi:[1,0]
    v_pk_add_f32 v[214:215], v[214:215], 1.0 op_sel_hi:[1,0]
    v_pk_add_f32 v[216:217], v[216:217], 1.0 op_sel_hi:[1,0]
    s_waitcnt vmcnt(2)
    buffer_load_dwordx4 v[204:207], v5, s[24:27], s59 offen offset:0
    v_pk_add_f32 v[218:219], v[218:219], 1.0 op_sel_hi:[1,0]
    v_pk_add_f32 v[220:221], v[220:221], 1.0 op_sel_hi:[1,0]
    v_pk_add_f32 v[222:223], v[222:223], 1.0 op_sel_hi:[1,0]
    v_mfma_f32_32x32x16_bf16 v[160:175], v[100:103], v[52:55], v[160:175]
    v_rcp_f32 v208, v208
    v_rcp_f32 v209, v209
    v_rcp_f32 v210, v210
    v_mfma_f32_32x32x16_bf16 v[160:175], v[104:107], v[56:59], v[160:175]
    v_rcp_f32 v211, v211
    v_rcp_f32 v212, v212
    v_rcp_f32_e64 v213, v213
    v_mfma_f32_32x32x16_bf16 v[160:175], v[108:111], v[60:63], v[160:175]
    v_rcp_f32 v214, v214
    v_rcp_f32 v215, v215
    v_rcp_f32 v216, v216
    v_rcp_f32_e64 v217, v217
    s_cmp_lg_u32 s51, 1
    s_cbranch_scc1 L_c_11
    s_waitcnt lgkmcnt(0)
    v_mfma_f32_16x16x32_bf16 v[244:247], v[192:195], v[148:151], v[244:247]
    s_waitcnt lgkmcnt(0)
    v_mfma_f32_16x16x32_bf16 v[244:247], v[196:199], v[152:155], v[244:247]
    s_waitcnt lgkmcnt(0)
    v_mfma_f32_16x16x32_bf16 v[244:247], v[200:203], v[156:159], v[244:247]
L_c_11:
    v_rcp_f32 v218, v218
    v_rcp_f32 v219, v219
    v_rcp_f32_e64 v220, v220
    buffer_load_dwordx4 v[240:243], v5, s[24:27], s59 offen offset:64
    v_rcp_f32 v221, v221
    v_rcp_f32 v222, v222
    v_rcp_f32_e64 v223, v223
    v_pk_mul_f32 v[176:177], v[176:177], v[208:209]
    v_pk_mul_f32 v[178:179], v[178:179], v[210:211]
    v_pk_fma_f32 v[232:233], v[176:177], v[176:177], v[232:233]
    v_pk_mul_f32 v[180:181], v[180:181], v[212:213]
    v_pk_fma_f32 v[232:233], v[178:179], v[178:179], v[232:233]
    v_pk_mul_f32 v[182:183], v[182:183], v[214:215]
    v_pk_fma_f32 v[232:233], v[180:181], v[180:181], v[232:233]
    v_pk_mul_f32 v[184:185], v[184:185], v[216:217]
    v_pk_fma_f32 v[232:233], v[182:183], v[182:183], v[232:233]
    v_pk_mul_f32 v[186:187], v[186:187], v[218:219]
    v_pk_fma_f32 v[232:233], v[184:185], v[184:185], v[232:233]
    v_pk_mul_f32 v[188:189], v[188:189], v[220:221]
    v_pk_fma_f32 v[232:233], v[186:187], v[186:187], v[232:233]
    v_pk_mul_f32 v[190:191], v[190:191], v[222:223]
    v_pk_fma_f32 v[232:233], v[188:189], v[188:189], v[232:233]
    v_pk_fma_f32 v[232:233], v[190:191], v[190:191], v[232:233]
    v_cvt_pk_bf16_f32 v224, v176, v177
    v_cvt_pk_bf16_f32 v225, v178, v179
    v_cvt_pk_bf16_f32 v226, v180, v181
    v_cvt_pk_bf16_f32 v227, v182, v183
    ds_write_b128 v252, v[224:227] offset:128
    v_cvt_pk_bf16_f32 v228, v184, v185
    v_cvt_pk_bf16_f32 v229, v186, v187
    v_cvt_pk_bf16_f32 v230, v188, v189
    v_cvt_pk_bf16_f32 v231, v190, v191
    ds_write_b128 v253, v[228:231] offset:128
    s_cmp_lg_u32 s51, 0
    s_cbranch_scc1 L_c_12
    ds_read_b128 v[192:195], v251 offset:0
    ds_read_b128 v[196:199], v251 offset:32
    ds_read_b128 v[200:203], v251 offset:64
L_c_12:
    v_pk_fma_f32 v[208:209], v[160:161], v[160:161], s[48:49] neg_lo:[1,0,0] neg_hi:[1,0,0]
    buffer_load_dwordx4 v[40:43], v2, s[24:27], s59 offen offset:0
    v_pk_fma_f32 v[210:211], v[162:163], v[162:163], s[48:49] neg_lo:[1,0,0] neg_hi:[1,0,0]
    v_pk_fma_f32 v[212:213], v[164:165], v[164:165], s[48:49] neg_lo:[1,0,0] neg_hi:[1,0,0]
    v_pk_fma_f32 v[214:215], v[166:167], v[166:167], s[48:49] neg_lo:[1,0,0] neg_hi:[1,0,0]
    v_pk_fma_f32 v[216:217], v[168:169], v[168:169], s[48:49] neg_lo:[1,0,0] neg_hi:[1,0,0]
    v_pk_fma_f32 v[218:219], v[170:171], v[170:171], s[48:49] neg_lo:[1,0,0] neg_hi:[1,0,0]
    v_pk_fma_f32 v[220:221], v[172:173], v[172:173], s[48:49] neg_lo:[1,0,0] neg_hi:[1,0,0]
    v_pk_fma_f32 v[222:223], v[174:175], v[174:175], s[48:49] neg_lo:[1,0,0] neg_hi:[1,0,0]
    v_pk_mul_f32 v[208:209], v[160:161], v[208:209]
    v_pk_mul_f32 v[210:211], v[162:163], v[210:211]
    v_pk_mul_f32 v[212:213], v[164:165], v[212:213]
    v_pk_mul_f32 v[214:215], v[166:167], v[214:215]
    v_pk_mul_f32 v[216:217], v[168:169], v[216:217]
    v_pk_mul_f32 v[218:219], v[170:171], v[218:219]
    v_pk_mul_f32 v[220:221], v[172:173], v[220:221]
    v_pk_mul_f32 v[222:223], v[174:175], v[222:223]
    v_mfma_f32_32x32x16_bf16 v[176:191], v[16:19], v[112:115], 0
    v_exp_f32 v208, v208
    v_exp_f32 v209, v209
    v_exp_f32_e64 v210, v210
    v_mfma_f32_32x32x16_bf16 v[176:191], v[20:23], v[116:119], v[176:191]
    v_exp_f32 v211, v211
    v_exp_f32 v212, v212
    v_exp_f32_e64 v213, v213
    v_mfma_f32_32x32x16_bf16 v[176:191], v[24:27], v[120:123], v[176:191]
    v_exp_f32 v214, v214
    v_exp_f32 v215, v215
    buffer_load_dwordx4 v[44:47], v2, s[24:27], s59 offen offset:64
    v_exp_f32 v216, v216
    v_exp_f32_e64 v217, v217
    s_cmp_lg_u32 s51, 0
    s_cbranch_scc1 L_c_13
    s_waitcnt lgkmcnt(0)
    v_mfma_f32_16x16x32_bf16 v[244:247], v[192:195], v[112:115], v[244:247]
    s_waitcnt lgkmcnt(0)
    v_mfma_f32_16x16x32_bf16 v[244:247], v[196:199], v[116:119], v[244:247]
    s_waitcnt lgkmcnt(0)
    v_mfma_f32_16x16x32_bf16 v[244:247], v[200:203], v[120:123], v[244:247]
    ds_read_b128 v[192:195], v251 offset:96
    ds_read_b128 v[196:199], v251 offset:128
    ds_read_b128 v[200:203], v251 offset:160
L_c_13:
    v_exp_f32 v218, v218
    v_exp_f32 v219, v219
    v_exp_f32 v220, v220
    v_exp_f32 v221, v221
    v_exp_f32 v222, v222
    v_exp_f32 v223, v223
    v_pk_add_f32 v[208:209], v[208:209], 1.0 op_sel_hi:[1,0]
    v_pk_add_f32 v[210:211], v[210:211], 1.0 op_sel_hi:[1,0]
    v_pk_add_f32 v[212:213], v[212:213], 1.0 op_sel_hi:[1,0]
    v_pk_add_f32 v[214:215], v[214:215], 1.0 op_sel_hi:[1,0]
    v_pk_add_f32 v[216:217], v[216:217], 1.0 op_sel_hi:[1,0]
    v_pk_add_f32 v[218:219], v[218:219], 1.0 op_sel_hi:[1,0]
    v_pk_add_f32 v[220:221], v[220:221], 1.0 op_sel_hi:[1,0]
    v_pk_add_f32 v[222:223], v[222:223], 1.0 op_sel_hi:[1,0]
    v_mfma_f32_32x32x16_bf16 v[176:191], v[28:31], v[124:127], v[176:191]
    v_rcp_f32 v208, v208
    v_rcp_f32 v209, v209
    v_rcp_f32_e64 v210, v210
    v_mfma_f32_32x32x16_bf16 v[176:191], v[32:35], v[128:131], v[176:191]
    v_rcp_f32 v211, v211
    v_rcp_f32 v212, v212
    v_rcp_f32_e64 v213, v213
    v_mfma_f32_32x32x16_bf16 v[176:191], v[36:39], v[132:135], v[176:191]
    v_rcp_f32_e64 v214, v214
    buffer_load_dwordx4 v[48:51], v3, s[24:27], s59 offen offset:0
    v_rcp_f32 v215, v215
    v_rcp_f32 v216, v216
    v_rcp_f32 v217, v217
    s_cmp_lg_u32 s51, 0
    s_cbranch_scc1 L_c_14
    s_waitcnt lgkmcnt(0)
    v_mfma_f32_16x16x32_bf16 v[244:247], v[192:195], v[124:127], v[244:247]
    s_waitcnt lgkmcnt(0)
    v_mfma_f32_16x16x32_bf16 v[244:247], v[196:199], v[128:131], v[244:247]
    s_waitcnt lgkmcnt(0)
    v_mfma_f32_16x16x32_bf16 v[244:247], v[200:203], v[132:135], v[244:247]
L_c_14:
    v_rcp_f32 v218, v218
    v_rcp_f32 v219, v219
    v_rcp_f32 v220, v220
    v_rcp_f32 v221, v221
    v_rcp_f32 v222, v222
    v_rcp_f32 v223, v223
    v_pk_mul_f32 v[160:161], v[160:161], v[208:209]
    v_pk_mul_f32 v[162:163], v[162:163], v[210:211]
    v_pk_fma_f32 v[232:233], v[160:161], v[160:161], v[232:233]
    v_pk_mul_f32 v[164:165], v[164:165], v[212:213]
    v_pk_fma_f32 v[232:233], v[162:163], v[162:163], v[232:233]
    v_pk_mul_f32 v[166:167], v[166:167], v[214:215]
    v_pk_fma_f32 v[232:233], v[164:165], v[164:165], v[232:233]
    v_pk_mul_f32 v[168:169], v[168:169], v[216:217]
    v_pk_fma_f32 v[232:233], v[166:167], v[166:167], v[232:233]
    v_pk_mul_f32 v[170:171], v[170:171], v[218:219]
    v_pk_fma_f32 v[232:233], v[168:169], v[168:169], v[232:233]
    v_pk_mul_f32 v[172:173], v[172:173], v[220:221]
    v_pk_fma_f32 v[232:233], v[170:171], v[170:171], v[232:233]
    v_pk_mul_f32 v[174:175], v[174:175], v[222:223]
    v_pk_fma_f32 v[232:233], v[172:173], v[172:173], v[232:233]
    v_pk_fma_f32 v[232:233], v[174:175], v[174:175], v[232:233]
    v_cvt_pk_bf16_f32 v224, v160, v161
    v_cvt_pk_bf16_f32 v225, v162, v163
    v_cvt_pk_bf16_f32 v226, v164, v165
    v_cvt_pk_bf16_f32 v227, v166, v167
    ds_write_b128 v252, v[224:227] offset:256
    v_cvt_pk_bf16_f32 v228, v168, v169
    v_cvt_pk_bf16_f32 v229, v170, v171
    v_cvt_pk_bf16_f32 v230, v172, v173
    v_cvt_pk_bf16_f32 v231, v174, v175
    ds_write_b128 v253, v[228:231] offset:256
    v_add_f32_e64 v232, v232, v233
    ds_write_b32 v255, v232 offset:0
    v_pk_fma_f32 v[208:209], v[244:245], v[244:245], s[48:49] neg_lo:[1,0,0] neg_hi:[1,0,0]
    v_pk_fma_f32 v[210:211], v[246:247], v[246:247], s[48:49] neg_lo:[1,0,0] neg_hi:[1,0,0]
    v_pk_mul_f32 v[208:209], v[244:245], v[208:209]
    v_pk_mul_f32 v[210:211], v[246:247], v[210:211]
    v_exp_f32 v208, v208
    v_exp_f32 v209, v209
    v_exp_f32 v210, v210
    v_exp_f32 v211, v211
    v_pk_add_f32 v[208:209], v[208:209], 1.0 op_sel_hi:[1,0]
    v_pk_add_f32 v[210:211], v[210:211], 1.0 op_sel_hi:[1,0]
    v_rcp_f32 v208, v208
    v_rcp_f32 v209, v209
    v_rcp_f32 v210, v210
    v_rcp_f32 v211, v211
    v_pk_mul_f32 v[244:245], v[244:245], v[208:209]
    v_pk_mul_f32 v[246:247], v[246:247], v[210:211]
    v_pk_mul_f32 v[212:213], v[244:245], v[244:245]
    v_pk_fma_f32 v[212:213], v[246:247], v[246:247], v[212:213]
    v_cvt_pk_bf16_f32 v244, v244, v245
    v_cvt_pk_bf16_f32 v245, v246, v247
    s_cmp_eq_u32 s51, 0
    s_cselect_b32 exec_hi, -1, 0
    v_add_f32_e64 v246, v212, v213
    ds_write_b96 v254, v[244:246]
    s_mov_b32 exec_hi, -1
    s_setprio 2
    v_pk_fma_f32 v[208:209], v[176:177], v[176:177], s[48:49] neg_lo:[1,0,0] neg_hi:[1,0,0]
    buffer_load_dwordx4 v[52:55], v3, s[24:27], s59 offen offset:64
    v_pk_fma_f32 v[210:211], v[178:179], v[178:179], s[48:49] neg_lo:[1,0,0] neg_hi:[1,0,0]
    v_pk_fma_f32 v[212:213], v[180:181], v[180:181], s[48:49] neg_lo:[1,0,0] neg_hi:[1,0,0]
    v_pk_fma_f32 v[214:215], v[182:183], v[182:183], s[48:49] neg_lo:[1,0,0] neg_hi:[1,0,0]
    v_pk_fma_f32 v[216:217], v[184:185], v[184:185], s[48:49] neg_lo:[1,0,0] neg_hi:[1,0,0]
    v_pk_fma_f32 v[218:219], v[186:187], v[186:187], s[48:49] neg_lo:[1,0,0] neg_hi:[1,0,0]
    v_pk_fma_f32 v[220:221], v[188:189], v[188:189], s[48:49] neg_lo:[1,0,0] neg_hi:[1,0,0]
    v_pk_fma_f32 v[222:223], v[190:191], v[190:191], s[48:49] neg_lo:[1,0,0] neg_hi:[1,0,0]
    v_pk_mul_f32 v[208:209], v[176:177], v[208:209]
    v_pk_mul_f32 v[210:211], v[178:179], v[210:211]
    v_pk_mul_f32 v[212:213], v[180:181], v[212:213]
    v_pk_mul_f32 v[214:215], v[182:183], v[214:215]
    v_pk_mul_f32 v[216:217], v[184:185], v[216:217]
    v_pk_mul_f32 v[218:219], v[186:187], v[218:219]
    v_pk_mul_f32 v[220:221], v[188:189], v[220:221]
    v_pk_mul_f32 v[222:223], v[190:191], v[222:223]
    buffer_load_dwordx4 v[56:59], v4, s[24:27], s59 offen offset:0
    v_mfma_f32_32x32x16_bf16 v[160:175], v[64:67], v[112:115], 0
    v_exp_f32 v208, v208
    v_exp_f32 v209, v209
    v_exp_f32_e64 v210, v210
    v_mfma_f32_32x32x16_bf16 v[160:175], v[68:71], v[116:119], v[160:175]
    v_exp_f32 v211, v211
    v_exp_f32 v212, v212
    v_exp_f32_e64 v213, v213
    v_mfma_f32_32x32x16_bf16 v[160:175], v[72:75], v[120:123], v[160:175]
    v_exp_f32 v214, v214
    v_exp_f32 v215, v215
    v_exp_f32 v216, v216
    v_exp_f32 v217, v217
    v_exp_f32 v218, v218
    v_exp_f32 v219, v219
    v_exp_f32_e64 v220, v220
    buffer_load_dwordx4 v[60:63], v4, s[24:27], s59 offen offset:64
    v_exp_f32 v221, v221
    v_exp_f32 v222, v222
    v_exp_f32_e64 v223, v223
    v_pk_add_f32 v[208:209], v[208:209], 1.0 op_sel_hi:[1,0]
    v_pk_add_f32 v[210:211], v[210:211], 1.0 op_sel_hi:[1,0]
    v_pk_add_f32 v[212:213], v[212:213], 1.0 op_sel_hi:[1,0]
    v_pk_add_f32 v[214:215], v[214:215], 1.0 op_sel_hi:[1,0]
    v_pk_add_f32 v[216:217], v[216:217], 1.0 op_sel_hi:[1,0]
    v_pk_add_f32 v[218:219], v[218:219], 1.0 op_sel_hi:[1,0]
    v_pk_add_f32 v[220:221], v[220:221], 1.0 op_sel_hi:[1,0]
    v_pk_add_f32 v[222:223], v[222:223], 1.0 op_sel_hi:[1,0]
    v_mfma_f32_32x32x16_bf16 v[160:175], v[76:79], v[124:127], v[160:175]
    v_rcp_f32 v208, v208
    v_rcp_f32 v209, v209
    v_rcp_f32 v210, v210
    s_movk_i32 s40, 6144
    v_mfma_f32_32x32x16_bf16 v[160:175], v[80:83], v[128:131], v[160:175]
    v_rcp_f32 v211, v211
    v_rcp_f32 v212, v212
    v_rcp_f32_e64 v213, v213
    v_mfma_f32_32x32x16_bf16 v[160:175], v[84:87], v[132:135], v[160:175]
    v_rcp_f32 v214, v214
    v_rcp_f32 v215, v215
    v_rcp_f32 v216, v216
    v_rcp_f32 v217, v217
    v_rcp_f32 v218, v218
    v_rcp_f32 v219, v219
    v_rcp_f32 v220, v220
    v_rcp_f32 v221, v221
    v_rcp_f32 v222, v222
    v_rcp_f32 v223, v223
    v_pk_mul_f32 v[176:177], v[176:177], v[208:209]
    s_movk_i32 s41, 12288
    s_nop 0
    v_pk_mul_f32 v[178:179], v[178:179], v[210:211]
    v_pk_mul_f32 v[234:235], v[176:177], v[176:177]
    v_pk_mul_f32 v[180:181], v[180:181], v[212:213]
    v_pk_fma_f32 v[234:235], v[178:179], v[178:179], v[234:235]
    v_pk_mul_f32 v[182:183], v[182:183], v[214:215]
    v_pk_fma_f32 v[234:235], v[180:181], v[180:181], v[234:235]
    v_pk_mul_f32 v[184:185], v[184:185], v[216:217]
    v_pk_fma_f32 v[234:235], v[182:183], v[182:183], v[234:235]
    v_pk_mul_f32 v[186:187], v[186:187], v[218:219]
    v_pk_fma_f32 v[234:235], v[184:185], v[184:185], v[234:235]
    v_pk_mul_f32 v[188:189], v[188:189], v[220:221]
    v_pk_fma_f32 v[234:235], v[186:187], v[186:187], v[234:235]
    v_pk_mul_f32 v[190:191], v[190:191], v[222:223]
    v_pk_fma_f32 v[234:235], v[188:189], v[188:189], v[234:235]
    v_pk_fma_f32 v[234:235], v[190:191], v[190:191], v[234:235]
    v_cvt_pk_bf16_f32 v224, v176, v177
    v_cvt_pk_bf16_f32 v225, v178, v179
    v_cvt_pk_bf16_f32 v226, v180, v181
    v_cvt_pk_bf16_f32 v227, v182, v183
    ds_write_b128 v252, v[224:227] offset:53248
    v_cvt_pk_bf16_f32 v228, v184, v185
    v_cvt_pk_bf16_f32 v229, v186, v187
    v_cvt_pk_bf16_f32 v230, v188, v189
    v_cvt_pk_bf16_f32 v231, v190, v191
    ds_write_b128 v253, v[228:231] offset:53248
    v_pk_fma_f32 v[208:209], v[160:161], v[160:161], s[48:49] neg_lo:[1,0,0] neg_hi:[1,0,0]
    s_waitcnt vmcnt(9)
    s_nop 0
    buffer_load_dwordx4 v[192:195], v6, s[36:39], s41 offen
    v_pk_fma_f32 v[210:211], v[162:163], v[162:163], s[48:49] neg_lo:[1,0,0] neg_hi:[1,0,0]
    v_pk_fma_f32 v[212:213], v[164:165], v[164:165], s[48:49] neg_lo:[1,0,0] neg_hi:[1,0,0]
    v_pk_fma_f32 v[214:215], v[166:167], v[166:167], s[48:49] neg_lo:[1,0,0] neg_hi:[1,0,0]
    v_pk_fma_f32 v[216:217], v[168:169], v[168:169], s[48:49] neg_lo:[1,0,0] neg_hi:[1,0,0]
    v_pk_fma_f32 v[218:219], v[170:171], v[170:171], s[48:49] neg_lo:[1,0,0] neg_hi:[1,0,0]
    v_pk_fma_f32 v[220:221], v[172:173], v[172:173], s[48:49] neg_lo:[1,0,0] neg_hi:[1,0,0]
    v_pk_fma_f32 v[222:223], v[174:175], v[174:175], s[48:49] neg_lo:[1,0,0] neg_hi:[1,0,0]
    v_pk_mul_f32 v[208:209], v[160:161], v[208:209]
    v_pk_mul_f32 v[210:211], v[162:163], v[210:211]
    v_pk_mul_f32 v[212:213], v[164:165], v[212:213]
    v_pk_mul_f32 v[214:215], v[166:167], v[214:215]
    v_pk_mul_f32 v[216:217], v[168:169], v[216:217]
    v_pk_mul_f32 v[218:219], v[170:171], v[218:219]
    v_pk_mul_f32 v[220:221], v[172:173], v[220:221]
    v_pk_mul_f32 v[222:223], v[174:175], v[222:223]
    buffer_load_dwordx4 v[196:199], v7, s[36:39], s41 offen
    v_mfma_f32_32x32x16_bf16 v[176:191], v[88:91], v[112:115], 0
    v_exp_f32 v208, v208
    v_exp_f32 v209, v209
    v_exp_f32_e64 v210, v210
    v_mfma_f32_32x32x16_bf16 v[176:191], v[92:95], v[116:119], v[176:191]
    v_exp_f32 v211, v211
    v_exp_f32 v212, v212
    v_exp_f32_e64 v213, v213
    v_mfma_f32_32x32x16_bf16 v[176:191], v[96:99], v[120:123], v[176:191]
    v_exp_f32 v214, v214
    v_exp_f32 v215, v215
    v_exp_f32 v216, v216
    v_exp_f32 v217, v217
    v_exp_f32 v218, v218
    v_exp_f32 v219, v219
    v_exp_f32_e64 v220, v220
    buffer_load_dwordx4 v[200:203], v8, s[36:39], s41 offen
    v_exp_f32 v221, v221
    v_exp_f32 v222, v222
    v_exp_f32_e64 v223, v223
    v_pk_add_f32 v[208:209], v[208:209], 1.0 op_sel_hi:[1,0]
    v_pk_add_f32 v[210:211], v[210:211], 1.0 op_sel_hi:[1,0]
    v_pk_add_f32 v[212:213], v[212:213], 1.0 op_sel_hi:[1,0]
    v_pk_add_f32 v[214:215], v[214:215], 1.0 op_sel_hi:[1,0]
    v_pk_add_f32 v[216:217], v[216:217], 1.0 op_sel_hi:[1,0]
    v_pk_add_f32 v[218:219], v[218:219], 1.0 op_sel_hi:[1,0]
    v_pk_add_f32 v[220:221], v[220:221], 1.0 op_sel_hi:[1,0]
    v_pk_add_f32 v[222:223], v[222:223], 1.0 op_sel_hi:[1,0]
    v_mfma_f32_32x32x16_bf16 v[176:191], v[100:103], v[124:127], v[176:191]
    v_rcp_f32 v208, v208
    v_rcp_f32 v209, v209
    v_rcp_f32_e64 v210, v210
    global_load_dwordx4 v[2:5], v14, s[96:97] offset:-4096
    v_mfma_f32_32x32x16_bf16 v[176:191], v[104:107], v[128:131], v[176:191]
    v_rcp_f32 v211, v211
    v_rcp_f32 v212, v212
    v_rcp_f32_e64 v213, v213
    v_mfma_f32_32x32x16_bf16 v[176:191], v[108:111], v[132:135], v[176:191]
    v_rcp_f32 v214, v214
    v_rcp_f32 v215, v215
    v_rcp_f32 v216, v216
    v_rcp_f32 v217, v217
    v_rcp_f32 v218, v218
    v_rcp_f32 v219, v219
    v_rcp_f32 v220, v220
    v_rcp_f32 v221, v221
    v_rcp_f32 v222, v222
    v_rcp_f32 v223, v223
    v_pk_mul_f32 v[160:161], v[160:161], v[208:209]
    global_load_ushort v238, v9, s[12:13]
    v_pk_mul_f32 v[162:163], v[162:163], v[210:211]
    v_pk_fma_f32 v[234:235], v[160:161], v[160:161], v[234:235]
    v_pk_mul_f32 v[164:165], v[164:165], v[212:213]
    v_pk_fma_f32 v[234:235], v[162:163], v[162:163], v[234:235]
    v_pk_mul_f32 v[166:167], v[166:167], v[214:215]
    v_pk_fma_f32 v[234:235], v[164:165], v[164:165], v[234:235]
    v_pk_mul_f32 v[168:169], v[168:169], v[216:217]
    v_pk_fma_f32 v[234:235], v[166:167], v[166:167], v[234:235]
    v_pk_mul_f32 v[170:171], v[170:171], v[218:219]
    v_pk_fma_f32 v[234:235], v[168:169], v[168:169], v[234:235]
    v_pk_mul_f32 v[172:173], v[172:173], v[220:221]
    v_pk_fma_f32 v[234:235], v[170:171], v[170:171], v[234:235]
    v_pk_mul_f32 v[174:175], v[174:175], v[222:223]
    v_pk_fma_f32 v[234:235], v[172:173], v[172:173], v[234:235]
    v_pk_fma_f32 v[234:235], v[174:175], v[174:175], v[234:235]
    v_cvt_pk_bf16_f32 v224, v160, v161
    v_cvt_pk_bf16_f32 v225, v162, v163
    v_cvt_pk_bf16_f32 v226, v164, v165
    v_cvt_pk_bf16_f32 v227, v166, v167
    ds_write_b128 v252, v[224:227] offset:53376
    v_cvt_pk_bf16_f32 v228, v168, v169
    v_cvt_pk_bf16_f32 v229, v170, v171
    v_cvt_pk_bf16_f32 v230, v172, v173
    v_cvt_pk_bf16_f32 v231, v174, v175
    ds_write_b128 v253, v[228:231] offset:53376
    v_pk_fma_f32 v[208:209], v[176:177], v[176:177], s[48:49] neg_lo:[1,0,0] neg_hi:[1,0,0]
    buffer_load_dwordx4 v[112:115], v6, s[36:39], 0 offen
    v_pk_fma_f32 v[210:211], v[178:179], v[178:179], s[48:49] neg_lo:[1,0,0] neg_hi:[1,0,0]
    v_pk_fma_f32 v[212:213], v[180:181], v[180:181], s[48:49] neg_lo:[1,0,0] neg_hi:[1,0,0]
    v_pk_fma_f32 v[214:215], v[182:183], v[182:183], s[48:49] neg_lo:[1,0,0] neg_hi:[1,0,0]
    v_pk_fma_f32 v[216:217], v[184:185], v[184:185], s[48:49] neg_lo:[1,0,0] neg_hi:[1,0,0]
    v_pk_fma_f32 v[218:219], v[186:187], v[186:187], s[48:49] neg_lo:[1,0,0] neg_hi:[1,0,0]
    v_pk_fma_f32 v[220:221], v[188:189], v[188:189], s[48:49] neg_lo:[1,0,0] neg_hi:[1,0,0]
    v_pk_fma_f32 v[222:223], v[190:191], v[190:191], s[48:49] neg_lo:[1,0,0] neg_hi:[1,0,0]
    v_pk_mul_f32 v[208:209], v[176:177], v[208:209]
    v_pk_mul_f32 v[210:211], v[178:179], v[210:211]
    v_pk_mul_f32 v[212:213], v[180:181], v[212:213]
    v_pk_mul_f32 v[214:215], v[182:183], v[214:215]
    v_pk_mul_f32 v[216:217], v[184:185], v[216:217]
    v_pk_mul_f32 v[218:219], v[186:187], v[218:219]
    v_pk_mul_f32 v[220:221], v[188:189], v[220:221]
    v_pk_mul_f32 v[222:223], v[190:191], v[222:223]
    v_mfma_f32_32x32x16_bf16 v[160:175], v[16:19], v[136:139], 0
    v_exp_f32 v208, v208
    v_exp_f32 v209, v209
    v_exp_f32_e64 v210, v210
    buffer_load_dwordx4 v[116:119], v7, s[36:39], 0 offen
    v_mfma_f32_32x32x16_bf16 v[160:175], v[20:23], v[140:143], v[160:175]
    v_exp_f32 v211, v211
    v_exp_f32 v212, v212
    v_exp_f32_e64 v213, v213
    v_mfma_f32_32x32x16_bf16 v[160:175], v[24:27], v[144:147], v[160:175]
    v_exp_f32 v214, v214
    v_exp_f32 v215, v215
    v_exp_f32 v216, v216
    v_exp_f32 v217, v217
    v_exp_f32 v218, v218
    v_exp_f32 v219, v219
    v_exp_f32 v220, v220
    v_exp_f32 v221, v221
    v_exp_f32 v222, v222
    v_exp_f32 v223, v223
    v_pk_add_f32 v[208:209], v[208:209], 1.0 op_sel_hi:[1,0]
    v_pk_add_f32 v[210:211], v[210:211], 1.0 op_sel_hi:[1,0]
    v_pk_add_f32 v[212:213], v[212:213], 1.0 op_sel_hi:[1,0]
    v_pk_add_f32 v[214:215], v[214:215], 1.0 op_sel_hi:[1,0]
    v_pk_add_f32 v[216:217], v[216:217], 1.0 op_sel_hi:[1,0]
    buffer_load_dwordx4 v[120:123], v8, s[36:39], 0 offen
    v_pk_add_f32 v[218:219], v[218:219], 1.0 op_sel_hi:[1,0]
    v_pk_add_f32 v[220:221], v[220:221], 1.0 op_sel_hi:[1,0]
    v_pk_add_f32 v[222:223], v[222:223], 1.0 op_sel_hi:[1,0]
    v_mfma_f32_32x32x16_bf16 v[160:175], v[28:31], v[148:151], v[160:175]
    v_rcp_f32 v208, v208
    v_rcp_f32 v209, v209
    v_rcp_f32_e64 v210, v210
    v_mfma_f32_32x32x16_bf16 v[160:175], v[32:35], v[152:155], v[160:175]
    v_rcp_f32 v211, v211
    v_rcp_f32 v212, v212
    v_rcp_f32_e64 v213, v213
    v_mfma_f32_32x32x16_bf16 v[160:175], v[36:39], v[156:159], v[160:175]
    v_rcp_f32 v214, v214
    v_rcp_f32 v215, v215
    v_rcp_f32 v216, v216
    v_rcp_f32 v217, v217
    v_rcp_f32 v218, v218
    v_rcp_f32 v219, v219
    v_rcp_f32_e64 v220, v220
    global_load_dwordx4 v[248:251], v14, s[96:97] offset:-3072
    v_rcp_f32 v221, v221
    v_rcp_f32 v222, v222
    v_rcp_f32_e64 v223, v223
    v_pk_mul_f32 v[176:177], v[176:177], v[208:209]
    v_pk_mul_f32 v[178:179], v[178:179], v[210:211]
    v_pk_fma_f32 v[234:235], v[176:177], v[176:177], v[234:235]
    v_pk_mul_f32 v[180:181], v[180:181], v[212:213]
    v_pk_fma_f32 v[234:235], v[178:179], v[178:179], v[234:235]
    v_pk_mul_f32 v[182:183], v[182:183], v[214:215]
    v_pk_fma_f32 v[234:235], v[180:181], v[180:181], v[234:235]
    v_pk_mul_f32 v[184:185], v[184:185], v[216:217]
    v_pk_fma_f32 v[234:235], v[182:183], v[182:183], v[234:235]
    v_pk_mul_f32 v[186:187], v[186:187], v[218:219]
    v_pk_fma_f32 v[234:235], v[184:185], v[184:185], v[234:235]
    v_pk_mul_f32 v[188:189], v[188:189], v[220:221]
    v_pk_fma_f32 v[234:235], v[186:187], v[186:187], v[234:235]
    v_pk_mul_f32 v[190:191], v[190:191], v[222:223]
    v_pk_fma_f32 v[234:235], v[188:189], v[188:189], v[234:235]
    v_pk_fma_f32 v[234:235], v[190:191], v[190:191], v[234:235]
    v_cvt_pk_bf16_f32 v224, v176, v177
    v_cvt_pk_bf16_f32 v225, v178, v179
    v_cvt_pk_bf16_f32 v226, v180, v181
    v_cvt_pk_bf16_f32 v227, v182, v183
    ds_write_b128 v252, v[224:227] offset:53504
    v_cvt_pk_bf16_f32 v228, v184, v185
    v_cvt_pk_bf16_f32 v229, v186, v187
    v_cvt_pk_bf16_f32 v230, v188, v189
    v_cvt_pk_bf16_f32 v231, v190, v191
    ds_write_b128 v253, v[228:231] offset:53504
    v_add_f32_e64 v234, v234, v235
    ds_write_b32 v255, v234 offset:53248
    s_setprio 1
    s_nop 0
    v_pk_fma_f32 v[208:209], v[160:161], v[160:161], s[48:49] neg_lo:[1,0,0] neg_hi:[1,0,0]
    buffer_load_dwordx4 v[124:127], v6, s[36:39], s40 offen
    v_pk_fma_f32 v[210:211], v[162:163], v[162:163], s[48:49] neg_lo:[1,0,0] neg_hi:[1,0,0]
    v_pk_fma_f32 v[212:213], v[164:165], v[164:165], s[48:49] neg_lo:[1,0,0] neg_hi:[1,0,0]
    v_pk_fma_f32 v[214:215], v[166:167], v[166:167], s[48:49] neg_lo:[1,0,0] neg_hi:[1,0,0]
    v_pk_fma_f32 v[216:217], v[168:169], v[168:169], s[48:49] neg_lo:[1,0,0] neg_hi:[1,0,0]
    v_pk_fma_f32 v[218:219], v[170:171], v[170:171], s[48:49] neg_lo:[1,0,0] neg_hi:[1,0,0]
    v_pk_fma_f32 v[220:221], v[172:173], v[172:173], s[48:49] neg_lo:[1,0,0] neg_hi:[1,0,0]
    v_pk_fma_f32 v[222:223], v[174:175], v[174:175], s[48:49] neg_lo:[1,0,0] neg_hi:[1,0,0]
    v_pk_mul_f32 v[208:209], v[160:161], v[208:209]
    v_pk_mul_f32 v[210:211], v[162:163], v[210:211]
    v_pk_mul_f32 v[212:213], v[164:165], v[212:213]
    v_pk_mul_f32 v[214:215], v[166:167], v[214:215]
    v_pk_mul_f32 v[216:217], v[168:169], v[216:217]
    v_pk_mul_f32 v[218:219], v[170:171], v[218:219]
    v_pk_mul_f32 v[220:221], v[172:173], v[220:221]
    v_pk_mul_f32 v[222:223], v[174:175], v[222:223]
    v_mfma_f32_32x32x16_bf16 v[176:191], v[64:67], v[136:139], 0
    v_exp_f32 v208, v208
    v_exp_f32 v209, v209
    v_exp_f32_e64 v210, v210
    buffer_load_dwordx4 v[128:131], v7, s[36:39], s40 offen
    v_mfma_f32_32x32x16_bf16 v[176:191], v[68:71], v[140:143], v[176:191]
    v_exp_f32 v211, v211
    v_exp_f32 v212, v212
    v_exp_f32_e64 v213, v213
    v_mfma_f32_32x32x16_bf16 v[176:191], v[72:75], v[144:147], v[176:191]
    v_exp_f32 v214, v214
    v_exp_f32 v215, v215
    v_exp_f32 v216, v216
    v_exp_f32 v217, v217
    v_exp_f32 v218, v218
    v_exp_f32 v219, v219
    v_exp_f32 v220, v220
    v_exp_f32 v221, v221
    v_exp_f32 v222, v222
    v_exp_f32 v223, v223
    v_pk_add_f32 v[208:209], v[208:209], 1.0 op_sel_hi:[1,0]
    v_pk_add_f32 v[210:211], v[210:211], 1.0 op_sel_hi:[1,0]
    v_pk_add_f32 v[212:213], v[212:213], 1.0 op_sel_hi:[1,0]
    v_pk_add_f32 v[214:215], v[214:215], 1.0 op_sel_hi:[1,0]
    v_pk_add_f32 v[216:217], v[216:217], 1.0 op_sel_hi:[1,0]
    buffer_load_dwordx4 v[132:135], v8, s[36:39], s40 offen
    v_pk_add_f32 v[218:219], v[218:219], 1.0 op_sel_hi:[1,0]
    v_pk_add_f32 v[220:221], v[220:221], 1.0 op_sel_hi:[1,0]
    v_pk_add_f32 v[222:223], v[222:223], 1.0 op_sel_hi:[1,0]
    v_mfma_f32_32x32x16_bf16 v[176:191], v[76:79], v[148:151], v[176:191]
    v_rcp_f32 v208, v208
    v_rcp_f32 v209, v209
    v_rcp_f32_e64 v210, v210
    v_mfma_f32_32x32x16_bf16 v[176:191], v[80:83], v[152:155], v[176:191]
    v_rcp_f32 v211, v211
    v_rcp_f32 v212, v212
    v_rcp_f32_e64 v213, v213
    v_mfma_f32_32x32x16_bf16 v[176:191], v[84:87], v[156:159], v[176:191]
    v_rcp_f32 v214, v214
    v_rcp_f32 v215, v215
    v_rcp_f32 v216, v216
    v_rcp_f32 v217, v217
    v_rcp_f32 v218, v218
    v_rcp_f32 v219, v219
    v_rcp_f32_e64 v220, v220
    global_load_dwordx4 v[244:247], v14, s[96:97] offset:1024
    v_rcp_f32 v221, v221
    v_rcp_f32 v222, v222
    v_rcp_f32_e64 v223, v223
    v_pk_mul_f32 v[160:161], v[160:161], v[208:209]
    v_pk_mul_f32 v[162:163], v[162:163], v[210:211]
    v_pk_mul_f32 v[236:237], v[160:161], v[160:161]
    v_pk_mul_f32 v[164:165], v[164:165], v[212:213]
    v_pk_fma_f32 v[236:237], v[162:163], v[162:163], v[236:237]
    v_pk_mul_f32 v[166:167], v[166:167], v[214:215]
    v_pk_fma_f32 v[236:237], v[164:165], v[164:165], v[236:237]
    v_pk_mul_f32 v[168:169], v[168:169], v[216:217]
    v_pk_fma_f32 v[236:237], v[166:167], v[166:167], v[236:237]
    v_pk_mul_f32 v[170:171], v[170:171], v[218:219]
    v_pk_fma_f32 v[236:237], v[168:169], v[168:169], v[236:237]
    v_pk_mul_f32 v[172:173], v[172:173], v[220:221]
    v_pk_fma_f32 v[236:237], v[170:171], v[170:171], v[236:237]
    v_pk_mul_f32 v[174:175], v[174:175], v[222:223]
    v_pk_fma_f32 v[236:237], v[172:173], v[172:173], v[236:237]
    v_pk_fma_f32 v[236:237], v[174:175], v[174:175], v[236:237]
    v_add_u32 v252, 106496, v252
    v_add_u32 v253, 106496, v253
    v_cvt_pk_bf16_f32 v224, v160, v161
    v_cvt_pk_bf16_f32 v225, v162, v163
    v_cvt_pk_bf16_f32 v226, v164, v165
    v_cvt_pk_bf16_f32 v227, v166, v167
    ds_write_b128 v252, v[224:227] offset:0
    v_cvt_pk_bf16_f32 v228, v168, v169
    v_cvt_pk_bf16_f32 v229, v170, v171
    v_cvt_pk_bf16_f32 v230, v172, v173
    v_cvt_pk_bf16_f32 v231, v174, v175
    ds_write_b128 v253, v[228:231] offset:0
    v_pk_fma_f32 v[208:209], v[176:177], v[176:177], s[48:49] neg_lo:[1,0,0] neg_hi:[1,0,0]
    global_load_dwordx4 v[6:9], v14, s[96:97] offset:-2048
    v_pk_fma_f32 v[210:211], v[178:179], v[178:179], s[48:49] neg_lo:[1,0,0] neg_hi:[1,0,0]
    v_pk_fma_f32 v[212:213], v[180:181], v[180:181], s[48:49] neg_lo:[1,0,0] neg_hi:[1,0,0]
    v_pk_fma_f32 v[214:215], v[182:183], v[182:183], s[48:49] neg_lo:[1,0,0] neg_hi:[1,0,0]
    v_pk_fma_f32 v[216:217], v[184:185], v[184:185], s[48:49] neg_lo:[1,0,0] neg_hi:[1,0,0]
    v_pk_fma_f32 v[218:219], v[186:187], v[186:187], s[48:49] neg_lo:[1,0,0] neg_hi:[1,0,0]
    v_pk_fma_f32 v[220:221], v[188:189], v[188:189], s[48:49] neg_lo:[1,0,0] neg_hi:[1,0,0]
    v_pk_fma_f32 v[222:223], v[190:191], v[190:191], s[48:49] neg_lo:[1,0,0] neg_hi:[1,0,0]
    s_mov_b32 s28, s20
    s_nop 0
    v_pk_mul_f32 v[208:209], v[176:177], v[208:209]
    v_pk_mul_f32 v[210:211], v[178:179], v[210:211]
    v_pk_mul_f32 v[212:213], v[180:181], v[212:213]
    v_pk_mul_f32 v[214:215], v[182:183], v[214:215]
    v_pk_mul_f32 v[216:217], v[184:185], v[216:217]
    v_pk_mul_f32 v[218:219], v[186:187], v[218:219]
    v_pk_mul_f32 v[220:221], v[188:189], v[220:221]
    v_pk_mul_f32 v[222:223], v[190:191], v[222:223]
    s_mov_b32 s29, s21
    v_mfma_f32_32x32x16_bf16 v[160:175], v[88:91], v[136:139], 0
    v_exp_f32 v208, v208
    v_exp_f32 v209, v209
    v_exp_f32 v210, v210
    v_mfma_f32_32x32x16_bf16 v[160:175], v[92:95], v[140:143], v[160:175]
    v_exp_f32 v211, v211
    v_exp_f32 v212, v212
    v_exp_f32_e64 v213, v213
    s_mov_b32 s30, 34816
    v_mfma_f32_32x32x16_bf16 v[160:175], v[96:99], v[144:147], v[160:175]
    v_exp_f32 v214, v214
    v_exp_f32 v215, v215
    v_exp_f32 v216, v216
    v_exp_f32 v217, v217
    v_exp_f32 v218, v218
    v_exp_f32 v219, v219
    v_exp_f32_e64 v220, v220
    s_mov_b32 s54, 32768
    v_exp_f32 v221, v221
    v_exp_f32 v222, v222
    v_exp_f32_e64 v223, v223
    v_pk_add_f32 v[208:209], v[208:209], 1.0 op_sel_hi:[1,0]
    v_pk_add_f32 v[210:211], v[210:211], 1.0 op_sel_hi:[1,0]
    v_pk_add_f32 v[212:213], v[212:213], 1.0 op_sel_hi:[1,0]
    v_pk_add_f32 v[214:215], v[214:215], 1.0 op_sel_hi:[1,0]
    v_pk_add_f32 v[216:217], v[216:217], 1.0 op_sel_hi:[1,0]
    s_lshr_b32 s23, s2, 3
    v_pk_add_f32 v[218:219], v[218:219], 1.0 op_sel_hi:[1,0]
    v_pk_add_f32 v[220:221], v[220:221], 1.0 op_sel_hi:[1,0]
    v_pk_add_f32 v[222:223], v[222:223], 1.0 op_sel_hi:[1,0]
    v_mfma_f32_32x32x16_bf16 v[160:175], v[100:103], v[148:151], v[160:175]
    v_rcp_f32 v208, v208
    v_rcp_f32 v209, v209
    v_rcp_f32_e64 v210, v210
    s_and_b32 s23, s23, 15
    v_mfma_f32_32x32x16_bf16 v[160:175], v[104:107], v[152:155], v[160:175]
    v_rcp_f32 v211, v211
    v_rcp_f32 v212, v212
    v_rcp_f32_e64 v213, v213
    v_mfma_f32_32x32x16_bf16 v[160:175], v[108:111], v[156:159], v[160:175]
    v_rcp_f32 v214, v214
    v_rcp_f32 v215, v215
    v_rcp_f32 v216, v216
    s_lshl_b32 s23, s23, 11
    v_rcp_f32 v217, v217
    v_rcp_f32 v218, v218
    v_rcp_f32 v219, v219
    v_rcp_f32 v220, v220
    v_rcp_f32 v221, v221
    v_rcp_f32 v222, v222
    v_rcp_f32_e64 v223, v223
    v_pk_mul_f32 v[176:177], v[176:177], v[208:209]
    s_add_u32 s44, s20, s23
    s_nop 0
    v_pk_mul_f32 v[178:179], v[178:179], v[210:211]
    v_pk_fma_f32 v[236:237], v[176:177], v[176:177], v[236:237]
    v_pk_mul_f32 v[180:181], v[180:181], v[212:213]
    v_pk_fma_f32 v[236:237], v[178:179], v[178:179], v[236:237]
    v_pk_mul_f32 v[182:183], v[182:183], v[214:215]
    v_pk_fma_f32 v[236:237], v[180:181], v[180:181], v[236:237]
    v_pk_mul_f32 v[184:185], v[184:185], v[216:217]
    v_pk_fma_f32 v[236:237], v[182:183], v[182:183], v[236:237]
    s_addc_u32 s45, s21, 0
    s_nop 0
    v_pk_mul_f32 v[186:187], v[186:187], v[218:219]
    v_pk_fma_f32 v[236:237], v[184:185], v[184:185], v[236:237]
    v_pk_mul_f32 v[188:189], v[188:189], v[220:221]
    v_pk_fma_f32 v[236:237], v[186:187], v[186:187], v[236:237]
    v_pk_mul_f32 v[190:191], v[190:191], v[222:223]
    v_pk_fma_f32 v[236:237], v[188:189], v[188:189], v[236:237]
    v_pk_fma_f32 v[236:237], v[190:191], v[190:191], v[236:237]
    s_setprio 0
    s_nop 0
    v_pk_fma_f32 v[208:209], v[160:161], v[160:161], s[48:49] neg_lo:[1,0,0] neg_hi:[1,0,0]
    buffer_load_dwordx4 v[136:139], v15, s[28:31], s54 offen sc1
    v_pk_fma_f32 v[210:211], v[162:163], v[162:163], s[48:49] neg_lo:[1,0,0] neg_hi:[1,0,0]
    v_pk_fma_f32 v[212:213], v[164:165], v[164:165], s[48:49] neg_lo:[1,0,0] neg_hi:[1,0,0]
    v_pk_fma_f32 v[214:215], v[166:167], v[166:167], s[48:49] neg_lo:[1,0,0] neg_hi:[1,0,0]
    v_pk_fma_f32 v[216:217], v[168:169], v[168:169], s[48:49] neg_lo:[1,0,0] neg_hi:[1,0,0]
    v_pk_fma_f32 v[218:219], v[170:171], v[170:171], s[48:49] neg_lo:[1,0,0] neg_hi:[1,0,0]
    v_pk_fma_f32 v[220:221], v[172:173], v[172:173], s[48:49] neg_lo:[1,0,0] neg_hi:[1,0,0]
    v_pk_fma_f32 v[222:223], v[174:175], v[174:175], s[48:49] neg_lo:[1,0,0] neg_hi:[1,0,0]
    v_pk_mul_f32 v[208:209], v[160:161], v[208:209]
    v_pk_mul_f32 v[210:211], v[162:163], v[210:211]
    v_pk_mul_f32 v[212:213], v[164:165], v[212:213]
    v_pk_mul_f32 v[214:215], v[166:167], v[214:215]
    v_pk_mul_f32 v[216:217], v[168:169], v[216:217]
    v_pk_mul_f32 v[218:219], v[170:171], v[218:219]
    v_pk_mul_f32 v[220:221], v[172:173], v[220:221]
    v_pk_mul_f32 v[222:223], v[174:175], v[222:223]
    v_exp_f32 v208, v208
    v_exp_f32 v209, v209
    v_exp_f32_e64 v210, v210
    buffer_load_dwordx4 v[140:143], v15, s[28:31], s54 offen offset:1024 sc1
    v_exp_f32 v211, v211
    v_exp_f32 v212, v212
    v_exp_f32 v213, v213
    v_exp_f32 v214, v214
    v_exp_f32 v215, v215
    v_exp_f32 v216, v216
    v_exp_f32 v217, v217
    v_exp_f32 v218, v218
    v_exp_f32 v219, v219
    v_exp_f32 v220, v220
    v_exp_f32 v221, v221
    v_exp_f32 v222, v222
    v_exp_f32_e64 v223, v223
    v_pk_add_f32 v[208:209], v[208:209], 1.0 op_sel_hi:[1,0]
    v_pk_add_f32 v[210:211], v[210:211], 1.0 op_sel_hi:[1,0]
    v_pk_add_f32 v[212:213], v[212:213], 1.0 op_sel_hi:[1,0]
    v_pk_add_f32 v[214:215], v[214:215], 1.0 op_sel_hi:[1,0]
    v_pk_add_f32 v[216:217], v[216:217], 1.0 op_sel_hi:[1,0]
    global_load_dwordx4 v[144:147], v14, s[96:97] offset:-1024
    v_pk_add_f32 v[218:219], v[218:219], 1.0 op_sel_hi:[1,0]
    v_pk_add_f32 v[220:221], v[220:221], 1.0 op_sel_hi:[1,0]
    v_pk_add_f32 v[222:223], v[222:223], 1.0 op_sel_hi:[1,0]
    v_rcp_f32 v208, v208
    v_rcp_f32 v209, v209
    v_rcp_f32 v210, v210
    v_rcp_f32 v211, v211
    v_rcp_f32 v212, v212
    v_rcp_f32 v213, v213
    v_rcp_f32 v214, v214
    v_rcp_f32 v215, v215
    v_rcp_f32 v216, v216
    v_rcp_f32 v217, v217
    v_rcp_f32 v218, v218
    v_rcp_f32 v219, v219
    v_rcp_f32 v220, v220
    v_rcp_f32 v221, v221
    v_rcp_f32_e64 v222, v222
    global_load_dwordx4 v[148:151], v14, s[96:97] offset:0
    v_rcp_f32_e64 v223, v223
    v_pk_mul_f32 v[160:161], v[160:161], v[208:209]
    v_pk_mul_f32 v[162:163], v[162:163], v[210:211]
    v_pk_fma_f32 v[236:237], v[160:161], v[160:161], v[236:237]
    v_pk_mul_f32 v[164:165], v[164:165], v[212:213]
    v_pk_fma_f32 v[236:237], v[162:163], v[162:163], v[236:237]
    v_pk_mul_f32 v[166:167], v[166:167], v[214:215]
    v_pk_fma_f32 v[236:237], v[164:165], v[164:165], v[236:237]
    v_pk_mul_f32 v[168:169], v[168:169], v[216:217]
    v_pk_fma_f32 v[236:237], v[166:167], v[166:167], v[236:237]
    v_pk_mul_f32 v[170:171], v[170:171], v[218:219]
    v_pk_fma_f32 v[236:237], v[168:169], v[168:169], v[236:237]
    v_pk_mul_f32 v[172:173], v[172:173], v[220:221]
    v_pk_fma_f32 v[236:237], v[170:171], v[170:171], v[236:237]
    v_pk_mul_f32 v[174:175], v[174:175], v[222:223]
    v_pk_fma_f32 v[236:237], v[172:173], v[172:173], v[236:237]
    v_pk_fma_f32 v[236:237], v[174:175], v[174:175], v[236:237]
    v_add_f32 v236, v236, v237
    s_waitcnt vmcnt(26)
    ds_write_b32 v12, v236
    v_lshlrev_b32_e64 v211, 2, v0
    s_waitcnt lgkmcnt(0)
    s_barrier
    ds_read_b128 v[212:215], v11
    ds_read_b32 v216, v10
    s_waitcnt lgkmcnt(1)
    v_pk_add_f32 v[212:213], v[212:213], v[214:215]
    v_add_f32 v212, v212, v213
    s_waitcnt lgkmcnt(0)
    v_add_f32 v212, v212, v216
    v_cndmask_b32 v212, v212, 1.0, s[42:43]
    global_atomic_add_f32 v211, v212, s[44:45]
    v_cvt_pk_bf16_f32 v224, v160, v161
    v_cvt_pk_bf16_f32 v225, v162, v163
    v_cvt_pk_bf16_f32 v226, v164, v165
    v_cvt_pk_bf16_f32 v227, v166, v167
    ds_write_b128 v252, v[224:227] offset:256
    v_cvt_pk_bf16_f32 v228, v168, v169
    v_cvt_pk_bf16_f32 v229, v170, v171
    v_cvt_pk_bf16_f32 v230, v172, v173
    v_cvt_pk_bf16_f32 v231, v174, v175
    ds_write_b128 v253, v[228:231] offset:256
    v_cvt_pk_bf16_f32 v224, v176, v177
    v_cvt_pk_bf16_f32 v225, v178, v179
    v_cvt_pk_bf16_f32 v226, v180, v181
    v_cvt_pk_bf16_f32 v227, v182, v183
    ds_write_b128 v252, v[224:227] offset:128
    v_cvt_pk_bf16_f32 v228, v184, v185
    v_cvt_pk_bf16_f32 v229, v186, v187
    v_cvt_pk_bf16_f32 v230, v188, v189
    v_cvt_pk_bf16_f32 v231, v190, v191
    ds_write_b128 v253, v[228:231] offset:128
    v_mov_b32 v232, 64.0
    s_mov_b32 s62, 0x100000
    s_waitcnt vmcnt(4)
    v_cmp_neq_f32 vcc, v139, v232
    s_waitcnt vmcnt(3)
    v_cmp_neq_f32 s[52:53], v143, v232
    s_nop 0
    s_or_b64 vcc, vcc, s[52:53]
    s_cbranch_vccz L_biasok
L_biaspoll:
    buffer_load_dwordx4 v[136:139], v15, s[28:31], s54 offen sc1
    buffer_load_dwordx4 v[140:143], v15, s[28:31], s54 offen offset:1024 sc1
    s_waitcnt vmcnt(0)
    s_waitcnt vmcnt(0)
    v_cmp_neq_f32 vcc, v139, v232
    s_waitcnt vmcnt(0)
    v_cmp_neq_f32 s[52:53], v143, v232
    s_nop 0
    s_or_b64 vcc, vcc, s[52:53]
    s_sub_u32 s62, s62, 1
    s_cmp_le_i32 s62, 0
    s_cbranch_scc1 L_biasok
    s_cbranch_vccnz L_biaspoll
L_biasok:
    v_pk_add_f32 v[136:137], v[136:137], v[140:141]
    v_add_f32 v138, v138, v142
    v_mov_b32 v140, v136
    v_mov_b32 v141, v137
    v_mov_b32_e64 v142, v138
    v_permlane32_swap_b32 v136, v140
    v_permlane32_swap_b32 v137, v141
    v_permlane32_swap_b32 v138, v142
    v_pk_add_f32 v[136:137], v[136:137], v[140:141]
    v_add_f32_e64 v138, v138, v142
    ds_write2_b32 v13, v136, v137 offset0:0 offset1:1
    ds_write_b32 v13, v138 offset:8
    ds_read_b128 v[160:163], v247
    ds_read_b128 v[164:167], v247 offset:64
    ds_read_b128 v[168:171], v247 offset:128
    ds_read_b64_tr_b16 v[220:221], v3 offset:0
    ds_read_b64_tr_b16 v[222:223], v3 offset:6656
    ds_read_b64_tr_b16 v[224:225], v3 offset:53248
    ds_read_b64_tr_b16 v[226:227], v3 offset:59904
    v_add_u32 v3, 106496, v3
    ds_read_b64_tr_b16 v[228:229], v3 offset:0
    ds_read_b64_tr_b16 v[230:231], v3 offset:6656
    s_cmp_eq_u32 s46, 0
    s_cbranch_scc1 L_li
    v_pk_mov_b32 v[208:209], 0, 0
    v_pk_mov_b32 v[210:211], 0, 0
    v_pk_mov_b32 v[212:213], 0, 0
    v_pk_mov_b32 v[214:215], 0, 0
    v_pk_mov_b32 v[216:217], 0, 0
    v_pk_mov_b32 v[218:219], 0, 0
    s_branch L_keepl
L_li:
    s_waitcnt vmcnt(2) lgkmcnt(8)
    v_mfma_f32_16x16x32_bf16 v[208:211], v[144:147], v[204:207], v[160:163]
    s_waitcnt vmcnt(1) lgkmcnt(7)
    v_mfma_f32_16x16x32_bf16 v[212:215], v[148:151], v[204:207], v[164:167]
    s_waitcnt vmcnt(2) lgkmcnt(6)
    v_mfma_f32_16x16x32_bf16 v[216:219], v[144:147], v[240:243], v[168:171]
L_keepl:
    s_waitcnt vmcnt(2) lgkmcnt(4)
    v_mfma_f32_16x16x32_bf16 v[184:187], v[144:147], v[56:59], v[160:163]
    ds_read_b64_tr_b16 v[16:17], v2 offset:0
    ds_read_b64_tr_b16 v[18:19], v2 offset:6656
    v_mov_b32 v232, 16.0
    s_waitcnt vmcnt(1)
    v_mfma_f32_16x16x32_bf16 v[188:191], v[148:151], v[56:59], v[164:167]
    ds_read_b64_tr_b16 v[20:21], v2 offset:32
    ds_read_b64_tr_b16 v[22:23], v2 offset:6688
    s_mov_b32 s54, 8192
    s_mov_b32 s55, 16384
    v_mfma_f32_16x16x32_bf16 v[204:207], v[144:147], v[60:63], v[168:171]
    ds_read_b64_tr_b16 v[24:25], v2 offset:64
    ds_read_b64_tr_b16 v[26:27], v2 offset:6720
    s_mov_b32 s60, 24576
    v_mfma_f32_16x16x32_bf16 v[172:175], v[144:147], v[48:51], v[160:163]
    ds_read_b64_tr_b16 v[28:29], v2 offset:13312
    ds_read_b64_tr_b16 v[30:31], v2 offset:19968
    s_mov_b32 s61, 0x4091afa4
    v_mov_b32 v233, 0x358637bd
    v_mfma_f32_16x16x32_bf16 v[176:179], v[148:151], v[48:51], v[164:167]
    ds_read_b64_tr_b16 v[32:33], v2 offset:13344
    ds_read_b64_tr_b16 v[34:35], v2 offset:20000
    s_lshl_b32 s23, s22, 2
    v_mfma_f32_16x16x32_bf16 v[180:183], v[144:147], v[52:55], v[168:171]
    ds_read_b64_tr_b16 v[36:37], v2 offset:13376
    ds_read_b64_tr_b16 v[38:39], v2 offset:20032
    s_add_u32 s23, s23, 163328
    v_mov_b32 v234, s23
    v_mfma_f32_16x16x32_bf16 v[160:163], v[144:147], v[40:43], v[160:163]
    ds_read_b64_tr_b16 v[64:65], v2 offset:26624
    ds_read_b64_tr_b16 v[66:67], v2 offset:33280
    v_mov_b32 v235, 163328
    v_mfma_f32_16x16x32_bf16 v[164:167], v[148:151], v[40:43], v[164:167]
    ds_read_b64_tr_b16 v[68:69], v2 offset:26656
    ds_read_b64_tr_b16 v[70:71], v2 offset:33312
    v_mov_b32 v236, 0x40088e99
    v_lshlrev_b32_e64 v237, 16, v238
    v_mfma_f32_16x16x32_bf16 v[168:171], v[144:147], v[44:47], v[168:171]
    ds_read_b64_tr_b16 v[72:73], v2 offset:26688
    ds_read_b64_tr_b16 v[74:75], v2 offset:33344
    v_mul_f32 v237, v236, v237
    v_lshlrev_b32_e64 v153, 11, v1
    s_cmp_lg_u32 s22, 7
    s_cbranch_scc1 L_c_15
    s_mul_i32 s63, s2, 5
    s_and_b32 s63, s63, 127
    s_lshl_b32 s63, s63, 4
    s_add_u32 s63, s63, 12
    s_waitcnt vmcnt(0)
    s_mov_b64 exec, 0xffff
    buffer_load_dword v152, v153, s[28:31], s63 offen sc1
    s_mov_b64 exec, -1
L_c_15:
    global_load_dwordx4 v[40:43], v14, s[96:97] offset:2048
    global_load_dwordx4 v[44:47], v14, s[96:97] offset:3072
    s_cmp_lg_u32 s22, 7
    s_cbranch_scc1 L_c_16
    s_mov_b64 exec, 0xffff
    s_waitcnt vmcnt(2)
    s_waitcnt vmcnt(2)
    v_cmp_neq_f32 vcc, v152, v232
    s_nop 0
    s_cbranch_vccz L_lpd
L_lp:
    buffer_load_dword v152, v153, s[28:31], s63 offen sc1
    s_waitcnt vmcnt(0)
    s_waitcnt vmcnt(0)
    v_cmp_neq_f32 vcc, v152, v232
    s_sub_u32 s62, s62, 1
    s_cmp_le_i32 s62, 0
    s_cbranch_scc1 L_lpd
    s_cbranch_vccnz L_lp
L_lpd:
    s_mov_b64 exec, -1
L_c_16:
    s_barrier
    buffer_load_dwordx4 v[144:147], v9, s[28:31], 0 offen sc1
    buffer_load_dwordx4 v[148:151], v9, s[28:31], s54 offen sc1
    buffer_load_dwordx4 v[152:155], v9, s[28:31], s55 offen sc1
    buffer_load_dwordx4 v[156:159], v9, s[28:31], s60 offen sc1
    v_lshlrev_b32_e64 v136, 16, v112
    ds_read_b64_tr_b16 v[76:77], v2 offset:39936
    v_and_b32 v137, 0xffff0000, v112
    ds_read_b64_tr_b16 v[78:79], v2 offset:46592
    v_lshlrev_b32_e64 v138, 16, v113
    ds_read_b64_tr_b16 v[80:81], v2 offset:39968
    v_and_b32 v139, 0xffff0000, v113
    ds_read_b64_tr_b16 v[82:83], v2 offset:46624
    v_lshlrev_b32_e64 v140, 16, v114
    v_and_b32 v141, 0xffff0000, v114
    ds_read_b64_tr_b16 v[84:85], v2 offset:40000
    v_lshlrev_b32_e64 v142, 16, v115
    ds_read_b64_tr_b16 v[86:87], v2 offset:46656
    v_and_b32 v143, 0xffff0000, v115
    v_add_u32 v2, 53248, v2
    v_lshlrev_b32_e64 v48, 16, v116
    ds_read_b64_tr_b16 v[88:89], v2 offset:0
    v_and_b32 v49, 0xffff0000, v116
    v_lshlrev_b32_e64 v50, 16, v117
    ds_read_b64_tr_b16 v[90:91], v2 offset:6656
    v_and_b32 v51, 0xffff0000, v117
    ds_read_b64_tr_b16 v[92:93], v2 offset:32
    v_lshlrev_b32_e64 v52, 16, v118
    ds_read_b64_tr_b16 v[94:95], v2 offset:6688
    v_and_b32 v53, 0xffff0000, v118
    ds_read_b64_tr_b16 v[96:97], v2 offset:64
    v_lshlrev_b32_e64 v54, 16, v119
    v_and_b32 v55, 0xffff0000, v119
    ds_read_b64_tr_b16 v[98:99], v2 offset:6720
    v_lshlrev_b32_e64 v56, 16, v120
    ds_read_b64_tr_b16 v[100:101], v2 offset:13312
    v_and_b32 v57, 0xffff0000, v120
    ds_read_b64_tr_b16 v[102:103], v2 offset:19968
    v_lshlrev_b32_e64 v58, 16, v121
    ds_read_b64_tr_b16 v[104:105], v2 offset:13344
    v_and_b32 v59, 0xffff0000, v121
    v_lshlrev_b32_e64 v60, 16, v122
    ds_read_b64_tr_b16 v[106:107], v2 offset:20000
    v_and_b32 v61, 0xffff0000, v122
    ds_read_b64_tr_b16 v[108:109], v2 offset:13376
    v_lshlrev_b32_e64 v62, 16, v123
    ds_read_b64_tr_b16 v[110:111], v2 offset:20032
    v_and_b32 v63, 0xffff0000, v123
    s_waitcnt vmcnt(0)
    v_cmp_neq_f32 vcc, v147, v232
    v_cmp_neq_f32 s[52:53], v151, v232
    s_nop 0
    s_or_b64 vcc, vcc, s[52:53]
    v_cmp_neq_f32 s[52:53], v155, v232
    s_nop 0
    s_or_b64 vcc, vcc, s[52:53]
    v_cmp_neq_f32 s[52:53], v159, v232
    s_nop 0
    s_or_b64 vcc, vcc, s[52:53]
    s_cbranch_vccz L_pollok
L_poll:
    buffer_load_dwordx4 v[144:147], v9, s[28:31], 0 offen sc1
    buffer_load_dwordx4 v[148:151], v9, s[28:31], s54 offen sc1
    buffer_load_dwordx4 v[152:155], v9, s[28:31], s55 offen sc1
    buffer_load_dwordx4 v[156:159], v9, s[28:31], s60 offen sc1
    s_waitcnt vmcnt(0)
    s_waitcnt vmcnt(0)
    v_cmp_neq_f32 vcc, v147, v232
    s_waitcnt vmcnt(0)
    v_cmp_neq_f32 s[52:53], v151, v232
    s_nop 0
    s_or_b64 vcc, vcc, s[52:53]
    s_waitcnt vmcnt(0)
    v_cmp_neq_f32 s[52:53], v155, v232
    s_nop 0
    s_or_b64 vcc, vcc, s[52:53]
    s_waitcnt vmcnt(0)
    v_cmp_neq_f32 s[52:53], v159, v232
    s_nop 0
    s_or_b64 vcc, vcc, s[52:53]
    s_sub_u32 s62, s62, 1
    s_cmp_le_i32 s62, 0
    s_cbranch_scc1 L_pollok
    s_cbranch_vccnz L_poll
L_pollok:
    s_nop 0
    v_pk_add_f32 v[144:145], v[144:145], v[148:149]
    v_pk_add_f32 v[152:153], v[152:153], v[156:157]
    v_pk_add_f32 v[146:147], v[146:147], v[150:151]
    v_pk_add_f32 v[154:155], v[154:155], v[158:159]
    v_pk_add_f32 v[144:145], v[144:145], v[152:153]
    v_pk_add_f32 v[146:147], v[146:147], v[154:155]
    s_nop 0
    v_permlane32_swap_b32 v144, v145
    v_permlane32_swap_b32 v146, v147
    v_add_f32 v144, v144, v145
    v_add_f32 v146, v146, v147
    s_nop 1
    v_permlane16_swap_b32 v144, v146
    v_add_f32 v144, v144, v146
    v_fma_f32 v144, v144, s61, v233
    v_sqrt_f32_e64 v144, v144
    s_mov_b32 exec_hi, 0xffff
    v_mul_f32_e64 v145, v144, v237
    v_add_f32_dpp v146, v144, v144 row_ror:8 row_mask:0xf bank_mask:0xf
    ds_write_b32 v251, v145
    s_nop 0
    v_add_f32_dpp v146, v146, v146 row_ror:4 row_mask:0xf bank_mask:0xf
    s_nop 1
    v_add_f32_dpp v146, v146, v146 row_ror:2 row_mask:0xf bank_mask:0xf
    s_nop 1
    v_add_f32_dpp v146, v146, v146 row_ror:1 row_mask:0xf bank_mask:0xf
    s_nop 1
    v_add_f32_dpp v146, v146, v146 row_bcast:15 row_mask:0x2 bank_mask:0xf
    s_nop 1
    v_add_f32_dpp v146, v146, v146 row_bcast:31 row_mask:0x4 bank_mask:0xf
    s_mov_b32 exec_lo, 0
    s_mov_b32 exec_hi, 1
    ds_write_b32 v234, v146
    s_mov_b64 exec, -1
    s_waitcnt lgkmcnt(0)
    s_barrier
    ds_read_b128 v[148:151], v235
    ds_read_b128 v[144:147], v235 offset:16
    ds_read_b32 v10, v248 offset:0
    ds_read_b32 v11, v249 offset:0
    ds_read_b32 v12, v250 offset:0
    ds_read_b32 v13, v248 offset:512
    ds_read_b32 v238, v249 offset:512
    ds_read_b32 v239, v250 offset:512
    ds_read_b32 v240, v248 offset:1024
    ds_read_b32 v241, v249 offset:1024
    ds_read_b32 v242, v250 offset:1024
    s_waitcnt lgkmcnt(10)
    v_pk_add_f32 v[148:149], v[148:149], v[150:151]
    s_waitcnt lgkmcnt(9)
    v_pk_add_f32 v[144:145], v[144:145], v[146:147]
    v_pk_add_f32 v[148:149], v[148:149], v[144:145]
    v_add_f32_e64 v148, v148, v149
    v_fmamk_f32 v148, v148, 0x3b2aaaab, v233
    v_rcp_f32 v243, v148
    s_waitcnt lgkmcnt(8)
    v_fma_f32 v10, v10, v243, v236
    s_waitcnt lgkmcnt(7)
    s_nop 0
    v_pk_mul_f32 v[136:137], v[136:137], v[10:11] op_sel:[0,0] op_sel_hi:[1,0]
    v_pk_mul_f32 v[138:139], v[138:139], v[10:11] op_sel:[0,0] op_sel_hi:[1,0]
    v_pk_mul_f32 v[140:141], v[140:141], v[10:11] op_sel:[0,0] op_sel_hi:[1,0]
    v_pk_mul_f32 v[142:143], v[142:143], v[10:11] op_sel:[0,0] op_sel_hi:[1,0]
    v_cvt_pk_bf16_f32 v112, v136, v137
    v_cvt_pk_bf16_f32 v113, v138, v139
    v_cvt_pk_bf16_f32 v114, v140, v141
    v_cvt_pk_bf16_f32 v115, v142, v143
    ds_write_b128 v6, v[112:115] offset:0
    v_fma_f32 v11, v11, v243, v236
    v_pk_mul_f32 v[48:49], v[48:49], v[10:11] op_sel:[0,1] op_sel_hi:[1,1]
    v_pk_mul_f32 v[50:51], v[50:51], v[10:11] op_sel:[0,1] op_sel_hi:[1,1]
    v_pk_mul_f32 v[52:53], v[52:53], v[10:11] op_sel:[0,1] op_sel_hi:[1,1]
    v_pk_mul_f32 v[54:55], v[54:55], v[10:11] op_sel:[0,1] op_sel_hi:[1,1]
    v_cvt_pk_bf16_f32 v116, v48, v49
    v_cvt_pk_bf16_f32 v117, v50, v51
    v_cvt_pk_bf16_f32 v118, v52, v53
    v_cvt_pk_bf16_f32 v119, v54, v55
    ds_write_b128 v7, v[116:119] offset:0
    s_waitcnt lgkmcnt(2)
    s_nop 0
    v_fma_f32 v12, v12, v243, v236
    v_pk_mul_f32 v[56:57], v[56:57], v[12:13] op_sel:[0,0] op_sel_hi:[1,0]
    v_pk_mul_f32 v[58:59], v[58:59], v[12:13] op_sel:[0,0] op_sel_hi:[1,0]
    v_pk_mul_f32 v[60:61], v[60:61], v[12:13] op_sel:[0,0] op_sel_hi:[1,0]
    v_pk_mul_f32 v[62:63], v[62:63], v[12:13] op_sel:[0,0] op_sel_hi:[1,0]
    v_cvt_pk_bf16_f32 v120, v56, v57
    v_cvt_pk_bf16_f32 v121, v58, v59
    v_cvt_pk_bf16_f32 v122, v60, v61
    v_cvt_pk_bf16_f32 v123, v62, v63
    ds_write_b128 v8, v[120:123] offset:0
    s_waitcnt lgkmcnt(0)
    s_barrier
    ds_read_b64_tr_b16 v[136:137], v4 offset:0
    ds_read_b64_tr_b16 v[138:139], v4 offset:3072
    ds_read_b64_tr_b16 v[140:141], v5 offset:32
    ds_read_b64_tr_b16 v[142:143], v5 offset:3104
    ds_read_b64_tr_b16 v[144:145], v4 offset:64
    ds_read_b64_tr_b16 v[146:147], v4 offset:3136
    s_setprio 3
    s_waitcnt lgkmcnt(4)
    v_mfma_f32_16x16x32_bf16 v[160:163], v[136:139], v[16:19], v[160:163]
    ds_read_b64_tr_b16 v[148:149], v4 offset:6144
    v_fma_f32 v13, v13, v243, v236
    v_lshlrev_b32_e64 v248, 16, v124
    v_mfma_f32_16x16x32_bf16 v[172:175], v[136:139], v[20:23], v[172:175]
    ds_read_b64_tr_b16 v[150:151], v4 offset:9216
    v_and_b32 v249, 0xffff0000, v124
    v_lshlrev_b32_e64 v250, 16, v125
    v_and_b32 v251, 0xffff0000, v125
    v_mfma_f32_16x16x32_bf16 v[184:187], v[136:139], v[24:27], v[184:187]
    v_lshlrev_b32_e64 v252, 16, v126
    v_and_b32 v253, 0xffff0000, v126
    s_waitcnt lgkmcnt(4)
    v_mfma_f32_16x16x32_bf16 v[164:167], v[140:143], v[16:19], v[164:167]
    ds_read_b64_tr_b16 v[152:153], v5 offset:6176
    v_lshlrev_b32 v254, 16, v127
    v_and_b32 v255, 0xffff0000, v127
    v_mul_f32_e64 v248, v248, v13
    v_mfma_f32_16x16x32_bf16 v[176:179], v[140:143], v[20:23], v[176:179]
    ds_read_b64_tr_b16 v[154:155], v5 offset:9248
    v_mul_f32 v249, v249, v13
    v_mul_f32 v250, v250, v13
    v_mfma_f32_16x16x32_bf16 v[188:191], v[140:143], v[24:27], v[188:191]
    v_mul_f32 v251, v251, v13
    v_mul_f32 v252, v252, v13
    v_mul_f32 v253, v253, v13
    s_waitcnt lgkmcnt(3)
    v_mfma_f32_16x16x32_bf16 v[168:171], v[144:147], v[16:19], v[168:171]
    ds_read_b64_tr_b16 v[156:157], v4 offset:6208
    v_mul_f32 v254, v254, v13
    v_mul_f32 v255, v255, v13
    v_mfma_f32_16x16x32_bf16 v[180:183], v[144:147], v[20:23], v[180:183]
    ds_read_b64_tr_b16 v[158:159], v4 offset:9280
    v_cvt_pk_bf16_f32 v124, v248, v249
    v_cvt_pk_bf16_f32 v125, v250, v251
    v_cvt_pk_bf16_f32 v126, v252, v253
    v_mfma_f32_16x16x32_bf16 v[204:207], v[144:147], v[24:27], v[204:207]
    v_cvt_pk_bf16_f32 v127, v254, v255
    ds_write_b128 v6, v[124:127] offset:24576
    s_cmp_lg_u32 s46, 0
    s_cbranch_scc1 L_c_17
    v_mfma_f32_16x16x32_bf16 v[208:211], v[136:139], v[220:223], v[208:211]
    v_mfma_f32_16x16x32_bf16 v[212:215], v[140:143], v[220:223], v[212:215]
    v_mfma_f32_16x16x32_bf16 v[216:219], v[144:147], v[220:223], v[216:219]
L_c_17:
    s_setprio 2
    s_waitcnt lgkmcnt(3)
    v_mfma_f32_16x16x32_bf16 v[160:163], v[148:151], v[28:31], v[160:163]
    ds_read_b64_tr_b16 v[136:137], v4 offset:12288
    ds_read_b64_tr_b16 v[138:139], v4 offset:15360
    v_fma_f32 v238, v238, v243, v236
    v_lshlrev_b32_e64 v248, 16, v128
    v_mfma_f32_16x16x32_bf16 v[172:175], v[148:151], v[32:35], v[172:175]
    ds_read_b64_tr_b16 v[140:141], v5 offset:12320
    v_and_b32 v249, 0xffff0000, v128
    v_lshlrev_b32_e64 v250, 16, v129
    v_and_b32 v251, 0xffff0000, v129
    v_mfma_f32_16x16x32_bf16 v[184:187], v[148:151], v[36:39], v[184:187]
    ds_read_b64_tr_b16 v[142:143], v5 offset:15392
    v_lshlrev_b32_e64 v252, 16, v130
    v_and_b32 v253, 0xffff0000, v130
    v_mfma_f32_16x16x32_bf16 v[164:167], v[152:155], v[28:31], v[164:167]
    ds_read_b64_tr_b16 v[144:145], v4 offset:12352
    ds_read_b64_tr_b16 v[146:147], v4 offset:15424
    v_lshlrev_b32_e64 v254, 16, v131
    v_and_b32 v255, 0xffff0000, v131
    v_mul_f32_e64 v248, v248, v238
    v_mfma_f32_16x16x32_bf16 v[176:179], v[152:155], v[32:35], v[176:179]
    ds_read_b64_tr_b16 v[16:17], v2 offset:26624
    v_mul_f32 v249, v249, v238
    v_mul_f32 v250, v250, v238
    v_mfma_f32_16x16x32_bf16 v[188:191], v[152:155], v[36:39], v[188:191]
    ds_read_b64_tr_b16 v[18:19], v2 offset:33280
    v_mul_f32 v251, v251, v238
    v_mul_f32 v252, v252, v238
    v_mul_f32 v253, v253, v238
    s_waitcnt lgkmcnt(5)
    v_mfma_f32_16x16x32_bf16 v[168:171], v[156:159], v[28:31], v[168:171]
    ds_read_b64_tr_b16 v[20:21], v2 offset:26656
    ds_read_b64_tr_b16 v[22:23], v2 offset:33312
    v_mul_f32 v254, v254, v238
    v_mul_f32 v255, v255, v238
    v_mfma_f32_16x16x32_bf16 v[180:183], v[156:159], v[32:35], v[180:183]
    ds_read_b64_tr_b16 v[24:25], v2 offset:26688
    v_cvt_pk_bf16_f32 v128, v248, v249
    v_cvt_pk_bf16_f32 v129, v250, v251
    v_cvt_pk_bf16_f32 v130, v252, v253
    v_mfma_f32_16x16x32_bf16 v[204:207], v[156:159], v[36:39], v[204:207]
    ds_read_b64_tr_b16 v[26:27], v2 offset:33344
    v_cvt_pk_bf16_f32 v131, v254, v255
    ds_write_b128 v7, v[128:131] offset:24576
    s_cmp_lg_u32 s46, 1
    s_cbranch_scc1 L_c_18
    v_mfma_f32_16x16x32_bf16 v[208:211], v[148:151], v[220:223], v[208:211]
    v_mfma_f32_16x16x32_bf16 v[212:215], v[152:155], v[220:223], v[212:215]
    v_mfma_f32_16x16x32_bf16 v[216:219], v[156:159], v[220:223], v[216:219]
L_c_18:
    s_setprio 1
    v_mfma_f32_16x16x32_bf16 v[160:163], v[136:139], v[64:67], v[160:163]
    ds_read_b64_tr_b16 v[148:149], v4 offset:18432
    ds_read_b64_tr_b16 v[150:151], v4 offset:21504
    v_fma_f32 v239, v239, v243, v236
    v_lshlrev_b32 v248, 16, v132
    v_and_b32 v249, 0xffff0000, v132
    v_lshlrev_b32_e64 v250, 16, v133
    v_and_b32 v251, 0xffff0000, v133
    v_lshlrev_b32_e64 v252, 16, v134
    v_mfma_f32_16x16x32_bf16 v[172:175], v[136:139], v[68:71], v[172:175]
    ds_read_b64_tr_b16 v[152:153], v5 offset:18464
    v_and_b32 v253, 0xffff0000, v134
    v_lshlrev_b32_e64 v254, 16, v135
    v_and_b32 v255, 0xffff0000, v135
    v_mul_f32 v248, v248, v239
    v_mul_f32 v249, v249, v239
    v_mul_f32_e64 v250, v250, v239
    v_mfma_f32_16x16x32_bf16 v[184:187], v[136:139], v[72:75], v[184:187]
    ds_read_b64_tr_b16 v[154:155], v5 offset:21536
    v_mul_f32 v251, v251, v239
    v_mul_f32 v252, v252, v239
    v_mul_f32 v253, v253, v239
    v_mul_f32 v254, v254, v239
    v_mul_f32_e64 v255, v255, v239
    v_cvt_pk_bf16_f32 v132, v248, v249
    v_cvt_pk_bf16_f32 v133, v250, v251
    s_waitcnt lgkmcnt(2)
    v_mfma_f32_16x16x32_bf16 v[164:167], v[140:143], v[64:67], v[164:167]
    ds_read_b64_tr_b16 v[156:157], v4 offset:18496
    v_cvt_pk_bf16_f32 v134, v252, v253
    v_cvt_pk_bf16_f32 v135, v254, v255
    ds_write_b128 v8, v[132:135] offset:24576
    s_mov_b32 s40, s16
    s_mov_b32 s41, s17
    s_mov_b32 s42, 9633792
    v_mfma_f32_16x16x32_bf16 v[176:179], v[140:143], v[68:71], v[176:179]
    ds_read_b64_tr_b16 v[158:159], v4 offset:21568
    s_mov_b32 s43, 0x20000
    v_add_u32 v10, 416, v234
    v_xor_b32 v11, 4, v10
    v_mov_b32 v12, 163776
    v_mov_b32 v13, 1
    v_mov_b32 v233, 1
    v_mfma_f32_16x16x32_bf16 v[188:191], v[140:143], v[72:75], v[188:191]
    ds_read_b64_tr_b16 v[28:29], v2 offset:39936
    ds_read_b64_tr_b16 v[30:31], v2 offset:46592
    v_mfma_f32_16x16x32_bf16 v[168:171], v[144:147], v[64:67], v[168:171]
    ds_read_b64_tr_b16 v[32:33], v2 offset:39968
    v_mfma_f32_16x16x32_bf16 v[180:183], v[144:147], v[68:71], v[180:183]
    ds_read_b64_tr_b16 v[34:35], v2 offset:46624
    ds_read_b64_tr_b16 v[36:37], v2 offset:40000
    v_mfma_f32_16x16x32_bf16 v[204:207], v[144:147], v[72:75], v[204:207]
    ds_read_b64_tr_b16 v[38:39], v2 offset:46656
    s_cmp_lg_u32 s46, 2
    s_cbranch_scc1 L_c_19
    v_mfma_f32_16x16x32_bf16 v[208:211], v[136:139], v[220:223], v[208:211]
    v_mfma_f32_16x16x32_bf16 v[212:215], v[140:143], v[220:223], v[212:215]
    v_mfma_f32_16x16x32_bf16 v[216:219], v[144:147], v[220:223], v[216:219]
L_c_19:
    s_waitcnt lgkmcnt(7)
    s_barrier
    s_setprio 3
    v_mfma_f32_16x16x32_bf16 v[160:163], v[148:151], v[76:79], v[160:163]
    ds_read_b64_tr_b16 v[136:137], v4 offset:24576
    ds_read_b64_tr_b16 v[138:139], v4 offset:27648
    v_fma_f32 v240, v240, v243, v236
    v_lshlrev_b32 v248, 16, v192
    v_mfma_f32_16x16x32_bf16 v[172:175], v[148:151], v[80:83], v[172:175]
    ds_read_b64_tr_b16 v[140:141], v5 offset:24608
    v_and_b32 v249, 0xffff0000, v192
    v_lshlrev_b32_e64 v250, 16, v193
    v_and_b32 v251, 0xffff0000, v193
    v_mfma_f32_16x16x32_bf16 v[184:187], v[148:151], v[84:87], v[184:187]
    ds_read_b64_tr_b16 v[142:143], v5 offset:27680
    ds_read_b64_tr_b16 v[144:145], v4 offset:24640
    v_lshlrev_b32_e64 v252, 16, v194
    v_and_b32 v253, 0xffff0000, v194
    v_mfma_f32_16x16x32_bf16 v[164:167], v[152:155], v[76:79], v[164:167]
    ds_read_b64_tr_b16 v[146:147], v4 offset:27712
    v_lshlrev_b32_e64 v254, 16, v195
    v_and_b32 v255, 0xffff0000, v195
    v_mul_f32_e64 v248, v248, v240
    v_mfma_f32_16x16x32_bf16 v[176:179], v[152:155], v[80:83], v[176:179]
    v_add_u32 v2, 53248, v2
    ds_read_b64_tr_b16 v[64:65], v2 offset:0
    v_mul_f32 v249, v249, v240
    v_mul_f32 v250, v250, v240
    v_mfma_f32_16x16x32_bf16 v[188:191], v[152:155], v[84:87], v[188:191]
    ds_read_b64_tr_b16 v[66:67], v2 offset:6656
    v_mul_f32 v251, v251, v240
    v_mul_f32 v252, v252, v240
    v_mul_f32 v253, v253, v240
    s_waitcnt lgkmcnt(5)
    v_mfma_f32_16x16x32_bf16 v[168:171], v[156:159], v[76:79], v[168:171]
    ds_read_b64_tr_b16 v[68:69], v2 offset:32
    ds_read_b64_tr_b16 v[70:71], v2 offset:6688
    v_mul_f32 v254, v254, v240
    v_mul_f32 v255, v255, v240
    v_mfma_f32_16x16x32_bf16 v[180:183], v[156:159], v[80:83], v[180:183]
    ds_read_b64_tr_b16 v[72:73], v2 offset:64
    v_cvt_pk_bf16_f32 v192, v248, v249
    v_cvt_pk_bf16_f32 v193, v250, v251
    v_cvt_pk_bf16_f32 v194, v252, v253
    v_mfma_f32_16x16x32_bf16 v[204:207], v[156:159], v[84:87], v[204:207]
    ds_read_b64_tr_b16 v[74:75], v2 offset:6720
    v_cvt_pk_bf16_f32 v195, v254, v255
    ds_write_b128 v6, v[192:195] offset:49152
    s_cmp_lg_u32 s46, 3
    s_cbranch_scc1 L_c_20
    v_mfma_f32_16x16x32_bf16 v[208:211], v[148:151], v[220:223], v[208:211]
    v_mfma_f32_16x16x32_bf16 v[212:215], v[152:155], v[220:223], v[212:215]
    v_mfma_f32_16x16x32_bf16 v[216:219], v[156:159], v[220:223], v[216:219]
L_c_20:
    s_setprio 2
    v_mfma_f32_16x16x32_bf16 v[160:163], v[136:139], v[88:91], v[160:163]
    ds_read_b64_tr_b16 v[148:149], v4 offset:30720
    ds_read_b64_tr_b16 v[150:151], v4 offset:33792
    v_fma_f32 v241, v241, v243, v236
    v_lshlrev_b32 v248, 16, v196
    v_mfma_f32_16x16x32_bf16 v[172:175], v[136:139], v[92:95], v[172:175]
    ds_read_b64_tr_b16 v[152:153], v5 offset:30752
    v_and_b32 v249, 0xffff0000, v196
    v_lshlrev_b32_e64 v250, 16, v197
    v_and_b32 v251, 0xffff0000, v197
    v_mfma_f32_16x16x32_bf16 v[184:187], v[136:139], v[96:99], v[184:187]
    ds_read_b64_tr_b16 v[154:155], v5 offset:33824
    v_lshlrev_b32_e64 v252, 16, v198
    v_and_b32 v253, 0xffff0000, v198
    s_waitcnt lgkmcnt(5)
    v_mfma_f32_16x16x32_bf16 v[164:167], v[140:143], v[88:91], v[164:167]
    ds_read_b64_tr_b16 v[156:157], v4 offset:30784
    ds_read_b64_tr_b16 v[158:159], v4 offset:33856
    v_lshlrev_b32 v254, 16, v199
    v_and_b32 v255, 0xffff0000, v199
    v_mul_f32_e64 v248, v248, v241
    v_mfma_f32_16x16x32_bf16 v[176:179], v[140:143], v[92:95], v[176:179]
    ds_read_b64_tr_b16 v[76:77], v2 offset:13312
    v_mul_f32 v249, v249, v241
    v_mul_f32 v250, v250, v241
    v_mfma_f32_16x16x32_bf16 v[188:191], v[140:143], v[96:99], v[188:191]
    ds_read_b64_tr_b16 v[78:79], v2 offset:19968
    v_mul_f32 v251, v251, v241
    v_mul_f32 v252, v252, v241
    v_mul_f32_e64 v253, v253, v241
    v_mfma_f32_16x16x32_bf16 v[168:171], v[144:147], v[88:91], v[168:171]
    ds_read_b64_tr_b16 v[80:81], v2 offset:13344
    ds_read_b64_tr_b16 v[82:83], v2 offset:20000
    v_mul_f32 v254, v254, v241
    v_mul_f32 v255, v255, v241
    v_mfma_f32_16x16x32_bf16 v[180:183], v[144:147], v[92:95], v[180:183]
    ds_read_b64_tr_b16 v[84:85], v2 offset:13376
    v_cvt_pk_bf16_f32 v196, v248, v249
    v_cvt_pk_bf16_f32 v197, v250, v251
    v_cvt_pk_bf16_f32 v198, v252, v253
    v_mfma_f32_16x16x32_bf16 v[204:207], v[144:147], v[96:99], v[204:207]
    ds_read_b64_tr_b16 v[86:87], v2 offset:20032
    v_cvt_pk_bf16_f32 v199, v254, v255
    ds_write_b128 v7, v[196:199] offset:49152
    s_cmp_lg_u32 s46, 0
    s_cbranch_scc1 L_c_21
    v_mfma_f32_16x16x32_bf16 v[208:211], v[136:139], v[224:227], v[208:211]
    v_mfma_f32_16x16x32_bf16 v[212:215], v[140:143], v[224:227], v[212:215]
    v_mfma_f32_16x16x32_bf16 v[216:219], v[144:147], v[224:227], v[216:219]
L_c_21:
    s_setprio 1
    s_waitcnt lgkmcnt(5)
    v_mfma_f32_16x16x32_bf16 v[160:163], v[148:151], v[100:103], v[160:163]
    v_add_u32 v4, 36864, v4
    v_add_u32 v5, 36864, v5
    ds_read_b64_tr_b16 v[112:113], v4 offset:0
    v_fma_f32 v242, v242, v243, v236
    v_lshlrev_b32_e64 v248, 16, v200
    v_and_b32 v249, 0xffff0000, v200
    v_lshlrev_b32_e64 v250, 16, v201
    v_mfma_f32_16x16x32_bf16 v[172:175], v[148:151], v[104:107], v[172:175]
    ds_read_b64_tr_b16 v[114:115], v4 offset:3072
    ds_read_b64_tr_b16 v[116:117], v5 offset:32
    v_and_b32 v251, 0xffff0000, v201
    v_lshlrev_b32_e64 v252, 16, v202
    v_and_b32 v253, 0xffff0000, v202
    v_lshlrev_b32_e64 v254, 16, v203
    v_and_b32 v255, 0xffff0000, v203
    v_mfma_f32_16x16x32_bf16 v[184:187], v[148:151], v[108:111], v[184:187]
    ds_read_b64_tr_b16 v[118:119], v5 offset:3104
    ds_read_b64_tr_b16 v[120:121], v4 offset:64
    v_mul_f32 v248, v248, v242
    v_mul_f32 v249, v249, v242
    v_mul_f32 v250, v250, v242
    v_mul_f32 v251, v251, v242
    v_mfma_f32_16x16x32_bf16 v[164:167], v[152:155], v[100:103], v[164:167]
    ds_read_b64_tr_b16 v[122:123], v4 offset:3136
    ds_read_b64_tr_b16 v[124:125], v4 offset:6144
    v_mul_f32 v252, v252, v242
    v_mul_f32 v253, v253, v242
    v_mul_f32 v254, v254, v242
    v_mul_f32 v255, v255, v242
    v_cvt_pk_bf16_f32 v200, v248, v249
    v_mfma_f32_16x16x32_bf16 v[176:179], v[152:155], v[104:107], v[176:179]
    ds_read_b64_tr_b16 v[126:127], v4 offset:9216
    ds_read_b64_tr_b16 v[128:129], v5 offset:6176
    v_cvt_pk_bf16_f32 v201, v250, v251
    v_cvt_pk_bf16_f32 v202, v252, v253
    v_cvt_pk_bf16_f32 v203, v254, v255
    ds_write_b128 v8, v[200:203] offset:49152
    v_mfma_f32_16x16x32_bf16 v[188:191], v[152:155], v[108:111], v[188:191]
    ds_read_b64_tr_b16 v[130:131], v5 offset:9248
    ds_read_b64_tr_b16 v[132:133], v4 offset:6208
    ds_read_b64_tr_b16 v[134:135], v4 offset:9280
    v_mfma_f32_16x16x32_bf16 v[168:171], v[156:159], v[100:103], v[168:171]
    ds_read_b64_tr_b16 v[88:89], v2 offset:26624
    ds_read_b64_tr_b16 v[90:91], v2 offset:33280
    v_mfma_f32_16x16x32_bf16 v[180:183], v[156:159], v[104:107], v[180:183]
    ds_read_b64_tr_b16 v[92:93], v2 offset:26656
    ds_read_b64_tr_b16 v[94:95], v2 offset:33312
    v_mfma_f32_16x16x32_bf16 v[204:207], v[156:159], v[108:111], v[204:207]
    ds_read_b64_tr_b16 v[96:97], v2 offset:26688
    ds_read_b64_tr_b16 v[98:99], v2 offset:33344
    s_cmp_lg_u32 s46, 1
    s_cbranch_scc1 L_c_22
    v_mfma_f32_16x16x32_bf16 v[208:211], v[148:151], v[224:227], v[208:211]
    v_mfma_f32_16x16x32_bf16 v[212:215], v[152:155], v[224:227], v[212:215]
    v_mfma_f32_16x16x32_bf16 v[216:219], v[156:159], v[224:227], v[216:219]
L_c_22:
    s_waitcnt lgkmcnt(9)
    s_barrier
    s_setprio 3
    s_nop 0
    v_mfma_f32_16x16x32_bf16 v[160:163], v[112:115], v[16:19], v[160:163]
    ds_read_b64_tr_b16 v[192:193], v4 offset:12288
    ds_read_b64_tr_b16 v[194:195], v4 offset:15360
    ds_read_b64_tr_b16 v[196:197], v5 offset:12320
    v_mfma_f32_16x16x32_bf16 v[164:167], v[116:119], v[16:19], v[164:167]
    ds_read_b64_tr_b16 v[198:199], v5 offset:15392
    ds_read_b64_tr_b16 v[200:201], v4 offset:12352
    v_mfma_f32_16x16x32_bf16 v[168:171], v[120:123], v[16:19], v[168:171]
    ds_read_b64_tr_b16 v[202:203], v4 offset:15424
    ds_read_b64_tr_b16 v[52:53], v4 offset:18432
    ds_read_b64_tr_b16 v[54:55], v4 offset:21504
    v_mfma_f32_16x16x32_bf16 v[160:163], v[124:127], v[28:31], v[160:163]
    ds_read_b64_tr_b16 v[56:57], v5 offset:18464
    ds_read_b64_tr_b16 v[58:59], v5 offset:21536
    s_waitcnt lgkmcnt(10)
    s_nop 0
    v_mfma_f32_16x16x32_bf16 v[164:167], v[128:131], v[28:31], v[164:167]
    ds_read_b64_tr_b16 v[60:61], v4 offset:18496
    ds_read_b64_tr_b16 v[62:63], v4 offset:21568
    ds_read_b64_tr_b16 v[100:101], v2 offset:39936
    v_mfma_f32_16x16x32_bf16 v[168:171], v[132:135], v[28:31], v[168:171]
    ds_read_b64_tr_b16 v[102:103], v2 offset:46592
    ds_read_b64_tr_b16 v[136:137], v4 offset:24576
    s_waitcnt lgkmcnt(13)
    v_mfma_f32_16x16x32_bf16 v[160:163], v[192:195], v[64:67], v[160:163]
    ds_read_b64_tr_b16 v[138:139], v4 offset:27648
    ds_read_b64_tr_b16 v[140:141], v5 offset:24608
    ds_read_b64_tr_b16 v[142:143], v5 offset:27680
    s_waitcnt lgkmcnt(14)
    v_mfma_f32_16x16x32_bf16 v[164:167], v[196:199], v[64:67], v[164:167]
    ds_read_b64_tr_b16 v[144:145], v4 offset:24640
    ds_read_b64_tr_b16 v[146:147], v4 offset:27712
    s_waitcnt lgkmcnt(14)
    v_mfma_f32_16x16x32_bf16 v[168:171], v[200:203], v[64:67], v[168:171]
    ds_read_b64_tr_b16 v[148:149], v4 offset:30720
    ds_read_b64_tr_b16 v[150:151], v4 offset:33792
    ds_read_b64_tr_b16 v[152:153], v5 offset:30752
    s_waitcnt lgkmcnt(13)
    v_mfma_f32_16x16x32_bf16 v[160:163], v[52:55], v[76:79], v[160:163]
    ds_read_b64_tr_b16 v[154:155], v5 offset:33824
    ds_read_b64_tr_b16 v[156:157], v4 offset:30784
    v_mfma_f32_16x16x32_bf16 v[164:167], v[56:59], v[76:79], v[164:167]
    ds_read_b64_tr_b16 v[158:159], v4 offset:33856
    ds_read_b64_tr_b16 v[104:105], v2 offset:39968
    ds_read_b64_tr_b16 v[106:107], v2 offset:46624
    s_waitcnt lgkmcnt(13)
    v_mfma_f32_16x16x32_bf16 v[168:171], v[60:63], v[76:79], v[168:171]
    ds_read_b64_tr_b16 v[108:109], v2 offset:40000
    ds_read_b64_tr_b16 v[110:111], v2 offset:46656
    s_waitcnt lgkmcnt(13)
    v_mfma_f32_16x16x32_bf16 v[160:163], v[136:139], v[88:91], v[160:163]
    s_waitcnt lgkmcnt(12)
    v_mfma_f32_16x16x32_bf16 v[164:167], v[140:143], v[88:91], v[164:167]
    s_waitcnt lgkmcnt(10)
    v_mfma_f32_16x16x32_bf16 v[168:171], v[144:147], v[88:91], v[168:171]
    s_waitcnt lgkmcnt(8)
    v_mfma_f32_16x16x32_bf16 v[160:163], v[148:151], v[100:103], v[160:163]
    s_waitcnt lgkmcnt(6)
    v_mfma_f32_16x16x32_bf16 v[164:167], v[152:155], v[100:103], v[164:167]
    s_waitcnt lgkmcnt(4)
    v_mfma_f32_16x16x32_bf16 v[168:171], v[156:159], v[100:103], v[168:171]
    s_setprio 2
    v_mfma_f32_16x16x32_bf16 v[172:175], v[112:115], v[20:23], v[172:175]
    v_mfma_f32_16x16x32_bf16 v[176:179], v[116:119], v[20:23], v[176:179]
    s_nop 0
    s_nop 0
    v_cvt_pk_bf16_f32 v160, v160, v161
    v_cvt_pk_bf16_f32 v161, v162, v163
    ds_write_b64 v244, v[160:161] offset:0
    v_mfma_f32_16x16x32_bf16 v[180:183], v[120:123], v[20:23], v[180:183]
    v_cvt_pk_bf16_f32 v164, v164, v165
    v_cvt_pk_bf16_f32 v165, v166, v167
    v_mfma_f32_16x16x32_bf16 v[172:175], v[124:127], v[32:35], v[172:175]
    ds_write_b64 v244, v[164:165] offset:32
    v_cvt_pk_bf16_f32 v168, v168, v169
    v_cvt_pk_bf16_f32 v169, v170, v171
    v_mfma_f32_16x16x32_bf16 v[176:179], v[128:131], v[32:35], v[176:179]
    ds_write_b64 v244, v[168:169] offset:64
    s_mov_b64 exec, 1
    ds_write_b32 v10, v13
    s_mov_b64 exec, -1
    s_cmp_lg_u32 s46, 2
    s_cbranch_scc1 L_c_23
    v_mfma_f32_16x16x32_bf16 v[208:211], v[112:115], v[224:227], v[208:211]
    v_mfma_f32_16x16x32_bf16 v[212:215], v[116:119], v[224:227], v[212:215]
    v_mfma_f32_16x16x32_bf16 v[216:219], v[120:123], v[224:227], v[216:219]
    v_mfma_f32_16x16x32_bf16 v[208:211], v[136:139], v[228:231], v[208:211]
    v_mfma_f32_16x16x32_bf16 v[212:215], v[140:143], v[228:231], v[212:215]
    v_mfma_f32_16x16x32_bf16 v[216:219], v[144:147], v[228:231], v[216:219]
L_c_23:
    s_cmp_lg_u32 s46, 3
    s_cbranch_scc1 L_c_24
    v_mfma_f32_16x16x32_bf16 v[208:211], v[124:127], v[224:227], v[208:211]
    v_mfma_f32_16x16x32_bf16 v[212:215], v[128:131], v[224:227], v[212:215]
    v_mfma_f32_16x16x32_bf16 v[216:219], v[132:135], v[224:227], v[216:219]
    v_mfma_f32_16x16x32_bf16 v[208:211], v[148:151], v[228:231], v[208:211]
    v_mfma_f32_16x16x32_bf16 v[212:215], v[152:155], v[228:231], v[212:215]
    v_mfma_f32_16x16x32_bf16 v[216:219], v[156:159], v[228:231], v[216:219]
L_c_24:
    s_cmp_lg_u32 s46, 0
    s_cbranch_scc1 L_c_25
    v_mfma_f32_16x16x32_bf16 v[208:211], v[192:195], v[228:231], v[208:211]
    v_mfma_f32_16x16x32_bf16 v[212:215], v[196:199], v[228:231], v[212:215]
    v_mfma_f32_16x16x32_bf16 v[216:219], v[200:203], v[228:231], v[216:219]
L_c_25:
    s_cmp_lg_u32 s46, 1
    s_cbranch_scc1 L_c_26
    v_mfma_f32_16x16x32_bf16 v[208:211], v[52:55], v[228:231], v[208:211]
    v_mfma_f32_16x16x32_bf16 v[212:215], v[56:59], v[228:231], v[212:215]
    v_mfma_f32_16x16x32_bf16 v[216:219], v[60:63], v[228:231], v[216:219]
L_c_26:
    v_mfma_f32_16x16x32_bf16 v[180:183], v[132:135], v[32:35], v[180:183]
    ds_read_b32 v232, v11
    ds_read_b128 v[16:19], v245 offset:0
    v_mfma_f32_16x16x32_bf16 v[172:175], v[192:195], v[68:71], v[172:175]
    ds_read_b128 v[28:31], v245 offset:832
    v_mfma_f32_16x16x32_bf16 v[176:179], v[196:199], v[68:71], v[176:179]
    v_mfma_f32_16x16x32_bf16 v[180:183], v[200:203], v[68:71], v[180:183]
    v_mfma_f32_16x16x32_bf16 v[172:175], v[52:55], v[80:83], v[172:175]
    s_waitcnt lgkmcnt(2)
    v_readfirstlane_b32 s23, v232
    s_nop 0
    s_cmp_gt_u32 s23, 0
    s_cbranch_scc1 L_ok_27
L_sp_28:
    ds_read_b32 v232, v11
    s_waitcnt lgkmcnt(1)
    ds_read_b128 v[16:19], v245 offset:0
    s_waitcnt lgkmcnt(0)
    ds_read_b128 v[28:31], v245 offset:832
    s_waitcnt lgkmcnt(0)
    s_waitcnt lgkmcnt(0)
    v_readfirstlane_b32 s23, v232
    s_sub_u32 s62, s62, 1
    s_cmp_le_i32 s62, 0
    s_cbranch_scc1 L_ok_27
    s_cmp_le_u32 s23, 0
    s_cbranch_scc1 L_sp_28
L_ok_27:
    s_waitcnt lgkmcnt(0)
    buffer_store_dwordx4 v[16:19], v40, s[40:43], s59 offen sc0 sc1
    s_waitcnt lgkmcnt(0)
    s_nop 0
    buffer_store_dwordx4 v[28:31], v41, s[40:43], s59 offen sc0 sc1
    v_mfma_f32_16x16x32_bf16 v[176:179], v[56:59], v[80:83], v[176:179]
    v_mov_b32_dpp v208, v212 row_shr:4 row_mask:0xf bank_mask:0x2
    v_mov_b32_dpp v209, v213 row_shr:4 row_mask:0xf bank_mask:0x2
    v_mfma_f32_16x16x32_bf16 v[180:183], v[60:63], v[80:83], v[180:183]
    v_mov_b32_dpp v210, v214 row_shr:4 row_mask:0xf bank_mask:0x2
    v_mfma_f32_16x16x32_bf16 v[172:175], v[136:139], v[92:95], v[172:175]
    v_mov_b32_dpp v211, v215 row_shr:4 row_mask:0xf bank_mask:0x2
    v_mov_b32_dpp v208, v216 row_shr:8 row_mask:0xf bank_mask:0x4
    v_mfma_f32_16x16x32_bf16 v[176:179], v[140:143], v[92:95], v[176:179]
    v_mov_b32_dpp v209, v217 row_shr:8 row_mask:0xf bank_mask:0x4
    v_mfma_f32_16x16x32_bf16 v[180:183], v[144:147], v[92:95], v[180:183]
    v_mov_b32_dpp v210, v218 row_shr:8 row_mask:0xf bank_mask:0x4
    v_mov_b32_dpp v211, v219 row_shr:8 row_mask:0xf bank_mask:0x4
    v_mfma_f32_16x16x32_bf16 v[172:175], v[148:151], v[104:107], v[172:175]
    ds_write_b128 v246, v[208:211]
    s_mov_b64 exec, 1
    ds_add_u32 v12, v233
    s_mov_b64 exec, -1
    v_mfma_f32_16x16x32_bf16 v[176:179], v[152:155], v[104:107], v[176:179]
    v_mfma_f32_16x16x32_bf16 v[180:183], v[156:159], v[104:107], v[180:183]
    s_setprio 1
    s_nop 0
    v_mfma_f32_16x16x32_bf16 v[184:187], v[112:115], v[24:27], v[184:187]
    v_mfma_f32_16x16x32_bf16 v[184:187], v[124:127], v[36:39], v[184:187]
    v_cvt_pk_bf16_f32 v172, v172, v173
    v_cvt_pk_bf16_f32 v173, v174, v175
    ds_write_b64 v244, v[172:173] offset:3328
    v_mfma_f32_16x16x32_bf16 v[184:187], v[192:195], v[72:75], v[184:187]
    v_cvt_pk_bf16_f32 v176, v176, v177
    v_cvt_pk_bf16_f32 v177, v178, v179
    ds_write_b64 v244, v[176:177] offset:3360
    v_mfma_f32_16x16x32_bf16 v[184:187], v[52:55], v[84:87], v[184:187]
    v_cvt_pk_bf16_f32 v180, v180, v181
    v_cvt_pk_bf16_f32 v181, v182, v183
    ds_write_b64 v244, v[180:181] offset:3392
    v_mfma_f32_16x16x32_bf16 v[184:187], v[136:139], v[96:99], v[184:187]
    v_mov_b32 v13, 2
    s_mov_b64 exec, 1
    ds_write_b32 v10, v13
    s_mov_b64 exec, -1
    s_nop 0
    v_mfma_f32_16x16x32_bf16 v[184:187], v[148:151], v[108:111], v[184:187]
    v_mfma_f32_16x16x32_bf16 v[188:191], v[116:119], v[24:27], v[188:191]
    v_mfma_f32_16x16x32_bf16 v[188:191], v[128:131], v[36:39], v[188:191]
    ds_read_b32 v232, v11
    ds_read_b128 v[64:67], v245 offset:3328
    v_mfma_f32_16x16x32_bf16 v[188:191], v[196:199], v[72:75], v[188:191]
    ds_read_b128 v[76:79], v245 offset:4160
    v_mfma_f32_16x16x32_bf16 v[188:191], v[56:59], v[84:87], v[188:191]
    s_nop 0
    v_cvt_pk_bf16_f32 v184, v184, v185
    v_cvt_pk_bf16_f32 v185, v186, v187
    v_mfma_f32_16x16x32_bf16 v[188:191], v[140:143], v[96:99], v[188:191]
    ds_write_b64 v244, v[184:185] offset:6656
    v_mfma_f32_16x16x32_bf16 v[188:191], v[152:155], v[108:111], v[188:191]
    s_waitcnt lgkmcnt(3)
    v_readfirstlane_b32 s23, v232
    s_nop 0
    s_cmp_gt_u32 s23, 1
    s_cbranch_scc1 L_ok_29
L_sp_30:
    ds_read_b32 v232, v11
    s_waitcnt lgkmcnt(2)
    ds_read_b128 v[64:67], v245 offset:3328
    s_waitcnt lgkmcnt(1)
    ds_read_b128 v[76:79], v245 offset:4160
    s_waitcnt lgkmcnt(0)
    s_waitcnt lgkmcnt(0)
    v_readfirstlane_b32 s23, v232
    s_sub_u32 s62, s62, 1
    s_cmp_le_i32 s62, 0
    s_cbranch_scc1 L_ok_29
    s_cmp_le_u32 s23, 1
    s_cbranch_scc1 L_sp_30
L_ok_29:
    s_waitcnt lgkmcnt(0)
    buffer_store_dwordx4 v[64:67], v42, s[40:43], s59 offen sc0 sc1
    s_waitcnt lgkmcnt(0)
    buffer_store_dwordx4 v[76:79], v43, s[40:43], s59 offen sc0 sc1
    v_mfma_f32_16x16x32_bf16 v[204:207], v[120:123], v[24:27], v[204:207]
    v_mfma_f32_16x16x32_bf16 v[204:207], v[132:135], v[36:39], v[204:207]
    v_mfma_f32_16x16x32_bf16 v[204:207], v[200:203], v[72:75], v[204:207]
    v_mfma_f32_16x16x32_bf16 v[204:207], v[60:63], v[84:87], v[204:207]
    v_cvt_pk_bf16_f32 v188, v188, v189
    v_mfma_f32_16x16x32_bf16 v[204:207], v[144:147], v[96:99], v[204:207]
    v_cvt_pk_bf16_f32 v189, v190, v191
    v_mfma_f32_16x16x32_bf16 v[204:207], v[156:159], v[108:111], v[204:207]
    ds_write_b64 v244, v[188:189] offset:6688
    s_nop 6
    v_cvt_pk_bf16_f32 v204, v204, v205
    v_cvt_pk_bf16_f32 v205, v206, v207
    ds_write_b64 v244, v[204:205] offset:6720
    v_mov_b32_e64 v13, 3
    s_mov_b64 exec, 1
    ds_write_b32 v10, v13
    s_mov_b64 exec, -1
    ds_read_b32 v232, v11
    ds_read_b128 v[88:91], v245 offset:6656
    ds_read_b128 v[100:103], v245 offset:7488
    s_cmp_lg_u32 s22, 0
    s_cbranch_scc1 L_c_31
L_cw:
    ds_read_b32 v239, v12
    s_waitcnt lgkmcnt(0)
    s_waitcnt lgkmcnt(0)
    v_readfirstlane_b32 s23, v239
    s_sub_u32 s62, s62, 1
    s_cmp_le_i32 s62, 0
    s_cbranch_scc1 L_cd
    s_cmp_lt_u32 s23, 8
    s_cbranch_scc1 L_cw
L_cd:
    s_nop 0
    ds_read_b128 v[112:115], v47 offset:0
    ds_read_b128 v[116:119], v47 offset:16
    ds_read_b128 v[120:123], v47 offset:1600
    ds_read_b128 v[124:127], v47 offset:1616
    ds_read_b128 v[128:131], v47 offset:3200
    ds_read_b128 v[132:135], v47 offset:3216
    ds_read_b128 v[136:139], v47 offset:4800
    ds_read_b128 v[140:143], v47 offset:4816
L_c_31:
    s_waitcnt lgkmcnt(0)
    v_readfirstlane_b32 s23, v232
    s_nop 0
    s_cmp_gt_u32 s23, 2
    s_cbranch_scc1 L_ok_32
L_sp_33:
    ds_read_b32 v232, v11
    ds_read_b128 v[88:91], v245 offset:6656
    ds_read_b128 v[100:103], v245 offset:7488
    s_waitcnt lgkmcnt(0)
    s_waitcnt lgkmcnt(0)
    v_readfirstlane_b32 s23, v232
    s_sub_u32 s62, s62, 1
    s_cmp_le_i32 s62, 0
    s_cbranch_scc1 L_ok_32
    s_cmp_le_u32 s23, 2
    s_cbranch_scc1 L_sp_33
L_ok_32:
    s_waitcnt lgkmcnt(0)
    buffer_store_dwordx4 v[88:91], v44, s[40:43], s59 offen sc0 sc1
    s_waitcnt lgkmcnt(0)
    buffer_store_dwordx4 v[100:103], v45, s[40:43], s59 offen sc0 sc1
    s_cmp_lg_u32 s22, 0
    s_cbranch_scc1 L_c_34
    s_waitcnt lgkmcnt(0)
    v_pk_add_f32 v[112:113], v[112:113], v[120:121]
    v_pk_add_f32 v[128:129], v[128:129], v[136:137]
    v_pk_add_f32 v[114:115], v[114:115], v[122:123]
    v_pk_add_f32 v[130:131], v[130:131], v[138:139]
    v_pk_add_f32 v[116:117], v[116:117], v[124:125]
    v_pk_add_f32 v[132:133], v[132:133], v[140:141]
    v_pk_add_f32 v[118:119], v[118:119], v[126:127]
    v_pk_add_f32 v[134:135], v[134:135], v[142:143]
    v_pk_add_f32 v[112:113], v[112:113], v[128:129]
    v_pk_add_f32 v[114:115], v[114:115], v[130:131]
    v_pk_add_f32 v[116:117], v[116:117], v[132:133]
    v_pk_add_f32 v[118:119], v[118:119], v[134:135]
    v_cvt_pk_bf16_f32 v148, v112, v113
    v_cvt_pk_bf16_f32 v149, v114, v115
    v_cvt_pk_bf16_f32 v150, v116, v117
    v_cvt_pk_bf16_f32 v151, v118, v119
    buffer_store_dwordx4 v[148:151], v46, s[40:43], s59 offen sc0 sc1
L_c_34:
L_end:
    s_endpgm
.section .rodata,"a"
.p2align 6
.amdhsa_kernel standalone__modern_conv_block_slak__vision_kernel
  .amdhsa_next_free_vgpr 256
  .amdhsa_next_free_sgpr 102
  .amdhsa_accum_offset 256
  .amdhsa_group_segment_fixed_size 0
  .amdhsa_kernarg_size 72
  .amdhsa_user_sgpr_count 2
  .amdhsa_user_sgpr_kernarg_segment_ptr 1
  .amdhsa_system_sgpr_workgroup_id_x 1
.end_amdhsa_kernel
```
